```python
import torch

def _softmax(x, axis=-1):
    return torch.softmax(x, dim=axis)
def _gelu(x):
    return torch.nn.functional.gelu(x, approximate="tanh")
def _silu(x):
    return torch.nn.functional.silu(x)
def _sigmoid(x):
    return torch.sigmoid(x)
def _layernorm(x, axis=-1, eps=1e-5):
    m = x.mean(dim=axis, keepdim=True)
    v = x.var(dim=axis, keepdim=True, unbiased=False)
    return (x - m) / torch.sqrt(v + eps)
def _scatter_add(tgt, idx, src, axis=0):
    return tgt.clone().index_add_(axis, idx, src)
def _segment_sum(src, seg, n):
    out = torch.zeros((n,) + src.shape[1:], dtype=src.dtype)
    return out.index_add_(0, seg, src)
def _pad(x, pw):
    flat = tuple(v for pair in reversed(pw) for v in pair)
    return torch.nn.functional.pad(x, flat)

kernel_name = 'interleave_layers__ssm_conv_h3__glu_gated_geglu__prompt'

def setup_inputs():

    _w = (lambda a: (lambda t: t.to(torch.bfloat16) if t.is_floating_point() else t)(torch.as_tensor(a)))
    def _A_setup():
        B, S, D = 1, 2048, 640
        ks = 4
        return {
            "q": _w((lambda *s: torch.randn(*s, dtype=torch.bfloat16) * 0.05)(B, S, D)),
            "k": _w((lambda *s: torch.randn(*s, dtype=torch.bfloat16) * 0.2)(B, S, D)),
            "v": _w((lambda *s: torch.randn(*s, dtype=torch.bfloat16) * 0.2)(B, S, D)),
            "shift_k": _w((lambda *s: torch.randn(*s, dtype=torch.bfloat16) * 0.2)(D, ks) * 0.5),
            "ssm_k": _w((lambda *s: torch.randn(*s, dtype=torch.bfloat16) * 0.4)(D, S) * (1.0 / S ** 0.5)),
            "ssm_D": _w((lambda *s: torch.randn(*s, dtype=torch.bfloat16) * 0.2)(D)),
        }
    _A_in = _A_setup()

    def _B_setup():
        B, S, Dm, Df = 1, 2048, 640, 1536
        return {
            "x": _w((lambda *s: torch.randn(*s, dtype=torch.bfloat16) * 0.05)(B, S, Dm)),
            "w_gate": _w((lambda *s: torch.randn(*s, dtype=torch.bfloat16) * 0.4)(Dm, Df) * (Dm ** -0.5)),
            "w_up": _w((lambda *s: torch.randn(*s, dtype=torch.bfloat16) * 0.4)(Dm, Df) * (Dm ** -0.5)),
            "w_down": _w((lambda *s: torch.randn(*s, dtype=torch.bfloat16) * 0.4)(Df, Dm) * (Df ** -0.5)),
        }
    _B_in = _B_setup()

    return {
        "A_q": _A_in["q"],
        "A_k": _A_in["k"],
        "A_v": _A_in["v"],
        "A_shift_k": _A_in["shift_k"],
        "A_ssm_k": _A_in["ssm_k"],
        "A_ssm_D": _A_in["ssm_D"],
        "B_x": _B_in["x"],
        "B_w_gate": _B_in["w_gate"],
        "B_w_up": _B_in["w_up"],
        "B_w_down": _B_in["w_down"],
    }

def reference(A_q, A_k, A_v, A_shift_k, A_ssm_k, A_ssm_D, B_x, B_w_gate, B_w_up, B_w_down):
    def _A_ref(q, k, v, shift_k, ssm_k, ssm_D):
        B, S, D = q.shape
        ks = shift_k.shape[-1]
        k_pad = _pad(k, ((0, 0), (ks - 1, 0), (0, 0)))
        k_shift = torch.zeros_like(k)
        for t in range(ks):
            k_shift = k_shift + k_pad[:, t:t + S, :] * shift_k[:, ks - 1 - t][None, None, :]
        kv = k_shift * v
        L = 2 * S
        kv_pad = _pad(kv, ((0, 0), (0, S), (0, 0)))
        kf_pad = _pad(ssm_k, ((0, 0), (0, S)))
        kv_f = (lambda x, axes=(-2,-1): torch.fft.rfft2(x.float(), dim=axes))(kv_pad[:, None, :, :], axes=(1, 2))
        kf_f = (lambda x, axes=(-2,-1): torch.fft.rfft2(x.float(), dim=axes))(kf_pad[:, None, :], axes=(1, 2))
        kf_f = (lambda x, *d: x.permute(*d))(kf_f, 1, 2, 0)
        y_f = kv_f * kf_f[None, :, :, :]
        y = (lambda x, s, axes=(-2,-1): torch.fft.irfft2(x, s=s, dim=axes).to(torch.bfloat16))(y_f, (1, L), axes=(1, 2))[:, 0, :S, :]
        y = y + kv * ssm_D[None, None, :]
        return q * y

    def _B_ref(x, w_gate, w_up, w_down):
        g = torch.einsum("bsd,df->bsf", x, w_gate)
        u = torch.einsum("bsd,df->bsf", x, w_up)
        h = _gelu(g) * u
        return torch.einsum("bsf,fd->bsd", h, w_down)

    x = A_q
    x = x + _A_ref(_layernorm(x, axis=-1), A_k, A_v, A_shift_k, A_ssm_k, A_ssm_D)
    x = x + _B_ref(_layernorm(x, axis=-1), B_w_gate, B_w_up, B_w_down)
    x = x + _A_ref(_layernorm(x, axis=-1), A_k, A_v, A_shift_k, A_ssm_k, A_ssm_D)
    x = x + _B_ref(_layernorm(x, axis=-1), B_w_gate, B_w_up, B_w_down)
    return x
```

```asm
; @launch grid=(256,1,1) block=(256,1,1) lds=163840
.amdgcn_target "amdgcn-amd-amdhsa--gfx950"
.text
.globl interleave_layers__ssm_conv_h3__glu_gated_geglu__prompt_kernel
.p2align 8
.type interleave_layers__ssm_conv_h3__glu_gated_geglu__prompt_kernel,@function
interleave_layers__ssm_conv_h3__glu_gated_geglu__prompt_kernel:
    s_cmp_ge_u32 s2, 256
    s_cbranch_scc1 L_mega_end
    s_getpc_b64 s[48:49]
    v_lshlrev_b32 v5, 7, v0
    v_min_u32 v5, 5120, v5
    global_load_dword a253, v5, s[48:49]
    s_load_dwordx4 s[44:47], s[0:1], 88
    s_load_dwordx2 s[24:25], s[0:1], 0
    s_load_dwordx2 s[28:29], s[0:1], 8
    s_load_dwordx2 s[32:33], s[0:1], 16
    s_load_dwordx2 s[20:21], s[0:1], 24
    s_load_dwordx4 s[4:7], s[0:1], 32
    s_load_dwordx4 s[40:43], s[0:1], 56
    s_load_dwordx2 s[36:37], s[0:1], 72
    s_load_dwordx2 s[12:13], s[0:1], 80
    s_memrealtime s[98:99]
    v_lshrrev_b32 v2, 6, v0
    v_and_b32 v1, 63, v0
    v_readfirstlane_b32 s3, v2
    v_lshlrev_b32 v2, 4, v1
    v_lshrrev_b32 v3, 5, v1
    v_and_b32 v4, 31, v1
    s_lshl_b32 s100, s2, 3
    s_lshl_b32 s101, s3, 1
    s_add_u32 s100, s100, s101
    v_add_u32 v16, s100, v3
    v_mul_u32_u24 v17, 1280, v16
    v_lshl_add_u32 v17, v4, 3, v17
    s_lshr_b32 s100, s2, 6
    s_lshl_b32 s100, s100, 3
    s_and_b32 s101, s2, 7
    s_add_u32 s100, s100, s101
    s_bfe_u32 s101, s2, 0x30003
    s_mul_i32 s38, s100, 81920
    s_mul_i32 s39, s101, 160
    s_add_u32 s38, s38, s39
    v_mov_b32 v31, 0x80000000
    v_add_u32 v24, 0, v0
    v_mul_u32_u24 v25, 6554, v24
    v_lshrrev_b32 v25, 16, v25
    v_mul_u32_u24 v25, 1120, v25
    v_lshl_add_u32 v18, v24, 4, v25
    v_add_u32 v18, s38, v18
    v_subrev_u32 v21, 3840, v18
    v_add_u32 v24, 256, v0
    v_mul_u32_u24 v25, 6554, v24
    v_lshrrev_b32 v25, 16, v25
    v_mul_u32_u24 v25, 1120, v25
    v_lshl_add_u32 v19, v24, 4, v25
    v_add_u32 v19, s38, v19
    v_subrev_u32 v22, 3840, v19
    v_add_u32 v24, 512, v0
    v_mul_u32_u24 v25, 6554, v24
    v_lshrrev_b32 v25, 16, v25
    v_mul_u32_u24 v25, 1120, v25
    v_lshl_add_u32 v20, v24, 4, v25
    v_add_u32 v20, s38, v20
    v_subrev_u32 v23, 3840, v20
    v_cmp_gt_u32 vcc, 128, v0
    s_lshl_b32 s38, s3, 10
    s_mov_b32 s26, 2621440
    v_cndmask_b32 v20, v31, v20, vcc
    v_cmp_gt_u32 vcc, 158, v0
    s_mov_b32 s27, 0x20000
    s_mov_b32 s30, 2621440
    v_cndmask_b32 v23, v31, v23, vcc
    s_mov_b32 s31, 0x20000
    s_mov_b32 s34, 2621440
    s_mov_b32 s35, 0x20000
    s_add_u32 m0, s38, 110592
    s_waitcnt lgkmcnt(0)
    v_mov_b32 v24, 0
    s_or_b32 s97, s2, s3
    s_cmp_lg_u32 s97, 0
    s_cbranch_scc1 L_nonce
    s_or_b32 s98, s98, 1
    v_mov_b32 v25, s98
    s_mov_b64 exec, 1
    global_store_dword v24, v25, s[44:45] sc1
    s_mov_b64 exec, -1
L_nonce:
    s_lshr_b32 s97, s2, 3
    s_cmp_lg_u32 s3, 3
    s_cbranch_scc1 L_nocode
    s_getpc_b64 s[98:99]
L_pc:
    s_lshl_b32 s97, s97, 13
    v_lshl_add_u32 v25, v1, 7, s97
    v_cmp_gt_u32 vcc, L_g1_0-L_pc, v25
    s_nop 0
    s_and_saveexec_b64 s[22:23], vcc
    s_cbranch_execz L_nocode0
    global_load_dword a252, v25, s[98:99]
L_nocode0:
    s_mov_b64 exec, -1
L_nocode:
    s_and_b32 s25, s25, 0xffff
    s_and_b32 s29, s29, 0xffff
    s_and_b32 s33, s33, 0xffff
    buffer_load_dwordx2 v[32:33], v17, s[24:27], 0 offen offset:0
    buffer_load_dwordx2 v[34:35], v17, s[24:27], 0 offen offset:256
    buffer_load_dwordx2 v[36:37], v17, s[24:27], 0 offen offset:512
    buffer_load_dwordx2 v[38:39], v17, s[24:27], 0 offen offset:768
    buffer_load_dwordx2 v[40:41], v17, s[24:27], 0 offen offset:1024
    buffer_load_dwordx4 v21, s[28:31], 0 offen lds
    s_add_u32 m0, s38, 122880
    s_nop 0
    buffer_load_dwordx4 v18, s[32:35], 0 offen lds
    s_add_u32 m0, s38, 114688
    s_nop 0
    buffer_load_dwordx4 v22, s[28:31], 0 offen lds
    s_add_u32 m0, s38, 126976
    s_nop 0
    buffer_load_dwordx4 v19, s[32:35], 0 offen lds
    s_add_u32 m0, s38, 118784
    s_nop 0
    buffer_load_dwordx4 v23, s[28:31], 0 offen lds
    s_add_u32 m0, s38, 131072
    s_nop 0
    buffer_load_dwordx4 v20, s[32:35], 0 offen lds
    v_cmp_lt_u32 vcc, 19, v1
    v_subrev_u32 v26, 20, v1
    s_lshl_b32 s25, s3, 1
    v_cndmask_b32 v26, v1, v26, vcc
    v_cndmask_b32 v27, 0, 1, vcc
    v_add_u32 v27, s25, v27
    s_mul_i32 s25, s101, 640
    v_lshl_add_u32 v28, v26, 5, s25
    s_and_b32 s21, s21, 0xffff
    s_mov_b32 s22, 5120
    s_mov_b32 s23, 0x20000
    buffer_load_dwordx4 v[44:47], v28, s[20:23], 0 offen
    buffer_load_dwordx4 v[48:51], v28, s[20:23], 0 offen offset:16
    s_mov_b32 s8, s46
    s_and_b32 s9, s47, 0xffff
    s_mov_b32 s10, 20889600
    s_mov_b32 s11, 0x20000
    s_bitcmp1_b32 s3, 0
    s_cselect_b32 s16, s42, s40
    s_cselect_b32 s17, s43, s41
    s_and_b32 s17, s17, 0xffff
    s_mov_b32 s18, 1966080
    s_mov_b32 s19, 0x20000
    s_and_b32 s13, s13, 0xffff
    s_mov_b32 s14, 2621440
    s_mov_b32 s15, 0x20000
    s_and_b32 s20, s2, 7
    s_lshr_b32 s21, s2, 3
    s_lshr_b32 s27, s3, 1
    s_mul_i32 s30, s27, 98304
    s_mul_i32 s31, s21, 96
    s_add_u32 s0, s30, s31
    s_mul_i32 s31, s27, 3072
    s_and_b32 s27, s3, 1
    s_mul_i32 s27, s27, 61440
    s_add_u32 s1, s31, s27
    s_mov_b32 s39, 0xffff0000
    v_mov_b32 v29, v16
    s_lshr_b32 s38, s21, 1
    s_xor_b32 s38, s38, s21
    s_and_b32 s38, s38, 1
    v_add_u32 v15, 0, v1
    v_mul_u32_u24 v16, 10923, v15
    v_lshrrev_b32 v16, 16, v16
    v_mul_u32_u24 v16, 2976, v16
    v_lshl_add_u32 v12, v15, 4, v16
    v_add_u32 v15, 64, v1
    v_mul_u32_u24 v16, 10923, v15
    v_lshrrev_b32 v16, 16, v16
    v_mul_u32_u24 v16, 2976, v16
    v_lshl_add_u32 v13, v15, 4, v16
    v_add_u32 v15, 128, v1
    v_mul_u32_u24 v16, 10923, v15
    v_lshrrev_b32 v16, 16, v16
    v_mul_u32_u24 v16, 2976, v16
    v_lshl_add_u32 v14, v15, 4, v16
    s_waitcnt vmcnt(8)
    v_lshlrev_b32 v15, 6, v4
    v_lshl_add_u32 v15, v3, 3, v15
    s_lshl_b32 s25, s3, 4
    s_add_u32 s25, s25, 98304
    v_add_u32 v15, s25, v15
    ds_write_b64 v15, v[32:33] offset:0
    ds_write_b64 v15, v[34:35] offset:2048
    ds_write_b64 v15, v[36:37] offset:4096
    ds_write_b64 v15, v[38:39] offset:6144
    ds_write_b64 v15, v[40:41] offset:8192
    v_lshlrev_b32 v64, 16, v32
    v_and_b32 v65, s39, v32
    v_lshlrev_b32 v66, 16, v33
    v_and_b32 v67, s39, v33
    v_lshlrev_b32 v68, 16, v34
    v_and_b32 v69, s39, v34
    v_lshlrev_b32 v70, 16, v35
    v_and_b32 v71, s39, v35
    v_lshlrev_b32 v72, 16, v36
    v_and_b32 v73, s39, v36
    v_lshlrev_b32 v74, 16, v37
    v_and_b32 v75, s39, v37
    v_lshlrev_b32 v76, 16, v38
    v_and_b32 v77, s39, v38
    v_lshlrev_b32 v78, 16, v39
    v_and_b32 v79, s39, v39
    v_lshlrev_b32 v80, 16, v40
    v_and_b32 v81, s39, v40
    v_lshlrev_b32 v82, 16, v41
    v_and_b32 v83, s39, v41
.p2align 3
    v_pk_add_f32 v[84:85], v[64:65], v[66:67]
    v_pk_mul_f32 v[86:87], v[64:65], v[64:65]
    v_pk_fma_f32 v[86:87], v[66:67], v[66:67], v[86:87]
    v_pk_add_f32 v[84:85], v[84:85], v[68:69]
    v_pk_fma_f32 v[86:87], v[68:69], v[68:69], v[86:87]
    v_pk_add_f32 v[84:85], v[84:85], v[70:71]
    v_pk_fma_f32 v[86:87], v[70:71], v[70:71], v[86:87]
    v_pk_add_f32 v[84:85], v[84:85], v[72:73]
    v_pk_fma_f32 v[86:87], v[72:73], v[72:73], v[86:87]
    v_pk_add_f32 v[84:85], v[84:85], v[74:75]
    v_pk_fma_f32 v[86:87], v[74:75], v[74:75], v[86:87]
    v_pk_add_f32 v[84:85], v[84:85], v[76:77]
    v_pk_fma_f32 v[86:87], v[76:77], v[76:77], v[86:87]
    v_pk_add_f32 v[84:85], v[84:85], v[78:79]
    v_pk_fma_f32 v[86:87], v[78:79], v[78:79], v[86:87]
    v_pk_add_f32 v[84:85], v[84:85], v[80:81]
    v_pk_fma_f32 v[86:87], v[80:81], v[80:81], v[86:87]
    v_pk_add_f32 v[84:85], v[84:85], v[82:83]
    v_pk_fma_f32 v[86:87], v[82:83], v[82:83], v[86:87]
    v_add_f32 v84, v84, v85
    v_add_f32 v85, v86, v87
    s_nop 0
    v_add_f32_dpp v84, v84, v84 row_ror:8 row_mask:0xf bank_mask:0xf
    v_add_f32_dpp v85, v85, v85 row_ror:8 row_mask:0xf bank_mask:0xf
    s_nop 0
    v_add_f32_dpp v84, v84, v84 row_ror:4 row_mask:0xf bank_mask:0xf
    v_add_f32_dpp v85, v85, v85 row_ror:4 row_mask:0xf bank_mask:0xf
    s_nop 0
    v_add_f32_dpp v84, v84, v84 row_ror:2 row_mask:0xf bank_mask:0xf
    v_add_f32_dpp v85, v85, v85 row_ror:2 row_mask:0xf bank_mask:0xf
    s_nop 0
    v_add_f32_dpp v84, v84, v84 row_ror:1 row_mask:0xf bank_mask:0xf
    v_add_f32_dpp v85, v85, v85 row_ror:1 row_mask:0xf bank_mask:0xf
    v_mov_b32 v86, v84
    v_mov_b32 v87, v85
    s_nop 0
    v_permlane16_swap_b32 v84, v86
    v_permlane16_swap_b32 v85, v87
    v_pk_add_f32 v[84:85], v[84:85], v[86:87]
    v_mul_f32 v86, 0x3acccccd, v84
    v_mul_f32 v87, 0x3acccccd, v85
    v_fma_f32 v87, -v86, v86, v87
    v_max_f32 v87, 0, v87
    v_cvt_pk_bf16_f32 v86, v86, v86
    v_lshlrev_b32 v86, 16, v86
    v_cvt_pk_bf16_f32 v87, v87, v87
    v_lshlrev_b32 v87, 16, v87
    v_add_f32 v87, 0x3727c5ac, v87
    v_cvt_pk_bf16_f32 v87, v87, v87
    v_lshlrev_b32 v87, 16, v87
    v_sqrt_f32 v87, v87
    s_nop 0
    v_cvt_pk_bf16_f32 v87, v87, v87
    v_lshlrev_b32 v87, 16, v87
    v_rcp_f32 v87, v87
    v_lshlrev_b32 v29, 3, v29
    s_mov_b32 s25, 2621440
    s_mov_b32 exec_lo, 1
    s_mov_b32 exec_hi, 1
    buffer_store_dwordx2 v[86:87], v29, s[8:11], s25 offen sc1
    s_mov_b64 exec, -1
    s_mul_i32 s25, s2, 1536
    s_add_u32 s25, s25, 16236544
    v_lshl_add_u32 v15, v0, 4, s25
    v_cmp_gt_u32 vcc, 96, v0
    s_lshl_b32 s25, s101, 7
    s_add_u32 s25, s25, 16687104
    s_cmp_eq_u32 s100, 0
    s_cselect_b32 s25, s25, 0x80000000
    v_cndmask_b32 v15, v31, v15, vcc
    v_cndmask_b32 v52, 0, -1, vcc
    v_mov_b32 v16, s25
    v_cmp_eq_u32 vcc, 96, v0
    v_mov_b32 v53, v52
    v_mov_b32 v54, v52
    v_mov_b32 v55, v52
    v_cndmask_b32 v15, v15, v16, vcc
    buffer_store_dwordx4 v[52:55], v15, s[8:11], 0 offen sc1
    v_mul_u32_u24 v16, 1280, v27
    v_lshl_add_u32 v16, v26, 3, v16
    v_add_u32 v16, 110592, v16
    v_mul_u32_u24 v17, 576, v26
    v_lshlrev_b32 v27, 4, v27
    v_sub_u32 v17, v17, v27
    v_add_u32 v17, 86896, v17
    v_lshrrev_b32 v26, 3, v0
    v_and_b32 v27, 7, v0
    v_mul_u32_u24 v18, 144, v26
    v_lshl_add_u32 v18, v27, 4, v18
    v_add_u32 v18, 86784, v18
    v_lshlrev_b32 v19, 12, v26
    v_lshl_add_u32 v19, v27, 4, v19
    v_lshlrev_b32 v20, 4, v0
    v_add_u32 v20, 98304, v20
    v_lshrrev_b32 v21, 2, v0
    v_lshlrev_b32 v21, 9, v21
    v_and_b32 v27, 3, v0
    v_lshl_add_u32 v21, v27, 4, v21
    v_cmp_gt_u32 vcc, 128, v0
    s_mul_i32 s22, s101, 327680
    s_lshl_b32 s23, s100, 7
    s_sub_u32 s22, s22, s23
    v_cndmask_b32 v22, v31, v19, vcc
    v_cndmask_b32 v23, v31, v21, vcc
    s_add_u32 s22, s22, 3968
    s_mul_i32 s23, s21, 81920
    s_lshl_b32 s25, s20, 6
    s_add_u32 s23, s23, s25
    s_add_u32 s23, s23, 2637824
    s_lshl_b32 s25, s20, 2
    s_sub_u32 s97, s21, s25
    s_and_b32 s97, s97, 31
    s_mul_i32 s40, s20, 20
    s_add_u32 s40, s40, s97
    s_sub_u32 s40, s40, 12
    s_lshl_b32 s41, s40, 2
    s_add_u32 s41, s41, s3
    s_mul_i32 s26, s3, 4608
    s_add_u32 s26, s26, 145408
    s_add_u32 s27, s26, 512
    s_mov_b32 s32, s4
    s_and_b32 s33, s5, 0xffff
    s_mov_b32 s34, 2621440
    s_lshl_b32 s25, s41, 12
    s_cmp_lt_u32 s97, 12
    s_cselect_b32 s25, 0, s25
    s_mov_b32 s30, s33
    s_mul_i32 s47, s38, 3
    s_mul_i32 s33, s47, 196608
    s_add_u32 s33, s33, s0
    s_mul_i32 s47, s47, 6144
    s_add_u32 s47, s47, s1
    s_add_u32 m0, s47, 0
    s_nop 0
    buffer_load_dwordx4 v12, s[16:19], s33 offen lds
    s_add_u32 m0, s47, 1024
    s_nop 0
    buffer_load_dwordx4 v13, s[16:19], s33 offen lds
    s_add_u32 m0, s47, 2048
    s_nop 0
    buffer_load_dwordx4 v14, s[16:19], s33 offen lds
    s_mov_b32 s33, s30
    s_waitcnt vmcnt(5)
    s_waitcnt lgkmcnt(0)
    s_barrier
    global_load_dword v30, v24, s[44:45] sc1
.p2align 3
    ds_read_b128 v[52:55], v20 offset:0
    ds_read_b128 v[56:59], v20 offset:4096
    ds_read_b128 v[60:63], v20 offset:8192
    ds_read_b64 v[64:65], v16 offset:0
    ds_read_b64 v[66:67], v16 offset:160
    ds_read_b64 v[68:69], v16 offset:320
    ds_read_b64 v[70:71], v16 offset:480
    ds_read_b64 v[72:73], v16 offset:640
    ds_read_b64 v[74:75], v16 offset:800
    ds_read_b64 v[76:77], v16 offset:960
    ds_read_b64 v[78:79], v16 offset:1120
    ds_read_b64 v[80:81], v16 offset:1280
    ds_read_b64 v[82:83], v16 offset:1440
    ds_read_b64 v[84:85], v16 offset:1600
    v_lshlrev_b32 v160, 16, v44
    v_lshlrev_b32 v161, 16, v46
    v_and_b32 v164, s39, v44
    v_and_b32 v165, s39, v46
    v_lshlrev_b32 v168, 16, v45
    v_lshlrev_b32 v169, 16, v47
    v_and_b32 v172, s39, v45
    v_and_b32 v173, s39, v47
    v_lshlrev_b32 v162, 16, v48
    v_lshlrev_b32 v163, 16, v50
    v_and_b32 v166, s39, v48
    v_and_b32 v167, s39, v50
    v_lshlrev_b32 v170, 16, v49
    v_lshlrev_b32 v171, 16, v51
    v_and_b32 v174, s39, v49
    v_and_b32 v175, s39, v51
    s_waitcnt lgkmcnt(4)
    ds_read_b64 v[96:97], v16 offset:12288
    ds_read_b64 v[98:99], v16 offset:12448
    ds_read_b64 v[100:101], v16 offset:12608
    ds_read_b64 v[102:103], v16 offset:12768
    ds_read_b64 v[104:105], v16 offset:12928
    ds_read_b64 v[106:107], v16 offset:13088
    ds_read_b64 v[108:109], v16 offset:13248
    ds_read_b64 v[110:111], v16 offset:13408
    v_lshlrev_b32 v112, 16, v64
    v_and_b32 v113, s39, v64
    v_lshlrev_b32 v114, 16, v65
    v_and_b32 v115, s39, v65
    v_lshlrev_b32 v116, 16, v66
    v_and_b32 v117, s39, v66
    v_lshlrev_b32 v118, 16, v67
    v_and_b32 v119, s39, v67
    v_lshlrev_b32 v120, 16, v68
    v_and_b32 v121, s39, v68
    v_lshlrev_b32 v122, 16, v69
    v_and_b32 v123, s39, v69
    v_lshlrev_b32 v124, 16, v70
    v_and_b32 v125, s39, v70
    v_lshlrev_b32 v126, 16, v71
    v_and_b32 v127, s39, v71
    v_lshlrev_b32 v128, 16, v72
    v_and_b32 v129, s39, v72
    v_lshlrev_b32 v130, 16, v73
    v_and_b32 v131, s39, v73
    v_lshlrev_b32 v132, 16, v74
    v_and_b32 v133, s39, v74
    v_lshlrev_b32 v134, 16, v75
    v_and_b32 v135, s39, v75
    v_lshlrev_b32 v136, 16, v76
    v_and_b32 v137, s39, v76
    v_lshlrev_b32 v138, 16, v77
    v_and_b32 v139, s39, v77
    s_waitcnt lgkmcnt(8)
    v_lshlrev_b32 v140, 16, v78
    v_and_b32 v141, s39, v78
    v_lshlrev_b32 v142, 16, v79
    v_and_b32 v143, s39, v79
    v_lshlrev_b32 v144, 16, v80
    v_and_b32 v145, s39, v80
    v_lshlrev_b32 v146, 16, v81
    v_and_b32 v147, s39, v81
    v_lshlrev_b32 v148, 16, v82
    v_and_b32 v149, s39, v82
    v_lshlrev_b32 v150, 16, v83
    v_and_b32 v151, s39, v83
    v_lshlrev_b32 v152, 16, v84
    v_and_b32 v153, s39, v84
    v_lshlrev_b32 v154, 16, v85
    v_and_b32 v155, s39, v85
    v_pk_mul_f32 v[176:177], v[112:113], v[172:173]
    v_pk_mul_f32 v[178:179], v[114:115], v[174:175]
    buffer_store_dwordx4 v[52:55], v21, s[8:11], s23 offen sc1
    s_add_u32 s23, s23, 32768
.p2align 3
    v_pk_mul_f32 v[180:181], v[116:117], v[172:173]
    v_pk_mul_f32 v[182:183], v[118:119], v[174:175]
    v_pk_mul_f32 v[184:185], v[120:121], v[172:173]
    v_pk_mul_f32 v[186:187], v[122:123], v[174:175]
    v_pk_mul_f32 v[188:189], v[124:125], v[172:173]
    v_pk_mul_f32 v[190:191], v[126:127], v[174:175]
    v_pk_mul_f32 v[192:193], v[128:129], v[172:173]
    v_pk_mul_f32 v[194:195], v[130:131], v[174:175]
    v_pk_mul_f32 v[196:197], v[132:133], v[172:173]
    v_pk_mul_f32 v[198:199], v[134:135], v[174:175]
    v_pk_mul_f32 v[200:201], v[136:137], v[172:173]
    v_pk_mul_f32 v[202:203], v[138:139], v[174:175]
    v_pk_mul_f32 v[204:205], v[140:141], v[172:173]
    v_pk_mul_f32 v[206:207], v[142:143], v[174:175]
    v_pk_fma_f32 v[176:177], v[116:117], v[168:169], v[176:177]
    v_pk_fma_f32 v[178:179], v[118:119], v[170:171], v[178:179]
    buffer_store_dwordx4 v[56:59], v21, s[8:11], s23 offen sc1
    s_add_u32 s23, s23, 32768
.p2align 3
    v_pk_fma_f32 v[180:181], v[120:121], v[168:169], v[180:181]
    v_pk_fma_f32 v[182:183], v[122:123], v[170:171], v[182:183]
    v_pk_fma_f32 v[184:185], v[124:125], v[168:169], v[184:185]
    v_pk_fma_f32 v[186:187], v[126:127], v[170:171], v[186:187]
    v_pk_fma_f32 v[188:189], v[128:129], v[168:169], v[188:189]
    v_pk_fma_f32 v[190:191], v[130:131], v[170:171], v[190:191]
    v_pk_fma_f32 v[192:193], v[132:133], v[168:169], v[192:193]
    v_pk_fma_f32 v[194:195], v[134:135], v[170:171], v[194:195]
    v_pk_fma_f32 v[196:197], v[136:137], v[168:169], v[196:197]
    v_pk_fma_f32 v[198:199], v[138:139], v[170:171], v[198:199]
    v_pk_fma_f32 v[200:201], v[140:141], v[168:169], v[200:201]
    v_pk_fma_f32 v[202:203], v[142:143], v[170:171], v[202:203]
    v_pk_fma_f32 v[204:205], v[144:145], v[168:169], v[204:205]
    v_pk_fma_f32 v[206:207], v[146:147], v[170:171], v[206:207]
    v_pk_fma_f32 v[176:177], v[120:121], v[164:165], v[176:177]
    v_pk_fma_f32 v[178:179], v[122:123], v[166:167], v[178:179]
    buffer_store_dwordx4 v[60:63], v23, s[8:11], s23 offen sc1
    v_pk_fma_f32 v[180:181], v[124:125], v[164:165], v[180:181]
    v_pk_fma_f32 v[182:183], v[126:127], v[166:167], v[182:183]
    v_pk_fma_f32 v[184:185], v[128:129], v[164:165], v[184:185]
    v_pk_fma_f32 v[186:187], v[130:131], v[166:167], v[186:187]
    v_pk_fma_f32 v[188:189], v[132:133], v[164:165], v[188:189]
    v_pk_fma_f32 v[190:191], v[134:135], v[166:167], v[190:191]
    v_pk_fma_f32 v[192:193], v[136:137], v[164:165], v[192:193]
    v_pk_fma_f32 v[194:195], v[138:139], v[166:167], v[194:195]
    v_pk_fma_f32 v[196:197], v[140:141], v[164:165], v[196:197]
    v_pk_fma_f32 v[198:199], v[142:143], v[166:167], v[198:199]
    v_pk_fma_f32 v[200:201], v[144:145], v[164:165], v[200:201]
    v_pk_fma_f32 v[202:203], v[146:147], v[166:167], v[202:203]
    v_pk_fma_f32 v[204:205], v[148:149], v[164:165], v[204:205]
    v_pk_fma_f32 v[206:207], v[150:151], v[166:167], v[206:207]
    v_pk_fma_f32 v[176:177], v[124:125], v[160:161], v[176:177]
    v_pk_fma_f32 v[178:179], v[126:127], v[162:163], v[178:179]
    v_pk_fma_f32 v[180:181], v[128:129], v[160:161], v[180:181]
    v_pk_fma_f32 v[182:183], v[130:131], v[162:163], v[182:183]
    v_pk_fma_f32 v[184:185], v[132:133], v[160:161], v[184:185]
    v_pk_fma_f32 v[186:187], v[134:135], v[162:163], v[186:187]
    v_pk_fma_f32 v[188:189], v[136:137], v[160:161], v[188:189]
    v_pk_fma_f32 v[190:191], v[138:139], v[162:163], v[190:191]
    v_pk_fma_f32 v[192:193], v[140:141], v[160:161], v[192:193]
    v_pk_fma_f32 v[194:195], v[142:143], v[162:163], v[194:195]
    v_pk_fma_f32 v[196:197], v[144:145], v[160:161], v[196:197]
    v_pk_fma_f32 v[198:199], v[146:147], v[162:163], v[198:199]
    v_pk_fma_f32 v[200:201], v[148:149], v[160:161], v[200:201]
    v_pk_fma_f32 v[202:203], v[150:151], v[162:163], v[202:203]
    v_pk_fma_f32 v[204:205], v[152:153], v[160:161], v[204:205]
    v_pk_fma_f32 v[206:207], v[154:155], v[162:163], v[206:207]
    s_waitcnt lgkmcnt(0)
    v_lshlrev_b32 v208, 16, v96
    v_and_b32 v209, s39, v96
    v_pk_mul_f32 v[176:177], v[176:177], v[208:209]
    v_lshlrev_b32 v210, 16, v97
    v_and_b32 v211, s39, v97
    v_pk_mul_f32 v[178:179], v[178:179], v[210:211]
    v_lshlrev_b32 v212, 16, v98
    v_and_b32 v213, s39, v98
    v_pk_mul_f32 v[180:181], v[180:181], v[212:213]
    v_lshlrev_b32 v214, 16, v99
    v_and_b32 v215, s39, v99
    v_pk_mul_f32 v[182:183], v[182:183], v[214:215]
    v_lshlrev_b32 v216, 16, v100
    v_and_b32 v217, s39, v100
    v_pk_mul_f32 v[184:185], v[184:185], v[216:217]
    v_lshlrev_b32 v218, 16, v101
    v_and_b32 v219, s39, v101
    v_pk_mul_f32 v[186:187], v[186:187], v[218:219]
    v_lshlrev_b32 v220, 16, v102
    v_and_b32 v221, s39, v102
    v_pk_mul_f32 v[188:189], v[188:189], v[220:221]
    v_lshlrev_b32 v222, 16, v103
    v_and_b32 v223, s39, v103
    v_pk_mul_f32 v[190:191], v[190:191], v[222:223]
    v_lshlrev_b32 v224, 16, v104
    v_and_b32 v225, s39, v104
    v_pk_mul_f32 v[192:193], v[192:193], v[224:225]
    v_lshlrev_b32 v226, 16, v105
    v_and_b32 v227, s39, v105
    v_pk_mul_f32 v[194:195], v[194:195], v[226:227]
    v_lshlrev_b32 v228, 16, v106
    v_and_b32 v229, s39, v106
    v_pk_mul_f32 v[196:197], v[196:197], v[228:229]
    v_lshlrev_b32 v230, 16, v107
    v_and_b32 v231, s39, v107
    v_pk_mul_f32 v[198:199], v[198:199], v[230:231]
    v_lshlrev_b32 v232, 16, v108
    v_and_b32 v233, s39, v108
    v_pk_mul_f32 v[200:201], v[200:201], v[232:233]
    v_lshlrev_b32 v234, 16, v109
    v_and_b32 v235, s39, v109
    v_pk_mul_f32 v[202:203], v[202:203], v[234:235]
    v_lshlrev_b32 v236, 16, v110
    v_and_b32 v237, s39, v110
    v_pk_mul_f32 v[204:205], v[204:205], v[236:237]
    v_lshlrev_b32 v238, 16, v111
    v_and_b32 v239, s39, v111
    v_pk_mul_f32 v[206:207], v[206:207], v[238:239]
    s_mov_b32 exec_hi, 0xff
.p2align 3
    v_cvt_pk_bf16_f32 v64, v204, v200
    v_cvt_pk_bf16_f32 v65, v196, v192
    v_cvt_pk_bf16_f32 v66, v188, v184
    v_cvt_pk_bf16_f32 v67, v180, v176
    ds_write_b128 v17, v[64:67] offset:0
    v_cvt_pk_bf16_f32 v68, v205, v201
    v_cvt_pk_bf16_f32 v69, v197, v193
    v_cvt_pk_bf16_f32 v70, v189, v185
    v_cvt_pk_bf16_f32 v71, v181, v177
    ds_write_b128 v17, v[68:71] offset:144
    v_cvt_pk_bf16_f32 v72, v206, v202
    v_cvt_pk_bf16_f32 v73, v198, v194
    v_cvt_pk_bf16_f32 v74, v190, v186
    v_cvt_pk_bf16_f32 v75, v182, v178
    ds_write_b128 v17, v[72:75] offset:288
    v_cvt_pk_bf16_f32 v76, v207, v203
    v_cvt_pk_bf16_f32 v77, v199, v195
    v_cvt_pk_bf16_f32 v78, v191, v187
    v_cvt_pk_bf16_f32 v79, v183, v179
    ds_write_b128 v17, v[76:79] offset:432
    s_mov_b64 exec, -1
    s_waitcnt lgkmcnt(0)
    s_barrier
    ds_read_b128 v[80:83], v18 offset:0
    ds_read_b128 v[84:87], v18 offset:4608
    ds_read_b128 v[88:91], v18 offset:9216
    s_waitcnt lgkmcnt(2)
    buffer_store_dwordx4 v[80:83], v19, s[8:11], s22 offen sc1
    s_add_u32 s22, s22, 131072
    s_waitcnt lgkmcnt(1)
    buffer_store_dwordx4 v[84:87], v19, s[8:11], s22 offen sc1
    s_add_u32 s22, s22, 131072
    s_waitcnt lgkmcnt(0)
    buffer_store_dwordx4 v[88:91], v22, s[8:11], s22 offen sc1
    s_mov_b32 m0, s27
    s_nop 0
    buffer_load_dwordx4 v2, s[32:35], s25 offen offset:0 lds
    buffer_load_dwordx4 v2, s[32:35], s25 offen offset:1024 lds
    buffer_load_dwordx4 v2, s[32:35], s25 offen offset:2048 lds
    buffer_load_dwordx4 v2, s[32:35], s25 offen offset:3072 lds
    s_waitcnt vmcnt(10)
    v_readfirstlane_b32 s96, v30
    s_nop 0
    s_cmp_lg_u32 s96, 0
    s_cbranch_scc1 L_non_1001
    s_mov_b32 s22, 262144
L_non_1001_l:
    global_load_dword v30, v24, s[44:45] sc1
    s_waitcnt vmcnt(0)
    v_readfirstlane_b32 s96, v30
    s_nop 0
    s_cmp_lg_u32 s96, 0
    s_cbranch_scc1 L_non_1001
    s_sub_u32 s22, s22, 1
    s_cbranch_scc0 L_non_1001_l
L_non_1001:
    s_lshl_b32 s22, s101, 5
    s_add_u32 s22, s22, s100
    s_lshl_b32 s22, s22, 4
    s_add_u32 s22, s22, 16689152
    v_mov_b32 v9, s96
    s_lshr_b32 s44, s21, 3
    s_lshl_b32 s45, s20, 2
    s_add_u32 s44, s44, s45
    s_and_b32 s45, s21, 7
    s_mul_i32 s46, s45, 245760
    s_mul_i32 s47, s3, 61440
    s_add_u32 s46, s46, s47
    s_add_u32 s46, s46, 14172160
    v_add_u32 v0, 4096, v2
    s_mov_b32 s101, s97
    s_lshr_b32 s23, s21, 3
    s_add_u32 s23, s23, 0
    s_and_b32 s23, s23, 3
    s_mul_i32 s97, s23, 5120
    s_lshr_b32 s23, s21, 3
    s_add_u32 s23, s23, 1
    s_and_b32 s23, s23, 3
    s_mul_i32 s98, s23, 5120
    s_lshr_b32 s23, s21, 3
    s_add_u32 s23, s23, 2
    s_and_b32 s23, s23, 3
    s_mul_i32 s99, s23, 5120
    s_lshr_b32 s23, s21, 3
    s_add_u32 s23, s23, 3
    s_and_b32 s23, s23, 3
    s_mul_i32 s100, s23, 5120
    s_lshl_b32 s24, s20, 2
    s_add_u32 s24, s24, s3
    v_lshlrev_b32 v6, 4, v4
    v_lshl_add_u32 v5, v3, 10, v6
    v_lshl_add_u32 v6, v3, 11, v6
    v_bfe_u32 v10, v1, 2, 2
    v_lshl_add_u32 v10, v3, 3, v10
    v_mul_u32_u24 v10, 96, v10
    v_and_b32 v11, 3, v1
    v_lshl_add_u32 v10, v11, 3, v10
    v_bfe_u32 v11, v1, 4, 1
    v_mul_u32_u24 v11, 61440, v11
    v_add_u32 v10, v10, v11
    v_lshlrev_b32 v11, 2, v4
    s_lshr_b32 s38, s21, 1
    s_xor_b32 s38, s38, s21
    s_and_b32 s38, s38, 1
    s_lshl_b32 s23, s20, 9
    s_add_u32 s23, s23, 16689152
    v_lshlrev_b32 v15, 4, v4
    s_waitcnt vmcnt(4)
    s_barrier
    s_cmp_lg_u32 s3, 0
    s_cbranch_scc1 L_noflag
    s_mov_b64 exec, 1
    buffer_store_dword v9, v24, s[8:11], s22 offen sc1
    s_mov_b64 exec, -1
L_noflag:
    buffer_load_dword v16, v15, s[8:11], s23 offen sc1
    s_getreg_b32 s30, hwreg(HW_REG_XCC_ID)
    s_lshl_b32 s22, s20, 11
    s_and_b32 s30, s30, 15
    s_add_u32 s22, s22, 16670720
    s_add_u32 s30, s30, s96
    s_lshl_b32 s31, s21, 6
    s_lshl_b32 s28, s3, 2
    s_add_u32 s31, s31, s28
    v_mov_b32 v8, s31
    v_mov_b32 v17, s30
    s_cmp_lt_u32 s101, 12
    s_cbranch_scc1 L_idle
    s_mov_b32 s37, s30
    s_lshl_b32 s42, s41, 12
    s_add_u32 s42, s42, 0
    s_add_u32 s4, s4, s25
    s_addc_u32 s5, s5, 0
    s_load_dword s28, s[4:5], 0
    s_lshr_b32 s29, s41, 1
    s_lshl_b32 s29, s29, 2
    s_add_u32 s6, s6, s29
    s_addc_u32 s7, s7, 0
    s_load_dword s29, s[6:7], 0
    s_mov_b32 s30, s26
    s_mul_i32 s26, s3, 8704
    s_add_u32 s26, s26, 110592
    v_and_b32 v28, 15, v1
    v_lshrrev_b32 v29, 4, v1
    v_mov_b32 v24, 0
    v_mov_b32 v25, 0
    v_mov_b32 v26, 0
    v_mov_b32 v27, 0
    v_lshl_add_u32 v31, v1, 3, s30
    ds_write_b64 v31, v[24:25]
    v_lshrrev_b32 v31, 1, v1
    v_mul_u32_u24 v31, 4288, v31
    v_and_b32 v56, 1, v1
    v_lshl_add_u32 v31, v56, 4, v31
    v_add_u32 v31, s26, v31
    s_mov_b64 exec, 15
    ds_write_b128 v31, v[24:27] offset:4096
    s_mov_b64 exec, -1
    v_and_b32 v31, 7, v28
    v_lshlrev_b32 v31, 2, v31
    v_lshlrev_b32 v56, 4, v29
    v_sub_u32 v31, v56, v31
    v_lshrrev_b32 v57, 3, v28
    v_mul_u32_u24 v57, 4288, v57
    v_add3_u32 v31, v31, v57, s26
    v_add_u32 v59, 28, v31
    v_add_u32 v58, 1052, v31
    v_add_u32 v57, 2076, v31
    v_add_u32 v56, 3100, v31
    v_lshlrev_b32 v20, 5, v28
    v_lshl_add_u32 v20, v29, 4, v20
    v_add_u32 v20, s30, v20
    s_lshl_b32 s43, s3, 6
    s_add_u32 s43, s43, s26
    v_lshlrev_b32 v21, 11, v3
    v_lshl_add_u32 v21, v28, 4, v21
    v_and_b32 v22, 1, v29
    v_lshl_add_u32 v21, v22, 3, v21
    v_add_u32 v21, s43, v21
    v_lshrrev_b32 v22, 2, v28
    v_mul_u32_u24 v22, 8768, v22
    v_and_b32 v23, 3, v28
    v_lshl_add_u32 v22, v23, 3, v22
    v_lshl_add_u32 v22, v29, 5, v22
    s_lshl_b32 s43, s3, 7
    s_add_u32 s43, s43, 110592
    v_add_u32 v22, s43, v22
    v_mul_u32_u24 v23, 81920, v3
    v_lshl_add_u32 v23, v4, 4, v23
    s_mul_i32 s43, s3, 163840
    s_lshl_b32 s25, s40, 9
    s_add_u32 s43, s43, s25
    s_waitcnt lgkmcnt(0)
    s_lshl_b32 s28, s28, 16
    s_and_b32 s25, s29, 0xffff0000
    s_lshl_b32 s29, s29, 16
    s_bitcmp1_b32 s41, 0
    s_cselect_b32 s29, s25, s29
    v_mov_b32 v24, s28
    v_add_f32 v24, s29, v24
    v_cvt_pk_bf16_f32 v24, v24, v24
    v_mov_b32 v25, s27
    s_waitcnt vmcnt(0)
    v_cmp_ne_u32 vcc, s96, v16
    s_nop 0
    s_mov_b64 s[34:35], vcc
    s_cmp_eq_u64 s[34:35], 0
    s_cbranch_scc0 L_cf_1002
L_cb_1003:
    buffer_load_dwordx4 v[64:67], v2, s[8:11], s42 offen offset:0 sc1
    buffer_load_dword v68, v2, s[8:11], s42 offen offset:16 sc1
    buffer_load_dwordx4 v[72:75], v2, s[8:11], s42 offen offset:1024 sc1
    buffer_load_dword v76, v2, s[8:11], s42 offen offset:1040 sc1
    buffer_load_dwordx4 v[80:83], v2, s[8:11], s42 offen offset:2048 sc1
    buffer_load_dword v84, v2, s[8:11], s42 offen offset:2064 sc1
    buffer_load_dwordx4 v[88:91], v2, s[8:11], s42 offen offset:3072 sc1
    buffer_load_dword v92, v2, s[8:11], s42 offen offset:3088 sc1
    s_mov_b64 exec, 1
    buffer_store_dword v17, v8, s[8:11], s22 offen sc1
    s_mov_b64 exec, -1
    s_sub_u32 s47, 1, s38
    s_mul_i32 s33, s47, 196608
    s_add_u32 s33, s33, s0
    s_mul_i32 s47, s47, 6144
    s_add_u32 s47, s47, s1
    s_add_u32 m0, s47, 0
    s_nop 0
    buffer_load_dwordx4 v12, s[16:19], s33 offen lds
    s_add_u32 m0, s47, 1024
    s_nop 0
    buffer_load_dwordx4 v13, s[16:19], s33 offen lds
    s_add_u32 m0, s47, 2048
    s_nop 0
    buffer_load_dwordx4 v14, s[16:19], s33 offen lds
    s_lshl_b32 s42, s3, 10
    s_add_u32 s42, s42, 2621440
    v_mov_b32 v16, v56
    v_mov_b32 v17, v57
    v_mov_b32 v18, v58
    v_mov_b32 v19, v59
    s_waitcnt vmcnt(4)
    v_writelane_b32 v92, 0, 63
    v_add_u32 v30, s26, v2
.p2align 3
    ds_write_b128 v30, v[64:67] offset:4288
    v_alignbit_b32 v96, v65, v64, 16
    v_alignbit_b32 v97, v66, v65, 16
    v_alignbit_b32 v98, v67, v66, 16
    v_alignbit_b32 v99, v68, v67, 16
    ds_write_b128 v30, v[96:99] offset:0
    ds_write_b128 v30, v[72:75] offset:5312
    v_alignbit_b32 v100, v73, v72, 16
    v_alignbit_b32 v101, v74, v73, 16
    v_alignbit_b32 v102, v75, v74, 16
    v_alignbit_b32 v103, v76, v75, 16
    ds_write_b128 v30, v[100:103] offset:1024
    ds_write_b128 v30, v[80:83] offset:6336
    v_alignbit_b32 v104, v81, v80, 16
    v_alignbit_b32 v105, v82, v81, 16
    v_alignbit_b32 v106, v83, v82, 16
    v_alignbit_b32 v107, v84, v83, 16
    ds_write_b128 v30, v[104:107] offset:2048
    ds_write_b128 v30, v[88:91] offset:7360
    v_alignbit_b32 v108, v89, v88, 16
    v_alignbit_b32 v109, v90, v89, 16
    v_alignbit_b32 v110, v91, v90, 16
    v_alignbit_b32 v111, v92, v91, 16
    ds_write_b128 v30, v[108:111] offset:3072
    s_mov_b64 exec, 1
    ds_write_b16 v25, v24
    s_mov_b64 exec, -1
.p2align 3
    ds_read2_b32 v[64:65], v16 offset0:240 offset1:241
    ds_read2_b32 v[66:67], v16 offset0:242 offset1:243
    ds_read_b128 v[128:131], v20 offset:480
    ds_read2_b32 v[68:69], v16 offset0:112 offset1:113
    ds_read2_b32 v[70:71], v16 offset0:114 offset1:115
    ds_read_b128 v[132:135], v20 offset:992
    ds_read2_b32 v[72:73], v17 offset0:240 offset1:241
    ds_read2_b32 v[74:75], v17 offset0:242 offset1:243
    ds_read_b128 v[136:139], v20 offset:1504
    ds_read2_b32 v[76:77], v17 offset0:112 offset1:113
    s_waitcnt lgkmcnt(3)
.p2align 3
    ds_read2_b32 v[78:79], v17 offset0:114 offset1:115
    ds_read_b128 v[140:143], v20 offset:2016
    ds_read2_b32 v[80:81], v18 offset0:240 offset1:241
    ds_read2_b32 v[82:83], v18 offset0:242 offset1:243
    ds_read_b128 v[144:147], v20 offset:2528
    ds_read2_b32 v[84:85], v18 offset0:112 offset1:113
    ds_read2_b32 v[86:87], v18 offset0:114 offset1:115
    ds_read_b128 v[148:151], v20 offset:3040
    ds_read2_b32 v[88:89], v19 offset0:240 offset1:241
    ds_read2_b32 v[90:91], v19 offset0:242 offset1:243
    s_waitcnt lgkmcnt(3)
    ds_read_b128 v[152:155], v20 offset:3552
    ds_read2_b32 v[92:93], v19 offset0:112 offset1:113
    ds_read2_b32 v[94:95], v19 offset0:114 offset1:115
    ds_read_b128 v[156:159], v20 offset:4064
    s_mov_b32 s23, 16689152
    s_mov_b32 s31, 16693248
    s_waitcnt lgkmcnt(0)
    v_mfma_f32_16x16x32_bf16 v[32:35], v[64:67], v[128:131], 0
    ds_read2_b32 v[96:97], v16 offset0:224 offset1:225
    v_mfma_f32_16x16x32_bf16 v[36:39], v[64:67], v[132:135], 0
    ds_read2_b32 v[98:99], v16 offset0:226 offset1:227
    v_mfma_f32_16x16x32_bf16 v[40:43], v[64:67], v[136:139], 0
    ds_read_b128 v[160:163], v20 offset:416
    v_mfma_f32_16x16x32_bf16 v[44:47], v[64:67], v[140:143], 0
    ds_read2_b32 v[100:101], v16 offset0:96 offset1:97
    v_mfma_f32_16x16x32_bf16 v[48:51], v[64:67], v[144:147], 0
    ds_read2_b32 v[102:103], v16 offset0:98 offset1:99
    v_mfma_f32_16x16x32_bf16 v[52:55], v[64:67], v[148:151], 0
    ds_read_b128 v[164:167], v20 offset:928
    v_mfma_f32_16x16x32_bf16 v[56:59], v[64:67], v[152:155], 0
    ds_read2_b32 v[104:105], v17 offset0:224 offset1:225
    v_mfma_f32_16x16x32_bf16 v[60:63], v[64:67], v[156:159], 0
    ds_read2_b32 v[106:107], v17 offset0:226 offset1:227
    v_mfma_f32_16x16x32_bf16 v[36:39], v[68:71], v[128:131], v[36:39]
    ds_read_b128 v[168:171], v20 offset:1440
    v_mfma_f32_16x16x32_bf16 v[40:43], v[68:71], v[132:135], v[40:43]
    s_sub_u32 s47, 2, s38
    s_mul_i32 s33, s47, 196608
    s_add_u32 s33, s33, s0
    s_mul_i32 s47, s47, 6144
    s_add_u32 s47, s47, s1
    s_add_u32 m0, s47, 0
    s_nop 0
    buffer_load_dwordx4 v12, s[16:19], s33 offen lds
    v_mfma_f32_16x16x32_bf16 v[44:47], v[68:71], v[136:139], v[44:47]
    ds_read2_b32 v[108:109], v17 offset0:96 offset1:97
    v_mfma_f32_16x16x32_bf16 v[48:51], v[68:71], v[140:143], v[48:51]
    ds_read2_b32 v[110:111], v17 offset0:98 offset1:99
    v_mfma_f32_16x16x32_bf16 v[52:55], v[68:71], v[144:147], v[52:55]
    ds_read_b128 v[172:175], v20 offset:1952
    v_mfma_f32_16x16x32_bf16 v[56:59], v[68:71], v[148:151], v[56:59]
    ds_read2_b32 v[112:113], v18 offset0:224 offset1:225
    v_mfma_f32_16x16x32_bf16 v[60:63], v[68:71], v[152:155], v[60:63]
    ds_read2_b32 v[114:115], v18 offset0:226 offset1:227
    v_mfma_f32_16x16x32_bf16 v[40:43], v[72:75], v[128:131], v[40:43]
    ds_read_b128 v[176:179], v20 offset:2464
    v_mfma_f32_16x16x32_bf16 v[44:47], v[72:75], v[132:135], v[44:47]
    ds_read2_b32 v[116:117], v18 offset0:96 offset1:97
    v_mfma_f32_16x16x32_bf16 v[48:51], v[72:75], v[136:139], v[48:51]
    ds_read2_b32 v[118:119], v18 offset0:98 offset1:99
    v_mfma_f32_16x16x32_bf16 v[52:55], v[72:75], v[140:143], v[52:55]
    ds_read_b128 v[180:183], v20 offset:2976
    v_mfma_f32_16x16x32_bf16 v[56:59], v[72:75], v[144:147], v[56:59]
    ds_read2_b32 v[120:121], v19 offset0:224 offset1:225
    v_mfma_f32_16x16x32_bf16 v[60:63], v[72:75], v[148:151], v[60:63]
    ds_read2_b32 v[122:123], v19 offset0:226 offset1:227
    v_mfma_f32_16x16x32_bf16 v[44:47], v[76:79], v[128:131], v[44:47]
    ds_read_b128 v[184:187], v20 offset:3488
    v_mfma_f32_16x16x32_bf16 v[48:51], v[76:79], v[132:135], v[48:51]
    ds_read2_b32 v[124:125], v19 offset0:96 offset1:97
    v_mfma_f32_16x16x32_bf16 v[52:55], v[76:79], v[136:139], v[52:55]
    ds_read2_b32 v[126:127], v19 offset0:98 offset1:99
    v_mfma_f32_16x16x32_bf16 v[56:59], v[76:79], v[140:143], v[56:59]
    ds_read_b128 v[188:191], v20 offset:4000
    v_mfma_f32_16x16x32_bf16 v[60:63], v[76:79], v[144:147], v[60:63]
    v_mfma_f32_16x16x32_bf16 v[48:51], v[80:83], v[128:131], v[48:51]
    v_mfma_f32_16x16x32_bf16 v[52:55], v[80:83], v[132:135], v[52:55]
    s_add_u32 m0, s47, 1024
    s_nop 0
    buffer_load_dwordx4 v13, s[16:19], s33 offen lds
    v_mfma_f32_16x16x32_bf16 v[56:59], v[80:83], v[136:139], v[56:59]
    v_mfma_f32_16x16x32_bf16 v[60:63], v[80:83], v[140:143], v[60:63]
    v_mfma_f32_16x16x32_bf16 v[52:55], v[84:87], v[128:131], v[52:55]
    v_mfma_f32_16x16x32_bf16 v[56:59], v[84:87], v[132:135], v[56:59]
    v_mfma_f32_16x16x32_bf16 v[60:63], v[84:87], v[136:139], v[60:63]
    v_mfma_f32_16x16x32_bf16 v[56:59], v[88:91], v[128:131], v[56:59]
    v_mfma_f32_16x16x32_bf16 v[60:63], v[88:91], v[132:135], v[60:63]
    v_mfma_f32_16x16x32_bf16 v[60:63], v[92:95], v[128:131], v[60:63]
    s_waitcnt lgkmcnt(0)
    v_mfma_f32_16x16x32_bf16 v[32:35], v[96:99], v[160:163], v[32:35]
    ds_read2_b32 v[64:65], v16 offset0:208 offset1:209
    v_mfma_f32_16x16x32_bf16 v[36:39], v[96:99], v[164:167], v[36:39]
    ds_read2_b32 v[66:67], v16 offset0:210 offset1:211
    v_mfma_f32_16x16x32_bf16 v[40:43], v[96:99], v[168:171], v[40:43]
    ds_read_b128 v[128:131], v20 offset:352
    v_mfma_f32_16x16x32_bf16 v[44:47], v[96:99], v[172:175], v[44:47]
    buffer_load_dword v224, v2, s[8:11], s23 offen offset:0 sc1
    v_mfma_f32_16x16x32_bf16 v[48:51], v[96:99], v[176:179], v[48:51]
    ds_read2_b32 v[68:69], v16 offset0:80 offset1:81
    v_mfma_f32_16x16x32_bf16 v[52:55], v[96:99], v[180:183], v[52:55]
    ds_read2_b32 v[70:71], v16 offset0:82 offset1:83
    v_mfma_f32_16x16x32_bf16 v[56:59], v[96:99], v[184:187], v[56:59]
    ds_read_b128 v[132:135], v20 offset:864
    v_mfma_f32_16x16x32_bf16 v[60:63], v[96:99], v[188:191], v[60:63]
    ds_read2_b32 v[72:73], v17 offset0:208 offset1:209
    v_mfma_f32_16x16x32_bf16 v[36:39], v[100:103], v[160:163], v[36:39]
    ds_read2_b32 v[74:75], v17 offset0:210 offset1:211
    v_mfma_f32_16x16x32_bf16 v[40:43], v[100:103], v[164:167], v[40:43]
    ds_read_b128 v[136:139], v20 offset:1376
    v_mfma_f32_16x16x32_bf16 v[44:47], v[100:103], v[168:171], v[44:47]
    buffer_load_dword v225, v2, s[8:11], s23 offen offset:1024 sc1
    v_mfma_f32_16x16x32_bf16 v[48:51], v[100:103], v[172:175], v[48:51]
    ds_read2_b32 v[76:77], v17 offset0:80 offset1:81
    v_mfma_f32_16x16x32_bf16 v[52:55], v[100:103], v[176:179], v[52:55]
    ds_read2_b32 v[78:79], v17 offset0:82 offset1:83
    v_mfma_f32_16x16x32_bf16 v[56:59], v[100:103], v[180:183], v[56:59]
    ds_read_b128 v[140:143], v20 offset:1888
    v_mfma_f32_16x16x32_bf16 v[60:63], v[100:103], v[184:187], v[60:63]
    ds_read2_b32 v[80:81], v18 offset0:208 offset1:209
    v_mfma_f32_16x16x32_bf16 v[40:43], v[104:107], v[160:163], v[40:43]
    ds_read2_b32 v[82:83], v18 offset0:210 offset1:211
    v_mfma_f32_16x16x32_bf16 v[44:47], v[104:107], v[164:167], v[44:47]
    ds_read_b128 v[144:147], v20 offset:2400
    v_mfma_f32_16x16x32_bf16 v[48:51], v[104:107], v[168:171], v[48:51]
    ds_read2_b32 v[84:85], v18 offset0:80 offset1:81
    v_mfma_f32_16x16x32_bf16 v[52:55], v[104:107], v[172:175], v[52:55]
    buffer_load_dword v226, v2, s[8:11], s23 offen offset:2048 sc1
    v_mfma_f32_16x16x32_bf16 v[56:59], v[104:107], v[176:179], v[56:59]
    ds_read2_b32 v[86:87], v18 offset0:82 offset1:83
    v_mfma_f32_16x16x32_bf16 v[60:63], v[104:107], v[180:183], v[60:63]
    ds_read_b128 v[148:151], v20 offset:2912
    v_mfma_f32_16x16x32_bf16 v[44:47], v[108:111], v[160:163], v[44:47]
    ds_read2_b32 v[88:89], v19 offset0:208 offset1:209
    v_mfma_f32_16x16x32_bf16 v[48:51], v[108:111], v[164:167], v[48:51]
    ds_read2_b32 v[90:91], v19 offset0:210 offset1:211
    v_mfma_f32_16x16x32_bf16 v[52:55], v[108:111], v[168:171], v[52:55]
    ds_read_b128 v[152:155], v20 offset:3424
    v_mfma_f32_16x16x32_bf16 v[56:59], v[108:111], v[172:175], v[56:59]
    ds_read2_b32 v[92:93], v19 offset0:80 offset1:81
    v_mfma_f32_16x16x32_bf16 v[60:63], v[108:111], v[176:179], v[60:63]
    buffer_load_dword v227, v2, s[8:11], s23 offen offset:3072 sc1
    v_mfma_f32_16x16x32_bf16 v[48:51], v[112:115], v[160:163], v[48:51]
    ds_read2_b32 v[94:95], v19 offset0:82 offset1:83
    v_mfma_f32_16x16x32_bf16 v[52:55], v[112:115], v[164:167], v[52:55]
    ds_read_b128 v[156:159], v20 offset:3936
    v_mfma_f32_16x16x32_bf16 v[56:59], v[112:115], v[168:171], v[56:59]
    v_mfma_f32_16x16x32_bf16 v[60:63], v[112:115], v[172:175], v[60:63]
    v_mfma_f32_16x16x32_bf16 v[52:55], v[116:119], v[160:163], v[52:55]
    v_mfma_f32_16x16x32_bf16 v[56:59], v[116:119], v[164:167], v[56:59]
    v_mfma_f32_16x16x32_bf16 v[60:63], v[116:119], v[168:171], v[60:63]
    s_add_u32 m0, s47, 2048
    s_nop 0
    buffer_load_dwordx4 v14, s[16:19], s33 offen lds
    v_mfma_f32_16x16x32_bf16 v[56:59], v[120:123], v[160:163], v[56:59]
    v_mfma_f32_16x16x32_bf16 v[60:63], v[120:123], v[164:167], v[60:63]
    v_mfma_f32_16x16x32_bf16 v[60:63], v[124:127], v[160:163], v[60:63]
    s_waitcnt lgkmcnt(0)
    v_mfma_f32_16x16x32_bf16 v[32:35], v[64:67], v[128:131], v[32:35]
    ds_read2_b32 v[96:97], v16 offset0:192 offset1:193
    v_mfma_f32_16x16x32_bf16 v[36:39], v[64:67], v[132:135], v[36:39]
    ds_read2_b32 v[98:99], v16 offset0:194 offset1:195
    v_mfma_f32_16x16x32_bf16 v[40:43], v[64:67], v[136:139], v[40:43]
    ds_read_b128 v[160:163], v20 offset:288
    v_mfma_f32_16x16x32_bf16 v[44:47], v[64:67], v[140:143], v[44:47]
    s_sub_u32 s47, 3, s38
    s_mul_i32 s33, s47, 196608
    s_add_u32 s33, s33, s0
    s_mul_i32 s47, s47, 6144
    s_add_u32 s47, s47, s1
    s_add_u32 m0, s47, 0
    s_nop 0
    buffer_load_dwordx4 v12, s[16:19], s33 offen lds
    v_mfma_f32_16x16x32_bf16 v[48:51], v[64:67], v[144:147], v[48:51]
    ds_read2_b32 v[100:101], v16 offset0:64 offset1:65
    v_mfma_f32_16x16x32_bf16 v[52:55], v[64:67], v[148:151], v[52:55]
    ds_read2_b32 v[102:103], v16 offset0:66 offset1:67
    v_mfma_f32_16x16x32_bf16 v[56:59], v[64:67], v[152:155], v[56:59]
    ds_read_b128 v[164:167], v20 offset:800
    v_mfma_f32_16x16x32_bf16 v[60:63], v[64:67], v[156:159], v[60:63]
    ds_read2_b32 v[104:105], v17 offset0:192 offset1:193
    v_mfma_f32_16x16x32_bf16 v[36:39], v[68:71], v[128:131], v[36:39]
    ds_read2_b32 v[106:107], v17 offset0:194 offset1:195
    v_mfma_f32_16x16x32_bf16 v[40:43], v[68:71], v[132:135], v[40:43]
    ds_read_b128 v[168:171], v20 offset:1312
    v_mfma_f32_16x16x32_bf16 v[44:47], v[68:71], v[136:139], v[44:47]
    s_add_u32 m0, s47, 1024
    s_nop 0
    buffer_load_dwordx4 v13, s[16:19], s33 offen lds
    v_mfma_f32_16x16x32_bf16 v[48:51], v[68:71], v[140:143], v[48:51]
    ds_read2_b32 v[108:109], v17 offset0:64 offset1:65
    v_mfma_f32_16x16x32_bf16 v[52:55], v[68:71], v[144:147], v[52:55]
    ds_read2_b32 v[110:111], v17 offset0:66 offset1:67
    v_mfma_f32_16x16x32_bf16 v[56:59], v[68:71], v[148:151], v[56:59]
    ds_read_b128 v[172:175], v20 offset:1824
    v_mfma_f32_16x16x32_bf16 v[60:63], v[68:71], v[152:155], v[60:63]
    ds_read2_b32 v[112:113], v18 offset0:192 offset1:193
    v_mfma_f32_16x16x32_bf16 v[40:43], v[72:75], v[128:131], v[40:43]
    ds_read2_b32 v[114:115], v18 offset0:194 offset1:195
    v_mfma_f32_16x16x32_bf16 v[44:47], v[72:75], v[132:135], v[44:47]
    ds_read_b128 v[176:179], v20 offset:2336
    v_mfma_f32_16x16x32_bf16 v[48:51], v[72:75], v[136:139], v[48:51]
    ds_read2_b32 v[116:117], v18 offset0:64 offset1:65
    v_mfma_f32_16x16x32_bf16 v[52:55], v[72:75], v[140:143], v[52:55]
    s_waitcnt vmcnt(3)
    v_cmp_ne_u32 vcc, s96, v224
    s_nop 0
    s_mov_b64 s[34:35], vcc
    v_cmp_ne_u32 vcc, s96, v225
    s_nop 0
    s_or_b64 s[34:35], s[34:35], vcc
    v_cmp_ne_u32 vcc, s96, v226
    s_nop 0
    s_or_b64 s[34:35], s[34:35], vcc
    v_cmp_ne_u32 vcc, s96, v227
    s_nop 0
    s_or_b64 s[34:35], s[34:35], vcc
    s_cmp_eq_u64 s[34:35], 0
    s_cbranch_scc0 L_cf_1004
L_cb_1005:
    v_mfma_f32_16x16x32_bf16 v[56:59], v[72:75], v[144:147], v[56:59]
    ds_read2_b32 v[118:119], v18 offset0:66 offset1:67
    v_mfma_f32_16x16x32_bf16 v[60:63], v[72:75], v[148:151], v[60:63]
    ds_read_b128 v[180:183], v20 offset:2848
    v_mfma_f32_16x16x32_bf16 v[44:47], v[76:79], v[128:131], v[44:47]
    ds_read2_b32 v[120:121], v19 offset0:192 offset1:193
    v_mfma_f32_16x16x32_bf16 v[48:51], v[76:79], v[132:135], v[48:51]
    ds_read2_b32 v[122:123], v19 offset0:194 offset1:195
    v_mfma_f32_16x16x32_bf16 v[52:55], v[76:79], v[136:139], v[52:55]
    ds_read_b128 v[184:187], v20 offset:3360
    v_mfma_f32_16x16x32_bf16 v[56:59], v[76:79], v[140:143], v[56:59]
    ds_read2_b32 v[124:125], v19 offset0:64 offset1:65
    v_mfma_f32_16x16x32_bf16 v[60:63], v[76:79], v[144:147], v[60:63]
    s_add_u32 s25, s43, 2637824
    buffer_load_dwordx4 v[192:195], v23, s[8:11], s25 offen sc1
    v_mfma_f32_16x16x32_bf16 v[48:51], v[80:83], v[128:131], v[48:51]
    ds_read2_b32 v[126:127], v19 offset0:66 offset1:67
    v_mfma_f32_16x16x32_bf16 v[52:55], v[80:83], v[132:135], v[52:55]
    ds_read_b128 v[188:191], v20 offset:3872
    v_mfma_f32_16x16x32_bf16 v[56:59], v[80:83], v[136:139], v[56:59]
    v_mfma_f32_16x16x32_bf16 v[60:63], v[80:83], v[140:143], v[60:63]
    v_mfma_f32_16x16x32_bf16 v[52:55], v[84:87], v[128:131], v[52:55]
    v_mfma_f32_16x16x32_bf16 v[56:59], v[84:87], v[132:135], v[56:59]
    v_mfma_f32_16x16x32_bf16 v[60:63], v[84:87], v[136:139], v[60:63]
    s_add_u32 s25, s43, 3293184
    buffer_load_dwordx4 v[196:199], v23, s[8:11], s25 offen sc1
    v_mfma_f32_16x16x32_bf16 v[56:59], v[88:91], v[128:131], v[56:59]
    v_mfma_f32_16x16x32_bf16 v[60:63], v[88:91], v[132:135], v[60:63]
    v_mfma_f32_16x16x32_bf16 v[60:63], v[92:95], v[128:131], v[60:63]
    s_waitcnt lgkmcnt(0)
    v_mfma_f32_16x16x32_bf16 v[32:35], v[96:99], v[160:163], v[32:35]
    ds_read2_b32 v[64:65], v16 offset0:176 offset1:177
    v_mfma_f32_16x16x32_bf16 v[36:39], v[96:99], v[164:167], v[36:39]
    ds_read2_b32 v[66:67], v16 offset0:178 offset1:179
    v_mfma_f32_16x16x32_bf16 v[40:43], v[96:99], v[168:171], v[40:43]
    ds_read_b128 v[128:131], v20 offset:224
    v_mfma_f32_16x16x32_bf16 v[44:47], v[96:99], v[172:175], v[44:47]
    s_add_u32 s25, s43, 3948544
    buffer_load_dwordx4 v[200:203], v23, s[8:11], s25 offen sc1
    v_mfma_f32_16x16x32_bf16 v[48:51], v[96:99], v[176:179], v[48:51]
    ds_read2_b32 v[68:69], v16 offset0:48 offset1:49
    v_mfma_f32_16x16x32_bf16 v[52:55], v[96:99], v[180:183], v[52:55]
    ds_read2_b32 v[70:71], v16 offset0:50 offset1:51
    v_mfma_f32_16x16x32_bf16 v[56:59], v[96:99], v[184:187], v[56:59]
    ds_read_b128 v[132:135], v20 offset:736
    v_mfma_f32_16x16x32_bf16 v[60:63], v[96:99], v[188:191], v[60:63]
    ds_read2_b32 v[72:73], v17 offset0:176 offset1:177
    v_mfma_f32_16x16x32_bf16 v[36:39], v[100:103], v[160:163], v[36:39]
    ds_read2_b32 v[74:75], v17 offset0:178 offset1:179
    v_mfma_f32_16x16x32_bf16 v[40:43], v[100:103], v[164:167], v[40:43]
    ds_read_b128 v[136:139], v20 offset:1248
    v_mfma_f32_16x16x32_bf16 v[44:47], v[100:103], v[168:171], v[44:47]
    s_add_u32 s25, s43, 4603904
    buffer_load_dwordx4 v[204:207], v23, s[8:11], s25 offen sc1
    v_mfma_f32_16x16x32_bf16 v[48:51], v[100:103], v[172:175], v[48:51]
    ds_read2_b32 v[76:77], v17 offset0:48 offset1:49
    v_mfma_f32_16x16x32_bf16 v[52:55], v[100:103], v[176:179], v[52:55]
    ds_read2_b32 v[78:79], v17 offset0:50 offset1:51
    v_mfma_f32_16x16x32_bf16 v[56:59], v[100:103], v[180:183], v[56:59]
    ds_read_b128 v[140:143], v20 offset:1760
    v_mfma_f32_16x16x32_bf16 v[60:63], v[100:103], v[184:187], v[60:63]
    ds_read2_b32 v[80:81], v18 offset0:176 offset1:177
    v_mfma_f32_16x16x32_bf16 v[40:43], v[104:107], v[160:163], v[40:43]
    ds_read2_b32 v[82:83], v18 offset0:178 offset1:179
    v_mfma_f32_16x16x32_bf16 v[44:47], v[104:107], v[164:167], v[44:47]
    ds_read_b128 v[144:147], v20 offset:2272
    v_mfma_f32_16x16x32_bf16 v[48:51], v[104:107], v[168:171], v[48:51]
    ds_read2_b32 v[84:85], v18 offset0:48 offset1:49
    v_mfma_f32_16x16x32_bf16 v[52:55], v[104:107], v[172:175], v[52:55]
    s_add_u32 s25, s42, 0
    buffer_load_dwordx4 v[208:211], v2, s[8:11], s25 offen sc1
    v_mfma_f32_16x16x32_bf16 v[56:59], v[104:107], v[176:179], v[56:59]
    ds_read2_b32 v[86:87], v18 offset0:50 offset1:51
    v_mfma_f32_16x16x32_bf16 v[60:63], v[104:107], v[180:183], v[60:63]
    ds_read_b128 v[148:151], v20 offset:2784
    v_mfma_f32_16x16x32_bf16 v[44:47], v[108:111], v[160:163], v[44:47]
    ds_read2_b32 v[88:89], v19 offset0:176 offset1:177
    v_mfma_f32_16x16x32_bf16 v[48:51], v[108:111], v[164:167], v[48:51]
    ds_read2_b32 v[90:91], v19 offset0:178 offset1:179
    v_mfma_f32_16x16x32_bf16 v[52:55], v[108:111], v[168:171], v[52:55]
    ds_read_b128 v[152:155], v20 offset:3296
    v_mfma_f32_16x16x32_bf16 v[56:59], v[108:111], v[172:175], v[56:59]
    ds_read2_b32 v[92:93], v19 offset0:48 offset1:49
    v_mfma_f32_16x16x32_bf16 v[60:63], v[108:111], v[176:179], v[60:63]
    s_add_u32 m0, s47, 2048
    s_nop 0
    buffer_load_dwordx4 v14, s[16:19], s33 offen lds
    v_mfma_f32_16x16x32_bf16 v[48:51], v[112:115], v[160:163], v[48:51]
    ds_read2_b32 v[94:95], v19 offset0:50 offset1:51
    v_mfma_f32_16x16x32_bf16 v[52:55], v[112:115], v[164:167], v[52:55]
    ds_read_b128 v[156:159], v20 offset:3808
    v_mfma_f32_16x16x32_bf16 v[56:59], v[112:115], v[168:171], v[56:59]
    v_mfma_f32_16x16x32_bf16 v[60:63], v[112:115], v[172:175], v[60:63]
    v_mfma_f32_16x16x32_bf16 v[52:55], v[116:119], v[160:163], v[52:55]
    v_mfma_f32_16x16x32_bf16 v[56:59], v[116:119], v[164:167], v[56:59]
    v_mfma_f32_16x16x32_bf16 v[60:63], v[116:119], v[168:171], v[60:63]
    s_add_u32 m0, s1, 24576
    s_add_u32 s33, s0, 786432
    buffer_load_dwordx4 v12, s[16:19], s33 offen lds
    v_mfma_f32_16x16x32_bf16 v[56:59], v[120:123], v[160:163], v[56:59]
    v_mfma_f32_16x16x32_bf16 v[60:63], v[120:123], v[164:167], v[60:63]
    v_mfma_f32_16x16x32_bf16 v[60:63], v[124:127], v[160:163], v[60:63]
    s_waitcnt lgkmcnt(0)
    v_mfma_f32_16x16x32_bf16 v[32:35], v[64:67], v[128:131], v[32:35]
    ds_read2_b32 v[96:97], v16 offset0:160 offset1:161
    v_mfma_f32_16x16x32_bf16 v[36:39], v[64:67], v[132:135], v[36:39]
    ds_read2_b32 v[98:99], v16 offset0:162 offset1:163
    v_mfma_f32_16x16x32_bf16 v[40:43], v[64:67], v[136:139], v[40:43]
    ds_read_b128 v[160:163], v20 offset:160
    v_mfma_f32_16x16x32_bf16 v[44:47], v[64:67], v[140:143], v[44:47]
    ds_read2_b32 v[100:101], v16 offset0:32 offset1:33
    v_mfma_f32_16x16x32_bf16 v[48:51], v[64:67], v[144:147], v[48:51]
    s_add_u32 s25, s42, 4096
    buffer_load_dwordx4 v[212:215], v2, s[8:11], s25 offen sc1
    v_mfma_f32_16x16x32_bf16 v[52:55], v[64:67], v[148:151], v[52:55]
    ds_read2_b32 v[102:103], v16 offset0:34 offset1:35
    v_mfma_f32_16x16x32_bf16 v[56:59], v[64:67], v[152:155], v[56:59]
    ds_read_b128 v[164:167], v20 offset:672
    v_mfma_f32_16x16x32_bf16 v[60:63], v[64:67], v[156:159], v[60:63]
    ds_read2_b32 v[104:105], v17 offset0:160 offset1:161
    v_mfma_f32_16x16x32_bf16 v[36:39], v[68:71], v[128:131], v[36:39]
    ds_read2_b32 v[106:107], v17 offset0:162 offset1:163
    v_mfma_f32_16x16x32_bf16 v[40:43], v[68:71], v[132:135], v[40:43]
    ds_read_b128 v[168:171], v20 offset:1184
    v_mfma_f32_16x16x32_bf16 v[44:47], v[68:71], v[136:139], v[44:47]
    ds_read2_b32 v[108:109], v17 offset0:32 offset1:33
    v_mfma_f32_16x16x32_bf16 v[48:51], v[68:71], v[140:143], v[48:51]
    ds_read2_b32 v[110:111], v17 offset0:34 offset1:35
    v_mfma_f32_16x16x32_bf16 v[52:55], v[68:71], v[144:147], v[52:55]
    ds_read_b128 v[172:175], v20 offset:1696
    v_mfma_f32_16x16x32_bf16 v[56:59], v[68:71], v[148:151], v[56:59]
    s_add_u32 s25, s42, 8192
    buffer_load_dwordx4 v[216:219], v2, s[8:11], s25 offen sc1
    v_mfma_f32_16x16x32_bf16 v[60:63], v[68:71], v[152:155], v[60:63]
    ds_read2_b32 v[112:113], v18 offset0:160 offset1:161
    v_mfma_f32_16x16x32_bf16 v[40:43], v[72:75], v[128:131], v[40:43]
    ds_read2_b32 v[114:115], v18 offset0:162 offset1:163
    v_mfma_f32_16x16x32_bf16 v[44:47], v[72:75], v[132:135], v[44:47]
    ds_read_b128 v[176:179], v20 offset:2208
    v_mfma_f32_16x16x32_bf16 v[48:51], v[72:75], v[136:139], v[48:51]
    ds_read2_b32 v[116:117], v18 offset0:32 offset1:33
    v_mfma_f32_16x16x32_bf16 v[52:55], v[72:75], v[140:143], v[52:55]
    ds_read2_b32 v[118:119], v18 offset0:34 offset1:35
    v_mfma_f32_16x16x32_bf16 v[56:59], v[72:75], v[144:147], v[56:59]
    ds_read_b128 v[180:183], v20 offset:2720
    v_mfma_f32_16x16x32_bf16 v[60:63], v[72:75], v[148:151], v[60:63]
    ds_read2_b32 v[120:121], v19 offset0:160 offset1:161
    v_mfma_f32_16x16x32_bf16 v[44:47], v[76:79], v[128:131], v[44:47]
    ds_read2_b32 v[122:123], v19 offset0:162 offset1:163
    v_mfma_f32_16x16x32_bf16 v[48:51], v[76:79], v[132:135], v[48:51]
    s_add_u32 s25, s42, 12288
    buffer_load_dwordx4 v[220:223], v2, s[8:11], s25 offen sc1
    v_mfma_f32_16x16x32_bf16 v[52:55], v[76:79], v[136:139], v[52:55]
    ds_read_b128 v[184:187], v20 offset:3232
    v_mfma_f32_16x16x32_bf16 v[56:59], v[76:79], v[140:143], v[56:59]
    ds_read2_b32 v[124:125], v19 offset0:32 offset1:33
    v_mfma_f32_16x16x32_bf16 v[60:63], v[76:79], v[144:147], v[60:63]
    ds_read2_b32 v[126:127], v19 offset0:34 offset1:35
    v_mfma_f32_16x16x32_bf16 v[48:51], v[80:83], v[128:131], v[48:51]
    ds_read_b128 v[188:191], v20 offset:3744
    v_mfma_f32_16x16x32_bf16 v[52:55], v[80:83], v[132:135], v[52:55]
    v_mfma_f32_16x16x32_bf16 v[56:59], v[80:83], v[136:139], v[56:59]
    v_mfma_f32_16x16x32_bf16 v[60:63], v[80:83], v[140:143], v[60:63]
    v_mfma_f32_16x16x32_bf16 v[52:55], v[84:87], v[128:131], v[52:55]
    v_mfma_f32_16x16x32_bf16 v[56:59], v[84:87], v[132:135], v[56:59]
    s_add_u32 m0, s1, 25600
    s_nop 0
    buffer_load_dwordx4 v13, s[16:19], s33 offen lds
    v_mfma_f32_16x16x32_bf16 v[60:63], v[84:87], v[136:139], v[60:63]
    v_mfma_f32_16x16x32_bf16 v[56:59], v[88:91], v[128:131], v[56:59]
    v_mfma_f32_16x16x32_bf16 v[60:63], v[88:91], v[132:135], v[60:63]
    v_mfma_f32_16x16x32_bf16 v[60:63], v[92:95], v[128:131], v[60:63]
    s_waitcnt lgkmcnt(0)
    v_mfma_f32_16x16x32_bf16 v[32:35], v[96:99], v[160:163], v[32:35]
    ds_read2_b32 v[64:65], v16 offset0:144 offset1:145
    v_mfma_f32_16x16x32_bf16 v[36:39], v[96:99], v[164:167], v[36:39]
    ds_read2_b32 v[66:67], v16 offset0:146 offset1:147
    v_mfma_f32_16x16x32_bf16 v[40:43], v[96:99], v[168:171], v[40:43]
    ds_read_b128 v[128:131], v20 offset:96
    v_mfma_f32_16x16x32_bf16 v[44:47], v[96:99], v[172:175], v[44:47]
    ds_read2_b32 v[68:69], v16 offset0:16 offset1:17
    v_mfma_f32_16x16x32_bf16 v[48:51], v[96:99], v[176:179], v[48:51]
    ds_read2_b32 v[70:71], v16 offset0:18 offset1:19
    v_mfma_f32_16x16x32_bf16 v[52:55], v[96:99], v[180:183], v[52:55]
    ds_read_b128 v[132:135], v20 offset:608
    v_mfma_f32_16x16x32_bf16 v[56:59], v[96:99], v[184:187], v[56:59]
    s_add_u32 m0, s1, 26624
    s_nop 0
    buffer_load_dwordx4 v14, s[16:19], s33 offen lds
    v_mfma_f32_16x16x32_bf16 v[60:63], v[96:99], v[188:191], v[60:63]
    ds_read2_b32 v[72:73], v17 offset0:144 offset1:145
    v_mfma_f32_16x16x32_bf16 v[36:39], v[100:103], v[160:163], v[36:39]
    ds_read2_b32 v[74:75], v17 offset0:146 offset1:147
    v_mfma_f32_16x16x32_bf16 v[40:43], v[100:103], v[164:167], v[40:43]
    ds_read_b128 v[136:139], v20 offset:1120
    v_mfma_f32_16x16x32_bf16 v[44:47], v[100:103], v[168:171], v[44:47]
    ds_read2_b32 v[76:77], v17 offset0:16 offset1:17
    v_mfma_f32_16x16x32_bf16 v[48:51], v[100:103], v[172:175], v[48:51]
    ds_read2_b32 v[78:79], v17 offset0:18 offset1:19
    v_mfma_f32_16x16x32_bf16 v[52:55], v[100:103], v[176:179], v[52:55]
    ds_read_b128 v[140:143], v20 offset:1632
    v_mfma_f32_16x16x32_bf16 v[56:59], v[100:103], v[180:183], v[56:59]
    ds_read2_b32 v[80:81], v18 offset0:144 offset1:145
    v_mfma_f32_16x16x32_bf16 v[60:63], v[100:103], v[184:187], v[60:63]
    ds_read2_b32 v[82:83], v18 offset0:146 offset1:147
    v_mfma_f32_16x16x32_bf16 v[40:43], v[104:107], v[160:163], v[40:43]
    ds_read_b128 v[144:147], v20 offset:2144
    v_mfma_f32_16x16x32_bf16 v[44:47], v[104:107], v[164:167], v[44:47]
    ds_read2_b32 v[84:85], v18 offset0:16 offset1:17
    v_mfma_f32_16x16x32_bf16 v[48:51], v[104:107], v[168:171], v[48:51]
    ds_read2_b32 v[86:87], v18 offset0:18 offset1:19
    v_mfma_f32_16x16x32_bf16 v[52:55], v[104:107], v[172:175], v[52:55]
    s_add_u32 m0, s1, 30720
    s_add_u32 s33, s0, 983040
    buffer_load_dwordx4 v12, s[16:19], s33 offen lds
    v_mfma_f32_16x16x32_bf16 v[56:59], v[104:107], v[176:179], v[56:59]
    ds_read_b128 v[148:151], v20 offset:2656
    v_mfma_f32_16x16x32_bf16 v[60:63], v[104:107], v[180:183], v[60:63]
    ds_read2_b32 v[88:89], v19 offset0:144 offset1:145
    v_mfma_f32_16x16x32_bf16 v[44:47], v[108:111], v[160:163], v[44:47]
    ds_read2_b32 v[90:91], v19 offset0:146 offset1:147
    v_mfma_f32_16x16x32_bf16 v[48:51], v[108:111], v[164:167], v[48:51]
    ds_read_b128 v[152:155], v20 offset:3168
    v_mfma_f32_16x16x32_bf16 v[52:55], v[108:111], v[168:171], v[52:55]
    ds_read2_b32 v[92:93], v19 offset0:16 offset1:17
    v_mfma_f32_16x16x32_bf16 v[56:59], v[108:111], v[172:175], v[56:59]
    ds_read2_b32 v[94:95], v19 offset0:18 offset1:19
    v_mfma_f32_16x16x32_bf16 v[60:63], v[108:111], v[176:179], v[60:63]
    ds_read_b128 v[156:159], v20 offset:3680
    v_mfma_f32_16x16x32_bf16 v[48:51], v[112:115], v[160:163], v[48:51]
    v_mfma_f32_16x16x32_bf16 v[52:55], v[112:115], v[164:167], v[52:55]
    v_mfma_f32_16x16x32_bf16 v[56:59], v[112:115], v[168:171], v[56:59]
    v_mfma_f32_16x16x32_bf16 v[60:63], v[112:115], v[172:175], v[60:63]
    v_mfma_f32_16x16x32_bf16 v[52:55], v[116:119], v[160:163], v[52:55]
    s_add_u32 m0, s1, 31744
    s_nop 0
    buffer_load_dwordx4 v13, s[16:19], s33 offen lds
    v_mfma_f32_16x16x32_bf16 v[56:59], v[116:119], v[164:167], v[56:59]
    v_mfma_f32_16x16x32_bf16 v[60:63], v[116:119], v[168:171], v[60:63]
    v_mfma_f32_16x16x32_bf16 v[56:59], v[120:123], v[160:163], v[56:59]
    v_mfma_f32_16x16x32_bf16 v[60:63], v[120:123], v[164:167], v[60:63]
    v_mfma_f32_16x16x32_bf16 v[60:63], v[124:127], v[160:163], v[60:63]
    s_waitcnt lgkmcnt(0)
    v_mfma_f32_16x16x32_bf16 v[32:35], v[64:67], v[128:131], v[32:35]
    ds_read2_b32 v[96:97], v16 offset0:128 offset1:129
    v_mfma_f32_16x16x32_bf16 v[36:39], v[64:67], v[132:135], v[36:39]
    ds_read2_b32 v[98:99], v16 offset0:130 offset1:131
    v_mfma_f32_16x16x32_bf16 v[40:43], v[64:67], v[136:139], v[40:43]
    ds_read_b128 v[160:163], v20 offset:32
    v_mfma_f32_16x16x32_bf16 v[44:47], v[64:67], v[140:143], v[44:47]
    ds_read2_b32 v[100:101], v16 offset0:0 offset1:1
    v_mfma_f32_16x16x32_bf16 v[48:51], v[64:67], v[144:147], v[48:51]
    ds_read2_b32 v[102:103], v16 offset0:2 offset1:3
    v_mfma_f32_16x16x32_bf16 v[52:55], v[64:67], v[148:151], v[52:55]
    ds_read_b128 v[164:167], v20 offset:544
    v_mfma_f32_16x16x32_bf16 v[56:59], v[64:67], v[152:155], v[56:59]
    ds_read2_b32 v[104:105], v17 offset0:128 offset1:129
    v_mfma_f32_16x16x32_bf16 v[60:63], v[64:67], v[156:159], v[60:63]
    ds_read2_b32 v[106:107], v17 offset0:130 offset1:131
    v_mfma_f32_16x16x32_bf16 v[36:39], v[68:71], v[128:131], v[36:39]
    ds_read_b128 v[168:171], v20 offset:1056
    v_mfma_f32_16x16x32_bf16 v[40:43], v[68:71], v[132:135], v[40:43]
    s_add_u32 m0, s1, 32768
    s_nop 0
    buffer_load_dwordx4 v14, s[16:19], s33 offen lds
    v_mfma_f32_16x16x32_bf16 v[44:47], v[68:71], v[136:139], v[44:47]
    ds_read2_b32 v[108:109], v17 offset0:0 offset1:1
    v_mfma_f32_16x16x32_bf16 v[48:51], v[68:71], v[140:143], v[48:51]
    ds_read2_b32 v[110:111], v17 offset0:2 offset1:3
    v_mfma_f32_16x16x32_bf16 v[52:55], v[68:71], v[144:147], v[52:55]
    ds_read_b128 v[172:175], v20 offset:1568
    v_mfma_f32_16x16x32_bf16 v[56:59], v[68:71], v[148:151], v[56:59]
    ds_read2_b32 v[112:113], v18 offset0:128 offset1:129
    v_mfma_f32_16x16x32_bf16 v[60:63], v[68:71], v[152:155], v[60:63]
    ds_read2_b32 v[114:115], v18 offset0:130 offset1:131
    v_mfma_f32_16x16x32_bf16 v[40:43], v[72:75], v[128:131], v[40:43]
    ds_read_b128 v[176:179], v20 offset:2080
    v_mfma_f32_16x16x32_bf16 v[44:47], v[72:75], v[132:135], v[44:47]
    ds_read2_b32 v[116:117], v18 offset0:0 offset1:1
    v_mfma_f32_16x16x32_bf16 v[48:51], v[72:75], v[136:139], v[48:51]
    ds_read2_b32 v[118:119], v18 offset0:2 offset1:3
    v_mfma_f32_16x16x32_bf16 v[52:55], v[72:75], v[140:143], v[52:55]
    ds_read_b128 v[180:183], v20 offset:2592
    v_mfma_f32_16x16x32_bf16 v[56:59], v[72:75], v[144:147], v[56:59]
    ds_read2_b32 v[120:121], v19 offset0:128 offset1:129
    v_mfma_f32_16x16x32_bf16 v[60:63], v[72:75], v[148:151], v[60:63]
    ds_read2_b32 v[122:123], v19 offset0:130 offset1:131
    v_mfma_f32_16x16x32_bf16 v[44:47], v[76:79], v[128:131], v[44:47]
    ds_read_b128 v[184:187], v20 offset:3104
    v_mfma_f32_16x16x32_bf16 v[48:51], v[76:79], v[132:135], v[48:51]
    ds_read2_b32 v[124:125], v19 offset0:0 offset1:1
    v_mfma_f32_16x16x32_bf16 v[52:55], v[76:79], v[136:139], v[52:55]
    ds_read2_b32 v[126:127], v19 offset0:2 offset1:3
    v_mfma_f32_16x16x32_bf16 v[56:59], v[76:79], v[140:143], v[56:59]
    ds_read_b128 v[188:191], v20 offset:3616
    v_mfma_f32_16x16x32_bf16 v[60:63], v[76:79], v[144:147], v[60:63]
    v_mfma_f32_16x16x32_bf16 v[48:51], v[80:83], v[128:131], v[48:51]
    v_mfma_f32_16x16x32_bf16 v[52:55], v[80:83], v[132:135], v[52:55]
    s_add_u32 m0, s1, 36864
    s_add_u32 s33, s0, 1179648
    buffer_load_dwordx4 v12, s[16:19], s33 offen lds
    v_mfma_f32_16x16x32_bf16 v[56:59], v[80:83], v[136:139], v[56:59]
    v_mfma_f32_16x16x32_bf16 v[60:63], v[80:83], v[140:143], v[60:63]
    v_mfma_f32_16x16x32_bf16 v[52:55], v[84:87], v[128:131], v[52:55]
    v_mfma_f32_16x16x32_bf16 v[56:59], v[84:87], v[132:135], v[56:59]
    v_mfma_f32_16x16x32_bf16 v[60:63], v[84:87], v[136:139], v[60:63]
    v_mfma_f32_16x16x32_bf16 v[56:59], v[88:91], v[128:131], v[56:59]
    v_mfma_f32_16x16x32_bf16 v[60:63], v[88:91], v[132:135], v[60:63]
    v_mfma_f32_16x16x32_bf16 v[60:63], v[92:95], v[128:131], v[60:63]
    s_waitcnt lgkmcnt(0)
    v_mfma_f32_16x16x32_bf16 v[32:35], v[96:99], v[160:163], v[32:35]
    v_mfma_f32_16x16x32_bf16 v[36:39], v[96:99], v[164:167], v[36:39]
    v_mfma_f32_16x16x32_bf16 v[40:43], v[96:99], v[168:171], v[40:43]
    v_mfma_f32_16x16x32_bf16 v[44:47], v[96:99], v[172:175], v[44:47]
    v_mfma_f32_16x16x32_bf16 v[48:51], v[96:99], v[176:179], v[48:51]
    s_add_u32 m0, s1, 37888
    s_nop 0
    buffer_load_dwordx4 v13, s[16:19], s33 offen lds
    v_mfma_f32_16x16x32_bf16 v[52:55], v[96:99], v[180:183], v[52:55]
    v_mfma_f32_16x16x32_bf16 v[56:59], v[96:99], v[184:187], v[56:59]
    v_mfma_f32_16x16x32_bf16 v[60:63], v[96:99], v[188:191], v[60:63]
    v_mfma_f32_16x16x32_bf16 v[36:39], v[100:103], v[160:163], v[36:39]
    v_mfma_f32_16x16x32_bf16 v[40:43], v[100:103], v[164:167], v[40:43]
    v_mfma_f32_16x16x32_bf16 v[44:47], v[100:103], v[168:171], v[44:47]
    v_mfma_f32_16x16x32_bf16 v[48:51], v[100:103], v[172:175], v[48:51]
    v_mfma_f32_16x16x32_bf16 v[52:55], v[100:103], v[176:179], v[52:55]
    s_add_u32 m0, s1, 38912
    s_nop 0
    buffer_load_dwordx4 v14, s[16:19], s33 offen lds
    v_mfma_f32_16x16x32_bf16 v[56:59], v[100:103], v[180:183], v[56:59]
    v_mfma_f32_16x16x32_bf16 v[60:63], v[100:103], v[184:187], v[60:63]
    v_mfma_f32_16x16x32_bf16 v[40:43], v[104:107], v[160:163], v[40:43]
    v_mfma_f32_16x16x32_bf16 v[44:47], v[104:107], v[164:167], v[44:47]
    v_mfma_f32_16x16x32_bf16 v[48:51], v[104:107], v[168:171], v[48:51]
    v_mfma_f32_16x16x32_bf16 v[52:55], v[104:107], v[172:175], v[52:55]
    v_mfma_f32_16x16x32_bf16 v[56:59], v[104:107], v[176:179], v[56:59]
    v_mfma_f32_16x16x32_bf16 v[60:63], v[104:107], v[180:183], v[60:63]
    v_mfma_f32_16x16x32_bf16 v[44:47], v[108:111], v[160:163], v[44:47]
    v_mfma_f32_16x16x32_bf16 v[48:51], v[108:111], v[164:167], v[48:51]
    v_mfma_f32_16x16x32_bf16 v[52:55], v[108:111], v[168:171], v[52:55]
    v_mfma_f32_16x16x32_bf16 v[56:59], v[108:111], v[172:175], v[56:59]
    v_mfma_f32_16x16x32_bf16 v[60:63], v[108:111], v[176:179], v[60:63]
    v_mfma_f32_16x16x32_bf16 v[48:51], v[112:115], v[160:163], v[48:51]
    v_mfma_f32_16x16x32_bf16 v[52:55], v[112:115], v[164:167], v[52:55]
    v_mfma_f32_16x16x32_bf16 v[56:59], v[112:115], v[168:171], v[56:59]
    v_mfma_f32_16x16x32_bf16 v[60:63], v[112:115], v[172:175], v[60:63]
    v_mfma_f32_16x16x32_bf16 v[52:55], v[116:119], v[160:163], v[52:55]
    v_mfma_f32_16x16x32_bf16 v[56:59], v[116:119], v[164:167], v[56:59]
    v_mfma_f32_16x16x32_bf16 v[60:63], v[116:119], v[168:171], v[60:63]
    v_mfma_f32_16x16x32_bf16 v[56:59], v[120:123], v[160:163], v[56:59]
    v_mfma_f32_16x16x32_bf16 v[60:63], v[120:123], v[164:167], v[60:63]
    v_mfma_f32_16x16x32_bf16 v[60:63], v[124:127], v[160:163], v[60:63]
.p2align 3
    v_cvt_pk_bf16_f32 v64, v32, v33
    v_cvt_pk_bf16_f32 v65, v34, v35
    ds_write_b64 v21, v[64:65] offset:0
    v_cvt_pk_bf16_f32 v66, v36, v37
    v_cvt_pk_bf16_f32 v67, v38, v39
    ds_write_b64 v21, v[66:67] offset:256
    v_cvt_pk_bf16_f32 v68, v40, v41
    v_cvt_pk_bf16_f32 v69, v42, v43
    ds_write_b64 v21, v[68:69] offset:512
    v_cvt_pk_bf16_f32 v70, v44, v45
    v_cvt_pk_bf16_f32 v71, v46, v47
    ds_write_b64 v21, v[70:71] offset:768
    v_cvt_pk_bf16_f32 v72, v48, v49
    v_cvt_pk_bf16_f32 v73, v50, v51
    ds_write_b64 v21, v[72:73] offset:1024
    v_cvt_pk_bf16_f32 v74, v52, v53
    v_cvt_pk_bf16_f32 v75, v54, v55
    ds_write_b64 v21, v[74:75] offset:1280
    v_cvt_pk_bf16_f32 v76, v56, v57
    v_cvt_pk_bf16_f32 v77, v58, v59
    ds_write_b64 v21, v[76:77] offset:1536
    v_cvt_pk_bf16_f32 v78, v60, v61
    v_cvt_pk_bf16_f32 v79, v62, v63
    ds_write_b64 v21, v[78:79] offset:1792
    s_waitcnt lgkmcnt(0)
    s_barrier
    ds_read_b64_tr_b16 v[32:33], v22 offset:0
    ds_read_b64_tr_b16 v[34:35], v22 offset:2048
    ds_read_b64_tr_b16 v[36:37], v22 offset:512
    ds_read_b64_tr_b16 v[38:39], v22 offset:2560
    ds_read_b64_tr_b16 v[40:41], v22 offset:1024
    ds_read_b64_tr_b16 v[42:43], v22 offset:3072
    ds_read_b64_tr_b16 v[44:45], v22 offset:1536
    ds_read_b64_tr_b16 v[46:47], v22 offset:3584
    s_waitcnt vmcnt(8)
    s_waitcnt lgkmcnt(6)
    v_lshlrev_b32 v64, 16, v192
    v_and_b32 v65, s39, v192
    v_lshlrev_b32 v68, 16, v32
    v_and_b32 v69, s39, v32
    v_pk_add_f32 v[66:67], v[64:65], v[208:209] op_sel_hi:[1,0] neg_lo:[0,1] neg_hi:[0,1]
    v_pk_mul_f32 v[68:69], v[68:69], v[208:209] op_sel:[0,1] op_sel_hi:[1,1]
    v_pk_fma_f32 v[64:65], v[66:67], v[68:69], v[64:65]
    v_cvt_pk_bf16_f32 v48, v64, v65
    v_lshlrev_b32 v72, 16, v193
    v_and_b32 v73, s39, v193
    v_lshlrev_b32 v76, 16, v33
    v_and_b32 v77, s39, v33
    v_pk_add_f32 v[74:75], v[72:73], v[208:209] op_sel_hi:[1,0] neg_lo:[0,1] neg_hi:[0,1]
    v_pk_mul_f32 v[76:77], v[76:77], v[208:209] op_sel:[0,1] op_sel_hi:[1,1]
    v_pk_fma_f32 v[72:73], v[74:75], v[76:77], v[72:73]
    v_cvt_pk_bf16_f32 v49, v72, v73
    v_lshlrev_b32 v64, 16, v194
    v_and_b32 v65, s39, v194
    v_lshlrev_b32 v68, 16, v34
    v_and_b32 v69, s39, v34
    v_pk_add_f32 v[66:67], v[64:65], v[210:211] op_sel_hi:[1,0] neg_lo:[0,1] neg_hi:[0,1]
    v_pk_mul_f32 v[68:69], v[68:69], v[210:211] op_sel:[0,1] op_sel_hi:[1,1]
    v_pk_fma_f32 v[64:65], v[66:67], v[68:69], v[64:65]
    v_cvt_pk_bf16_f32 v50, v64, v65
    v_lshlrev_b32 v72, 16, v195
    v_and_b32 v73, s39, v195
    v_lshlrev_b32 v76, 16, v35
    v_and_b32 v77, s39, v35
    v_pk_add_f32 v[74:75], v[72:73], v[210:211] op_sel_hi:[1,0] neg_lo:[0,1] neg_hi:[0,1]
    v_pk_mul_f32 v[76:77], v[76:77], v[210:211] op_sel:[0,1] op_sel_hi:[1,1]
    v_pk_fma_f32 v[72:73], v[74:75], v[76:77], v[72:73]
    v_cvt_pk_bf16_f32 v51, v72, v73
    s_add_u32 s25, s43, 2637824
    buffer_store_dwordx4 v[48:51], v23, s[8:11], s25 offen sc1
    s_waitcnt lgkmcnt(4)
    v_lshlrev_b32 v64, 16, v196
    v_and_b32 v65, s39, v196
    v_lshlrev_b32 v68, 16, v36
    v_and_b32 v69, s39, v36
    v_pk_add_f32 v[66:67], v[64:65], v[212:213] op_sel_hi:[1,0] neg_lo:[0,1] neg_hi:[0,1]
    v_pk_mul_f32 v[68:69], v[68:69], v[212:213] op_sel:[0,1] op_sel_hi:[1,1]
    v_pk_fma_f32 v[64:65], v[66:67], v[68:69], v[64:65]
    v_cvt_pk_bf16_f32 v52, v64, v65
    v_lshlrev_b32 v72, 16, v197
    v_and_b32 v73, s39, v197
    v_lshlrev_b32 v76, 16, v37
    v_and_b32 v77, s39, v37
    v_pk_add_f32 v[74:75], v[72:73], v[212:213] op_sel_hi:[1,0] neg_lo:[0,1] neg_hi:[0,1]
    v_pk_mul_f32 v[76:77], v[76:77], v[212:213] op_sel:[0,1] op_sel_hi:[1,1]
    v_pk_fma_f32 v[72:73], v[74:75], v[76:77], v[72:73]
    v_cvt_pk_bf16_f32 v53, v72, v73
    v_lshlrev_b32 v64, 16, v198
    v_and_b32 v65, s39, v198
    v_lshlrev_b32 v68, 16, v38
    v_and_b32 v69, s39, v38
    v_pk_add_f32 v[66:67], v[64:65], v[214:215] op_sel_hi:[1,0] neg_lo:[0,1] neg_hi:[0,1]
    v_pk_mul_f32 v[68:69], v[68:69], v[214:215] op_sel:[0,1] op_sel_hi:[1,1]
    v_pk_fma_f32 v[64:65], v[66:67], v[68:69], v[64:65]
    v_cvt_pk_bf16_f32 v54, v64, v65
    v_lshlrev_b32 v72, 16, v199
    v_and_b32 v73, s39, v199
    v_lshlrev_b32 v76, 16, v39
    v_and_b32 v77, s39, v39
    v_pk_add_f32 v[74:75], v[72:73], v[214:215] op_sel_hi:[1,0] neg_lo:[0,1] neg_hi:[0,1]
    v_pk_mul_f32 v[76:77], v[76:77], v[214:215] op_sel:[0,1] op_sel_hi:[1,1]
    v_pk_fma_f32 v[72:73], v[74:75], v[76:77], v[72:73]
    v_cvt_pk_bf16_f32 v55, v72, v73
    s_add_u32 s25, s43, 3293184
    buffer_store_dwordx4 v[52:55], v23, s[8:11], s25 offen sc1
    s_waitcnt lgkmcnt(2)
    v_lshlrev_b32 v64, 16, v200
    v_and_b32 v65, s39, v200
    v_lshlrev_b32 v68, 16, v40
    v_and_b32 v69, s39, v40
    v_pk_add_f32 v[66:67], v[64:65], v[216:217] op_sel_hi:[1,0] neg_lo:[0,1] neg_hi:[0,1]
    v_pk_mul_f32 v[68:69], v[68:69], v[216:217] op_sel:[0,1] op_sel_hi:[1,1]
    v_pk_fma_f32 v[64:65], v[66:67], v[68:69], v[64:65]
    v_cvt_pk_bf16_f32 v56, v64, v65
    v_lshlrev_b32 v72, 16, v201
    v_and_b32 v73, s39, v201
    v_lshlrev_b32 v76, 16, v41
    v_and_b32 v77, s39, v41
    v_pk_add_f32 v[74:75], v[72:73], v[216:217] op_sel_hi:[1,0] neg_lo:[0,1] neg_hi:[0,1]
    v_pk_mul_f32 v[76:77], v[76:77], v[216:217] op_sel:[0,1] op_sel_hi:[1,1]
    v_pk_fma_f32 v[72:73], v[74:75], v[76:77], v[72:73]
    v_cvt_pk_bf16_f32 v57, v72, v73
    v_lshlrev_b32 v64, 16, v202
    v_and_b32 v65, s39, v202
    v_lshlrev_b32 v68, 16, v42
    v_and_b32 v69, s39, v42
    v_pk_add_f32 v[66:67], v[64:65], v[218:219] op_sel_hi:[1,0] neg_lo:[0,1] neg_hi:[0,1]
    v_pk_mul_f32 v[68:69], v[68:69], v[218:219] op_sel:[0,1] op_sel_hi:[1,1]
    v_pk_fma_f32 v[64:65], v[66:67], v[68:69], v[64:65]
    v_cvt_pk_bf16_f32 v58, v64, v65
    v_lshlrev_b32 v72, 16, v203
    v_and_b32 v73, s39, v203
    v_lshlrev_b32 v76, 16, v43
    v_and_b32 v77, s39, v43
    v_pk_add_f32 v[74:75], v[72:73], v[218:219] op_sel_hi:[1,0] neg_lo:[0,1] neg_hi:[0,1]
    v_pk_mul_f32 v[76:77], v[76:77], v[218:219] op_sel:[0,1] op_sel_hi:[1,1]
    v_pk_fma_f32 v[72:73], v[74:75], v[76:77], v[72:73]
    v_cvt_pk_bf16_f32 v59, v72, v73
    s_add_u32 s25, s43, 3948544
    buffer_store_dwordx4 v[56:59], v23, s[8:11], s25 offen sc1
    s_waitcnt lgkmcnt(0)
    v_lshlrev_b32 v64, 16, v204
    v_and_b32 v65, s39, v204
    v_lshlrev_b32 v68, 16, v44
    v_and_b32 v69, s39, v44
    v_pk_add_f32 v[66:67], v[64:65], v[220:221] op_sel_hi:[1,0] neg_lo:[0,1] neg_hi:[0,1]
    v_pk_mul_f32 v[68:69], v[68:69], v[220:221] op_sel:[0,1] op_sel_hi:[1,1]
    v_pk_fma_f32 v[64:65], v[66:67], v[68:69], v[64:65]
    v_cvt_pk_bf16_f32 v60, v64, v65
    v_lshlrev_b32 v72, 16, v205
    v_and_b32 v73, s39, v205
    v_lshlrev_b32 v76, 16, v45
    v_and_b32 v77, s39, v45
    v_pk_add_f32 v[74:75], v[72:73], v[220:221] op_sel_hi:[1,0] neg_lo:[0,1] neg_hi:[0,1]
    v_pk_mul_f32 v[76:77], v[76:77], v[220:221] op_sel:[0,1] op_sel_hi:[1,1]
    v_pk_fma_f32 v[72:73], v[74:75], v[76:77], v[72:73]
    v_cvt_pk_bf16_f32 v61, v72, v73
    v_lshlrev_b32 v64, 16, v206
    v_and_b32 v65, s39, v206
    v_lshlrev_b32 v68, 16, v46
    v_and_b32 v69, s39, v46
    v_pk_add_f32 v[66:67], v[64:65], v[222:223] op_sel_hi:[1,0] neg_lo:[0,1] neg_hi:[0,1]
    v_pk_mul_f32 v[68:69], v[68:69], v[222:223] op_sel:[0,1] op_sel_hi:[1,1]
    v_pk_fma_f32 v[64:65], v[66:67], v[68:69], v[64:65]
    v_cvt_pk_bf16_f32 v62, v64, v65
    v_lshlrev_b32 v72, 16, v207
    v_and_b32 v73, s39, v207
    v_lshlrev_b32 v76, 16, v47
    v_and_b32 v77, s39, v47
    v_pk_add_f32 v[74:75], v[72:73], v[222:223] op_sel_hi:[1,0] neg_lo:[0,1] neg_hi:[0,1]
    v_pk_mul_f32 v[76:77], v[76:77], v[222:223] op_sel:[0,1] op_sel_hi:[1,1]
    v_pk_fma_f32 v[72:73], v[74:75], v[76:77], v[72:73]
    v_cvt_pk_bf16_f32 v63, v72, v73
    s_add_u32 s25, s43, 4603904
    buffer_store_dwordx4 v[60:63], v23, s[8:11], s25 offen sc1
    s_add_u32 s25, s43, 5259264
    buffer_store_dwordx4 v[32:35], v23, s[8:11], s25 offen sc1
    s_add_u32 s25, s43, 5914624
    buffer_store_dwordx4 v[36:39], v23, s[8:11], s25 offen sc1
    s_add_u32 s25, s43, 6569984
    buffer_store_dwordx4 v[40:43], v23, s[8:11], s25 offen sc1
    s_add_u32 s25, s43, 7225344
    buffer_store_dwordx4 v[44:47], v23, s[8:11], s25 offen sc1
    s_waitcnt vmcnt(0)
    s_barrier
    s_branch L_arrive
L_idle:
    s_mov_b64 exec, 1
    buffer_store_dword v17, v8, s[8:11], s22 offen sc1
    s_mov_b64 exec, -1
    s_mov_b32 s32, s36
    s_and_b32 s33, s37, 0xffff
    s_mov_b32 s37, s30
    s_mov_b32 s34, 1966080
    s_mul_i32 s30, s20, 12
    s_add_u32 s30, s30, s101
    s_lshl_b32 s40, s30, 2
    s_add_u32 s40, s40, s3
    s_lshl_b32 s26, s3, 12
    s_add_u32 s26, s26, 110592
    v_lshrrev_b32 v21, 2, v4
    v_lshlrev_b32 v21, 9, v21
    v_lshl_add_u32 v21, v3, 8, v21
    v_and_b32 v17, 3, v4
    v_lshl_add_u32 v21, v17, 6, v21
    v_add_u32 v21, s26, v21
    v_add_u32 v17, s26, v2
    s_mov_b32 s28, 0x05040100
    s_mov_b32 s29, 0x07060302
    s_mov_b32 s36, s33
    s_mov_b32 s33, s36
L_relay:
    s_mul_i32 s41, s40, 13108
    s_lshr_b32 s41, s41, 16
    s_mul_i32 s42, s41, 5
    s_sub_u32 s42, s40, s42
    s_mul_i32 s4, s41, 20480
    s_lshl_b32 s5, s42, 8
    s_add_u32 s4, s4, s5
    s_add_u32 s5, s4, 10240
    v_mul_u32_u24 v18, 5120, v3
    v_lshl_add_u32 v18, v4, 3, v18
    buffer_load_dwordx2 v[32:33], v18, s[32:35], s4 offen offset:0
    buffer_load_dwordx2 v[34:35], v18, s[32:35], s4 offen offset:1280
    buffer_load_dwordx2 v[36:37], v18, s[32:35], s4 offen offset:2560
    buffer_load_dwordx2 v[38:39], v18, s[32:35], s4 offen offset:3840
    buffer_load_dwordx2 v[40:41], v18, s[32:35], s5 offen offset:0
    buffer_load_dwordx2 v[42:43], v18, s[32:35], s5 offen offset:1280
    buffer_load_dwordx2 v[44:45], v18, s[32:35], s5 offen offset:2560
    buffer_load_dwordx2 v[46:47], v18, s[32:35], s5 offen offset:3840
    s_lshr_b32 s27, s40, 1
    s_mul_i32 s27, s27, 10240
    v_lshlrev_b32 v22, 7, v1
    s_cmp_ge_u32 s40, 384
    s_cbranch_scc1 L_notouch
    buffer_load_dword a250, v22, s[16:19], s27 offen
    s_add_u32 s27, s27, 8192
    s_mov_b64 exec, 0xffff
    buffer_load_dword a251, v22, s[16:19], s27 offen
    s_mov_b64 exec, -1
L_notouch:
    s_mul_i32 s43, s41, 43
    s_lshr_b32 s43, s43, 7
    s_mul_i32 s6, s43, 3
    s_sub_u32 s6, s41, s6
    s_lshl_b32 s6, s6, 2
    s_lshr_b32 s7, s43, 3
    s_mul_i32 s7, s7, 12
    s_add_u32 s6, s6, s7
    s_bfe_u32 s7, s43, 0x20001
    s_add_u32 s6, s6, s7
    s_mul_i32 s6, s6, 5120
    s_and_b32 s7, s43, 1
    s_lshl_b32 s7, s7, 9
    s_add_u32 s6, s6, s7
    s_add_u32 s6, s6, 14172160
    s_lshl_b32 s42, s42, 3
    v_add_u32 v19, s42, v3
    v_add_u32 v19, 0, v19
    v_mul_u32_u24 v20, 26, v19
    v_lshrrev_b32 v20, 7, v20
    v_mul_u32_u24 v20, 240640, v20
    v_lshl_add_u32 v20, v19, 10, v20
    v_lshl_add_u32 v24, v4, 4, v20
    v_add_u32 v19, s42, v3
    v_add_u32 v19, 2, v19
    v_mul_u32_u24 v20, 26, v19
    v_lshrrev_b32 v20, 7, v20
    v_mul_u32_u24 v20, 240640, v20
    v_lshl_add_u32 v20, v19, 10, v20
    v_lshl_add_u32 v25, v4, 4, v20
    v_add_u32 v19, s42, v3
    v_add_u32 v19, 4, v19
    v_mul_u32_u24 v20, 26, v19
    v_lshrrev_b32 v20, 7, v20
    v_mul_u32_u24 v20, 240640, v20
    v_lshl_add_u32 v20, v19, 10, v20
    v_lshl_add_u32 v26, v4, 4, v20
    v_add_u32 v19, s42, v3
    v_add_u32 v19, 6, v19
    v_mul_u32_u24 v20, 26, v19
    v_lshrrev_b32 v20, 7, v20
    v_mul_u32_u24 v20, 240640, v20
    v_lshl_add_u32 v20, v19, 10, v20
    v_lshl_add_u32 v27, v4, 4, v20
    s_waitcnt vmcnt(0)
.p2align 3
    v_perm_b32 v48, v34, v32, s28
    v_perm_b32 v49, v38, v36, s28
    v_perm_b32 v50, v42, v40, s28
    v_perm_b32 v51, v46, v44, s28
    ds_write_b128 v21, v[48:51] offset:0
    v_perm_b32 v52, v34, v32, s29
    v_perm_b32 v53, v38, v36, s29
    v_perm_b32 v54, v42, v40, s29
    v_perm_b32 v55, v46, v44, s29
    ds_write_b128 v21, v[52:55] offset:16
    v_perm_b32 v56, v35, v33, s28
    v_perm_b32 v57, v39, v37, s28
    v_perm_b32 v58, v43, v41, s28
    v_perm_b32 v59, v47, v45, s28
    ds_write_b128 v21, v[56:59] offset:32
    v_perm_b32 v60, v35, v33, s29
    v_perm_b32 v61, v39, v37, s29
    v_perm_b32 v62, v43, v41, s29
    v_perm_b32 v63, v47, v45, s29
    ds_write_b128 v21, v[60:63] offset:48
    ds_read_b128 v[64:67], v17 offset:0
    ds_read_b128 v[68:71], v17 offset:1024
    ds_read_b128 v[72:75], v17 offset:2048
    ds_read_b128 v[76:79], v17 offset:3072
    s_waitcnt lgkmcnt(3)
    buffer_store_dwordx4 v[64:67], v24, s[8:11], s6 offen sc1
    s_waitcnt lgkmcnt(2)
    buffer_store_dwordx4 v[68:71], v25, s[8:11], s6 offen sc1
    s_waitcnt lgkmcnt(1)
    buffer_store_dwordx4 v[72:75], v26, s[8:11], s6 offen sc1
    s_waitcnt lgkmcnt(0)
    buffer_store_dwordx4 v[76:79], v27, s[8:11], s6 offen sc1
    s_add_u32 s40, s40, 384
    s_cmp_lt_u32 s40, 480
    s_cbranch_scc1 L_relay
    s_sub_u32 s47, 1, s38
    s_mul_i32 s33, s47, 196608
    s_add_u32 s33, s33, s0
    s_mul_i32 s47, s47, 6144
    s_add_u32 s47, s47, s1
    s_add_u32 m0, s47, 0
    s_nop 0
    buffer_load_dwordx4 v12, s[16:19], s33 offen lds
    s_add_u32 m0, s47, 1024
    s_nop 0
    buffer_load_dwordx4 v13, s[16:19], s33 offen lds
    s_add_u32 m0, s47, 2048
    s_nop 0
    buffer_load_dwordx4 v14, s[16:19], s33 offen lds
    s_waitcnt vmcnt(3)
    s_barrier
    s_cmp_lg_u32 s3, 0
    s_cbranch_scc1 L_norf
    s_lshl_b32 s30, s30, 4
    s_add_u32 s30, s30, 16693248
    v_mov_b32 v24, 0
    s_mov_b64 exec, 1
    buffer_store_dword v9, v24, s[8:11], s30 offen sc1
    s_mov_b64 exec, -1
L_norf:
    s_mov_b32 s23, 16689152
    buffer_load_dword v224, v2, s[8:11], s23 offen offset:0 sc1
    buffer_load_dword v225, v2, s[8:11], s23 offen offset:1024 sc1
    buffer_load_dword v226, v2, s[8:11], s23 offen offset:2048 sc1
    buffer_load_dword v227, v2, s[8:11], s23 offen offset:3072 sc1
    s_sub_u32 s47, 2, s38
    s_mul_i32 s33, s47, 196608
    s_add_u32 s33, s33, s0
    s_mul_i32 s47, s47, 6144
    s_add_u32 s47, s47, s1
    s_add_u32 m0, s47, 0
    s_nop 0
    buffer_load_dwordx4 v12, s[16:19], s33 offen lds
    s_add_u32 m0, s47, 1024
    s_nop 0
    buffer_load_dwordx4 v13, s[16:19], s33 offen lds
    s_add_u32 m0, s47, 2048
    s_nop 0
    buffer_load_dwordx4 v14, s[16:19], s33 offen lds
    s_sub_u32 s47, 3, s38
    s_mul_i32 s33, s47, 196608
    s_add_u32 s33, s33, s0
    s_mul_i32 s47, s47, 6144
    s_add_u32 s47, s47, s1
    s_add_u32 m0, s47, 0
    s_nop 0
    buffer_load_dwordx4 v12, s[16:19], s33 offen lds
    s_add_u32 m0, s47, 1024
    s_nop 0
    buffer_load_dwordx4 v13, s[16:19], s33 offen lds
    s_add_u32 m0, s47, 2048
    s_nop 0
    buffer_load_dwordx4 v14, s[16:19], s33 offen lds
    s_add_u32 m0, s1, 24576
    s_add_u32 s33, s0, 786432
    buffer_load_dwordx4 v12, s[16:19], s33 offen lds
    s_add_u32 m0, s1, 25600
    s_nop 0
    buffer_load_dwordx4 v13, s[16:19], s33 offen lds
    s_add_u32 m0, s1, 26624
    s_nop 0
    buffer_load_dwordx4 v14, s[16:19], s33 offen lds
    s_add_u32 m0, s1, 30720
    s_add_u32 s33, s0, 983040
    buffer_load_dwordx4 v12, s[16:19], s33 offen lds
    s_add_u32 m0, s1, 31744
    s_nop 0
    buffer_load_dwordx4 v13, s[16:19], s33 offen lds
    s_add_u32 m0, s1, 32768
    s_nop 0
    buffer_load_dwordx4 v14, s[16:19], s33 offen lds
    s_add_u32 m0, s1, 36864
    s_add_u32 s33, s0, 1179648
    buffer_load_dwordx4 v12, s[16:19], s33 offen lds
    s_add_u32 m0, s1, 37888
    s_nop 0
    buffer_load_dwordx4 v13, s[16:19], s33 offen lds
    s_add_u32 m0, s1, 38912
    s_nop 0
    buffer_load_dwordx4 v14, s[16:19], s33 offen lds
    s_waitcnt vmcnt(15)
    v_cmp_ne_u32 vcc, s96, v224
    s_nop 0
    s_mov_b64 s[34:35], vcc
    v_cmp_ne_u32 vcc, s96, v225
    s_nop 0
    s_or_b64 s[34:35], s[34:35], vcc
    v_cmp_ne_u32 vcc, s96, v226
    s_nop 0
    s_or_b64 s[34:35], s[34:35], vcc
    v_cmp_ne_u32 vcc, s96, v227
    s_nop 0
    s_or_b64 s[34:35], s[34:35], vcc
    s_cmp_eq_u64 s[34:35], 0
    s_cbranch_scc0 L_cf_1006
L_cb_1007:
L_arrive:
    s_lshl_b32 s25, s20, 7
    s_add_u32 s25, s25, 16687104
    s_cmp_eq_u32 s3, 0
    s_cselect_b32 s23, 0, 0x80000000
    v_mov_b32 v24, 1
    v_mov_b32 v25, s23
    s_mov_b64 exec, 1
    buffer_atomic_add v24, v25, s[8:11], s25 offen sc0 sc1
    s_mov_b64 exec, -1
    s_add_u32 m0, s1, 43008
    s_add_u32 s33, s0, 1376256
    buffer_load_dwordx4 v12, s[16:19], s33 offen lds
    s_add_u32 m0, s1, 44032
    s_nop 0
    buffer_load_dwordx4 v13, s[16:19], s33 offen lds
    s_add_u32 m0, s1, 45056
    s_nop 0
    buffer_load_dwordx4 v14, s[16:19], s33 offen lds
    s_waitcnt vmcnt(3)
    v_readfirstlane_b32 s25, v24
    s_nop 0
    s_add_u32 s25, s25, s23
    s_cmp_lg_u32 s25, 31
    s_cbranch_scc1 L_arrived
    s_lshl_b32 s25, s20, 2
    s_add_u32 s25, s25, 16688128
    v_lshlrev_b32 v25, 7, v1
    s_mov_b64 exec, 0xff
    buffer_store_dword v9, v25, s[8:11], s25 offen sc1
    s_mov_b64 exec, -1
L_arrived:
    s_add_u32 m0, s1, 49152
    s_add_u32 s33, s0, 1572864
    buffer_load_dwordx4 v12, s[16:19], s33 offen lds
    s_add_u32 m0, s1, 50176
    s_nop 0
    buffer_load_dwordx4 v13, s[16:19], s33 offen lds
    s_add_u32 m0, s1, 51200
    s_nop 0
    buffer_load_dwordx4 v14, s[16:19], s33 offen lds
    s_add_u32 m0, s1, 55296
    s_add_u32 s33, s0, 1769472
    buffer_load_dwordx4 v12, s[16:19], s33 offen lds
    s_add_u32 m0, s1, 56320
    s_nop 0
    buffer_load_dwordx4 v13, s[16:19], s33 offen lds
    s_add_u32 m0, s1, 57344
    s_nop 0
    buffer_load_dwordx4 v14, s[16:19], s33 offen lds
    v_lshlrev_b32 v25, 4, v11
    buffer_load_dword v25, v25, s[8:11], s22 offen sc1
    s_lshl_b32 s22, s44, 2
    s_add_u32 s22, s22, s3
    s_lshl_b32 s23, s22, 10
    s_add_u32 s23, s23, 16366592
    v_lshl_add_u32 v23, v1, 7, s23
    s_lshl_b32 s22, s22, 7
    s_add_u32 s22, s22, 16629760
    v_writelane_b32 v23, s22, 2
    s_add_u32 s22, s22, 16384
    v_writelane_b32 v23, s22, 3
    s_lshl_b32 s22, s24, 7
    s_add_u32 s22, s22, 16662528
    v_writelane_b32 v23, s22, 4
    s_lshl_b32 s22, s24, 5
    s_add_u32 s22, s22, s21
    s_lshl_b32 s22, s22, 7
    s_add_u32 s22, s22, 16236544
    v_writelane_b32 v23, s22, 0
    s_add_u32 s22, s22, 262144
    v_writelane_b32 v23, s22, 1
    s_mov_b64 exec, 0xff1f
    buffer_load_dword a255, v23, s[8:11], 0 offen
    s_mov_b64 exec, -1
    s_lshr_b32 s22, s21, 3
    s_add_u32 s22, s22, 0
    s_and_b32 s22, s22, 3
    s_mul_i32 s4, s22, 6144
    s_lshr_b32 s22, s21, 3
    s_add_u32 s22, s22, 1
    s_and_b32 s22, s22, 3
    s_mul_i32 s5, s22, 6144
    s_lshr_b32 s22, s21, 3
    s_add_u32 s22, s22, 2
    s_and_b32 s22, s22, 3
    s_mul_i32 s6, s22, 6144
    s_lshr_b32 s22, s21, 3
    s_add_u32 s22, s22, 3
    s_and_b32 s22, s22, 3
    s_mul_i32 s7, s22, 6144
    s_getpc_b64 s[34:35]
L_pc_1009:
    s_add_u32 s34, s34, L_g1_0-L_pc_1009
    s_addc_u32 s35, s35, 0
    s_lshl_b32 s33, s21, 2
    s_add_u32 s33, s33, s3
    s_mul_i32 s33, s33, 256
    v_lshl_add_u32 v7, v1, 7, s33
    v_min_u32 v7, L_g1_1-L_g1_0, v7
    s_mov_b64 exec, 3
    global_load_dword a252, v7, s[34:35]
    s_mov_b64 exec, -1
    v_and_b32 v19, 15, v1
    v_lshrrev_b32 v20, 4, v1
    v_lshlrev_b32 v21, 4, v19
    v_lshl_add_u32 v21, v20, 9, v21
    v_lshl_add_u32 v22, v3, 11, v21
    s_mul_i32 s26, s44, 196608
    s_mul_i32 s34, s3, 24576
    s_add_u32 s26, s26, s34
    s_add_u32 s26, s26, 7880704
    s_add_u32 s34, s3, 0
    s_and_b32 s35, s34, 1
    s_mul_i32 s35, s35, 98304
    s_lshl_b32 s34, s34, 7
    s_and_b32 s34, s34, 256
    s_add_u32 s40, s26, s35
    s_add_u32 s40, s40, s34
    s_add_u32 s34, s3, 1
    s_and_b32 s35, s34, 1
    s_mul_i32 s35, s35, 98304
    s_lshl_b32 s34, s34, 7
    s_and_b32 s34, s34, 256
    s_add_u32 s41, s26, s35
    s_add_u32 s41, s41, s34
    s_add_u32 s34, s3, 2
    s_and_b32 s35, s34, 1
    s_mul_i32 s35, s35, 98304
    s_lshl_b32 s34, s34, 7
    s_and_b32 s34, s34, 256
    s_add_u32 s42, s26, s35
    s_add_u32 s42, s42, s34
    s_add_u32 s34, s3, 3
    s_and_b32 s35, s34, 1
    s_mul_i32 s35, s35, 98304
    s_lshl_b32 s34, s34, 7
    s_and_b32 s34, s34, 256
    s_add_u32 s43, s26, s35
    s_add_u32 s43, s43, s34
    s_waitcnt vmcnt(2)
    v_cmp_ne_u32 vcc, s37, v25
    s_nop 0
    s_cmp_eq_u32 vcc_lo, 0
    s_cselect_b32 s38, 1, 0
    s_mov_b32 s37, 0
    s_mov_b32 s101, 0
    s_barrier
    s_cmp_lg_u32 s3, 0
    s_cbranch_scc1 L_cs_early
    s_lshl_b32 s36, s20, 7
    s_add_u32 s36, s36, 16688128
    s_mov_b32 s35, 262144
L_go_1008_l:
    buffer_load_dword v18, v11, s[8:11], s36 offen sc1
    s_waitcnt vmcnt(0)
    v_cmp_eq_u32 vcc, s96, v18
    s_nop 0
    s_and_b32 s34, vcc_lo, 0xff
    s_cmp_eq_u32 s34, 0xff
    s_cbranch_scc1 L_go_1008
    s_sleep 2
    s_sub_u32 s35, s35, 1
    s_cbranch_scc0 L_go_1008_l
    s_branch L_go_1008
L_cs_early:
    s_lshl_b32 s22, s3, 5
    s_sub_u32 s22, s22, 32
    v_add_u32 v23, s22, v10
    v_and_b32 v48, 15, v1
    v_bfe_u32 v49, v1, 4, 1
    v_cmp_eq_u32 vcc, v48, v49
    v_mov_b32 v49, 0x3f803f80
.p2align 3
    ds_read_b64_tr_b16 v[24:25], v23 offset:0
    ds_read_b64_tr_b16 v[26:27], v23 offset:384
    ds_read_b64_tr_b16 v[28:29], v23 offset:1536
    ds_read_b64_tr_b16 v[30:31], v23 offset:1920
    ds_read_b64_tr_b16 v[32:33], v23 offset:3072
    ds_read_b64_tr_b16 v[34:35], v23 offset:3456
    ds_read_b64_tr_b16 v[36:37], v23 offset:4608
    ds_read_b64_tr_b16 v[38:39], v23 offset:4992
    ds_read_b64_tr_b16 v[40:41], v23 offset:6144
    ds_read_b64_tr_b16 v[42:43], v23 offset:6528
    v_cndmask_b32 v48, 0, v49, vcc
    v_mov_b32 v49, v48
    v_mov_b32 v50, v48
    v_mov_b32 v51, v48
    s_waitcnt lgkmcnt(8)
    s_nop 0
    v_mfma_f32_16x16x32_bf16 a[240:243], v[48:51], v[24:27], 0
    ds_read_b64_tr_b16 v[44:45], v23 offset:7680
    ds_read_b64_tr_b16 v[46:47], v23 offset:8064
    s_waitcnt lgkmcnt(8)
    v_mfma_f32_16x16x32_bf16 a[240:243], v[48:51], v[28:31], a[240:243]
    ds_read_b64_tr_b16 v[24:25], v23 offset:9216
    ds_read_b64_tr_b16 v[26:27], v23 offset:9600
    s_waitcnt lgkmcnt(8)
    v_mfma_f32_16x16x32_bf16 a[240:243], v[48:51], v[32:35], a[240:243]
    ds_read_b64_tr_b16 v[28:29], v23 offset:10752
    ds_read_b64_tr_b16 v[30:31], v23 offset:11136
    s_waitcnt lgkmcnt(8)
    v_mfma_f32_16x16x32_bf16 a[240:243], v[48:51], v[36:39], a[240:243]
    ds_read_b64_tr_b16 v[32:33], v23 offset:12288
    ds_read_b64_tr_b16 v[34:35], v23 offset:12672
    s_waitcnt lgkmcnt(8)
    v_mfma_f32_16x16x32_bf16 a[240:243], v[48:51], v[40:43], a[240:243]
    ds_read_b64_tr_b16 v[36:37], v23 offset:13824
    ds_read_b64_tr_b16 v[38:39], v23 offset:14208
    s_waitcnt lgkmcnt(8)
    v_mfma_f32_16x16x32_bf16 a[240:243], v[48:51], v[44:47], a[240:243]
    ds_read_b64_tr_b16 v[40:41], v23 offset:15360
    ds_read_b64_tr_b16 v[42:43], v23 offset:15744
    s_waitcnt lgkmcnt(8)
    v_mfma_f32_16x16x32_bf16 a[240:243], v[48:51], v[24:27], a[240:243]
    ds_read_b64_tr_b16 v[44:45], v23 offset:16896
    ds_read_b64_tr_b16 v[46:47], v23 offset:17280
    s_waitcnt lgkmcnt(8)
    v_mfma_f32_16x16x32_bf16 a[240:243], v[48:51], v[28:31], a[240:243]
    ds_read_b64_tr_b16 v[24:25], v23 offset:18432
    ds_read_b64_tr_b16 v[26:27], v23 offset:18816
    s_waitcnt lgkmcnt(8)
    v_mfma_f32_16x16x32_bf16 a[240:243], v[48:51], v[32:35], a[240:243]
    ds_read_b64_tr_b16 v[28:29], v23 offset:19968
    ds_read_b64_tr_b16 v[30:31], v23 offset:20352
    s_waitcnt lgkmcnt(8)
    v_mfma_f32_16x16x32_bf16 a[240:243], v[48:51], v[36:39], a[240:243]
    ds_read_b64_tr_b16 v[32:33], v23 offset:21504
    ds_read_b64_tr_b16 v[34:35], v23 offset:21888
    s_waitcnt lgkmcnt(8)
    v_mfma_f32_16x16x32_bf16 a[240:243], v[48:51], v[40:43], a[240:243]
    ds_read_b64_tr_b16 v[36:37], v23 offset:23040
    ds_read_b64_tr_b16 v[38:39], v23 offset:23424
    s_waitcnt lgkmcnt(8)
    v_mfma_f32_16x16x32_bf16 a[240:243], v[48:51], v[44:47], a[240:243]
    ds_read_b64_tr_b16 v[40:41], v23 offset:24576
    ds_read_b64_tr_b16 v[42:43], v23 offset:24960
    s_waitcnt lgkmcnt(8)
    v_mfma_f32_16x16x32_bf16 a[240:243], v[48:51], v[24:27], a[240:243]
    ds_read_b64_tr_b16 v[44:45], v23 offset:26112
    ds_read_b64_tr_b16 v[46:47], v23 offset:26496
    s_waitcnt lgkmcnt(8)
    v_mfma_f32_16x16x32_bf16 a[240:243], v[48:51], v[28:31], a[240:243]
    ds_read_b64_tr_b16 v[24:25], v23 offset:27648
    ds_read_b64_tr_b16 v[26:27], v23 offset:28032
    s_waitcnt lgkmcnt(8)
    v_mfma_f32_16x16x32_bf16 a[240:243], v[48:51], v[32:35], a[240:243]
    ds_read_b64_tr_b16 v[28:29], v23 offset:29184
    ds_read_b64_tr_b16 v[30:31], v23 offset:29568
    s_waitcnt lgkmcnt(8)
    v_mfma_f32_16x16x32_bf16 a[240:243], v[48:51], v[36:39], a[240:243]
    ds_read_b64_tr_b16 v[32:33], v23 offset:30720
    ds_read_b64_tr_b16 v[34:35], v23 offset:31104
    s_waitcnt lgkmcnt(8)
    v_mfma_f32_16x16x32_bf16 a[240:243], v[48:51], v[40:43], a[240:243]
    ds_read_b64_tr_b16 v[36:37], v23 offset:32256
    ds_read_b64_tr_b16 v[38:39], v23 offset:32640
    s_waitcnt lgkmcnt(8)
    v_mfma_f32_16x16x32_bf16 a[240:243], v[48:51], v[44:47], a[240:243]
    ds_read_b64_tr_b16 v[40:41], v23 offset:33792
    ds_read_b64_tr_b16 v[42:43], v23 offset:34176
    s_waitcnt lgkmcnt(8)
    v_mfma_f32_16x16x32_bf16 a[240:243], v[48:51], v[24:27], a[240:243]
    ds_read_b64_tr_b16 v[44:45], v23 offset:35328
    ds_read_b64_tr_b16 v[46:47], v23 offset:35712
    s_waitcnt lgkmcnt(8)
    v_mfma_f32_16x16x32_bf16 a[240:243], v[48:51], v[28:31], a[240:243]
    ds_read_b64_tr_b16 v[24:25], v23 offset:36864
    ds_read_b64_tr_b16 v[26:27], v23 offset:37248
    s_waitcnt lgkmcnt(8)
    v_mfma_f32_16x16x32_bf16 a[240:243], v[48:51], v[32:35], a[240:243]
    ds_read_b64_tr_b16 v[28:29], v23 offset:38400
    ds_read_b64_tr_b16 v[30:31], v23 offset:38784
    s_waitcnt lgkmcnt(8)
    v_mfma_f32_16x16x32_bf16 a[240:243], v[48:51], v[36:39], a[240:243]
    ds_read_b64_tr_b16 v[32:33], v23 offset:39936
    ds_read_b64_tr_b16 v[34:35], v23 offset:40320
    s_waitcnt lgkmcnt(8)
    v_mfma_f32_16x16x32_bf16 a[240:243], v[48:51], v[40:43], a[240:243]
    ds_read_b64_tr_b16 v[36:37], v23 offset:41472
    ds_read_b64_tr_b16 v[38:39], v23 offset:41856
    s_waitcnt lgkmcnt(8)
    v_mfma_f32_16x16x32_bf16 a[240:243], v[48:51], v[44:47], a[240:243]
    ds_read_b64_tr_b16 v[40:41], v23 offset:43008
    ds_read_b64_tr_b16 v[42:43], v23 offset:43392
    s_waitcnt lgkmcnt(8)
    v_mfma_f32_16x16x32_bf16 a[240:243], v[48:51], v[24:27], a[240:243]
    ds_read_b64_tr_b16 v[44:45], v23 offset:44544
    ds_read_b64_tr_b16 v[46:47], v23 offset:44928
    s_waitcnt lgkmcnt(8)
    v_mfma_f32_16x16x32_bf16 a[240:243], v[48:51], v[28:31], a[240:243]
    ds_read_b64_tr_b16 v[24:25], v23 offset:46080
    ds_read_b64_tr_b16 v[26:27], v23 offset:46464
    s_waitcnt lgkmcnt(8)
    v_mfma_f32_16x16x32_bf16 a[240:243], v[48:51], v[32:35], a[240:243]
    ds_read_b64_tr_b16 v[28:29], v23 offset:47616
    ds_read_b64_tr_b16 v[30:31], v23 offset:48000
    s_waitcnt lgkmcnt(8)
    v_mfma_f32_16x16x32_bf16 a[240:243], v[48:51], v[36:39], a[240:243]
    ds_read_b64_tr_b16 v[32:33], v23 offset:49152
    ds_read_b64_tr_b16 v[34:35], v23 offset:49536
    s_waitcnt lgkmcnt(8)
    v_mfma_f32_16x16x32_bf16 a[240:243], v[48:51], v[40:43], a[240:243]
    ds_read_b64_tr_b16 v[36:37], v23 offset:50688
    ds_read_b64_tr_b16 v[38:39], v23 offset:51072
    s_waitcnt lgkmcnt(8)
    v_mfma_f32_16x16x32_bf16 a[240:243], v[48:51], v[44:47], a[240:243]
    ds_read_b64_tr_b16 v[40:41], v23 offset:52224
    ds_read_b64_tr_b16 v[42:43], v23 offset:52608
    s_waitcnt lgkmcnt(8)
    v_mfma_f32_16x16x32_bf16 a[240:243], v[48:51], v[24:27], a[240:243]
    ds_read_b64_tr_b16 v[44:45], v23 offset:53760
    ds_read_b64_tr_b16 v[46:47], v23 offset:54144
    s_waitcnt lgkmcnt(8)
    v_mfma_f32_16x16x32_bf16 a[240:243], v[48:51], v[28:31], a[240:243]
    ds_read_b64_tr_b16 v[24:25], v23 offset:55296
    ds_read_b64_tr_b16 v[26:27], v23 offset:55680
    s_waitcnt lgkmcnt(8)
    v_mfma_f32_16x16x32_bf16 a[240:243], v[48:51], v[32:35], a[240:243]
    ds_read_b64_tr_b16 v[28:29], v23 offset:56832
    ds_read_b64_tr_b16 v[30:31], v23 offset:57216
    s_waitcnt lgkmcnt(8)
    v_mfma_f32_16x16x32_bf16 a[240:243], v[48:51], v[36:39], a[240:243]
    ds_read_b64_tr_b16 v[32:33], v23 offset:58368
    ds_read_b64_tr_b16 v[34:35], v23 offset:58752
    s_waitcnt lgkmcnt(8)
    v_mfma_f32_16x16x32_bf16 a[240:243], v[48:51], v[40:43], a[240:243]
    ds_read_b64_tr_b16 v[36:37], v23 offset:59904
    ds_read_b64_tr_b16 v[38:39], v23 offset:60288
    s_waitcnt lgkmcnt(8)
    v_mfma_f32_16x16x32_bf16 a[240:243], v[48:51], v[44:47], a[240:243]
    s_waitcnt lgkmcnt(6)
    v_mfma_f32_16x16x32_bf16 a[240:243], v[48:51], v[24:27], a[240:243]
    s_waitcnt lgkmcnt(4)
    v_mfma_f32_16x16x32_bf16 a[240:243], v[48:51], v[28:31], a[240:243]
    s_waitcnt lgkmcnt(2)
    v_mfma_f32_16x16x32_bf16 a[240:243], v[48:51], v[32:35], a[240:243]
    s_waitcnt lgkmcnt(0)
    v_mfma_f32_16x16x32_bf16 a[240:243], v[48:51], v[36:39], a[240:243]
    s_lshl_b32 s22, s3, 9
    s_add_u32 s22, s22, 122368
    v_lshl_add_u32 v23, v1, 3, s22
    v_cmp_gt_u32 vcc, 32, v1
    v_mov_b32 v30, 0
    s_nop 2
    v_accvgpr_read_b32 v24, a240
    v_accvgpr_read_b32 v25, a241
    s_nop 1
    v_permlane16_swap_b32 v24, v25
    v_cndmask_b32 v24, 0, v24, vcc
    v_cvt_pk_bf16_f32 v28, v24, v24
    v_lshlrev_b32 v25, 16, v28
    v_sub_f32 v25, v24, v25
    v_cvt_pk_bf16_f32 v28, v24, v25
    v_and_b32 v26, s39, v28
    v_sub_f32 v25, v25, v26
    v_cvt_pk_bf16_f32 v29, v25, v30
    ds_write_b64 v23, v[28:29]
    s_waitcnt lgkmcnt(0)
L_go_1008:
    v_lshlrev_b32 v23, 3, v1
    v_add_u32 v23, 122880, v23
    s_mul_i32 s22, s44, 81920
    s_lshl_b32 s29, s45, 6
    s_add_u32 s22, s22, s29
    s_mul_i32 s29, s3, 20480
    s_add_u32 s22, s22, s29
    s_add_u32 s22, s22, 2637824
    v_and_b32 v7, 7, v1
    v_lshlrev_b32 v7, 3, v7
    v_lshrrev_b32 v8, 3, v1
    v_lshl_add_u32 v8, v8, 9, v7
    s_barrier
    ds_read_b64 a[240:241], v23 offset:0
    ds_read_b64 a[244:245], v23 offset:512
    ds_read_b64 a[248:249], v23 offset:1024
    v_accvgpr_write_b32 a242, 0
    v_accvgpr_write_b32 a243, 0
    v_accvgpr_write_b32 a246, 0
    v_accvgpr_write_b32 a247, 0
L_g1_0:
    s_mul_i32 s25, s24, 81920
    s_add_u32 s25, s25, 2637824
    buffer_load_dwordx4 v[160:163], v5, s[8:11], s25 offen offset:0 sc1
    buffer_load_dwordx4 v[164:167], v5, s[8:11], s25 offen offset:512 sc1
    buffer_load_dwordx4 v[168:171], v5, s[8:11], s25 offen offset:2048 sc1
    buffer_load_dwordx4 v[172:175], v5, s[8:11], s25 offen offset:2560 sc1
    s_add_u32 s25, s25, 4096
    buffer_load_dwordx4 v[176:179], v5, s[8:11], s25 offen offset:0 sc1
    buffer_load_dwordx4 v[180:183], v5, s[8:11], s25 offen offset:512 sc1
    buffer_load_dwordx2 v[144:145], v8, s[8:11], s22 offen sc1
    s_add_u32 s22, s22, 4096
    buffer_load_dwordx2 v[146:147], v8, s[8:11], s22 offen sc1
    s_add_u32 s22, s22, 4096
    buffer_load_dwordx2 v[148:149], v8, s[8:11], s22 offen sc1
    s_add_u32 s22, s22, 4096
    buffer_load_dwordx2 v[150:151], v8, s[8:11], s22 offen sc1
    s_add_u32 s22, s22, 4096
    buffer_load_dwordx2 v[152:153], v8, s[8:11], s22 offen sc1
    buffer_load_dwordx4 v[184:187], v5, s[8:11], s25 offen offset:2048 sc1
    buffer_load_dwordx4 v[188:191], v5, s[8:11], s25 offen offset:2560 sc1
    s_add_u32 s25, s25, 4096
    buffer_load_dwordx4 v[192:195], v5, s[8:11], s25 offen offset:0 sc1
    buffer_load_dwordx4 v[196:199], v5, s[8:11], s25 offen offset:512 sc1
    buffer_load_dwordx4 v[200:203], v5, s[8:11], s25 offen offset:2048 sc1
    buffer_load_dwordx4 v[204:207], v5, s[8:11], s25 offen offset:2560 sc1
    s_add_u32 s25, s25, 4096
    ds_read_b64_tr_b16 v[24:25], v10 offset:0
    ds_read_b64_tr_b16 v[26:27], v10 offset:384
    ds_read_b64_tr_b16 v[28:29], v10 offset:32
    ds_read_b64_tr_b16 v[30:31], v10 offset:416
    ds_read_b64_tr_b16 v[32:33], v10 offset:64
    ds_read_b64_tr_b16 v[34:35], v10 offset:448
    s_waitcnt vmcnt(15)
    v_swap_b32 v162, v164
    v_swap_b32 v163, v165
    s_waitcnt lgkmcnt(0)
    s_nop 0
    v_mfma_f32_32x32x16_bf16 v[48:63], v[24:27], v[160:163], 0
    ds_read_b64_tr_b16 v[36:37], v10 offset:1536
    ds_read_b64_tr_b16 v[38:39], v10 offset:1920
    ds_read_b64_tr_b16 v[40:41], v10 offset:1568
    ds_read_b64_tr_b16 v[42:43], v10 offset:1952
    ds_read_b64_tr_b16 v[44:45], v10 offset:1600
    ds_read_b64_tr_b16 v[46:47], v10 offset:1984
    v_mfma_f32_32x32x16_bf16 v[64:79], v[24:27], v[164:167], 0
    buffer_load_dwordx4 v[208:211], v5, s[8:11], s25 offen offset:0 sc1
    s_lshl_b32 s26, s24, 12
    s_add_u32 s26, s26, 16236544
    v_mfma_f32_32x32x16_bf16 v[80:95], v[28:31], v[160:163], 0
    s_waitcnt vmcnt(14)
    v_swap_b32 v170, v172
    v_swap_b32 v171, v173
    v_mfma_f32_32x32x16_bf16 v[96:111], v[28:31], v[164:167], 0
    buffer_load_dwordx4 v[212:215], v5, s[8:11], s25 offen offset:512 sc1
    s_mul_i32 s27, s24, 196608
    s_mul_i32 s28, s21, 3072
    v_mfma_f32_32x32x16_bf16 v[112:127], v[32:35], v[160:163], 0
    s_add_u32 s27, s27, s28
    s_add_u32 s27, s27, 7880704
    s_add_u32 s28, s27, 98304
    s_waitcnt vmcnt(8)
    v_lshlrev_b32 v156, 16, v144
    v_and_b32 v157, s39, v144
    v_mfma_f32_32x32x16_bf16 v[128:143], v[32:35], v[164:167], 0
    buffer_load_dwordx4 v[216:219], v5, s[8:11], s25 offen offset:2048 sc1
    v_add_f32 v154, v156, v157
    s_waitcnt lgkmcnt(0)
    v_mfma_f32_32x32x16_bf16 v[48:63], v[36:39], v[168:171], v[48:63]
    ds_read_b64_tr_b16 v[24:25], v10 offset:3072
    ds_read_b64_tr_b16 v[26:27], v10 offset:3456
    ds_read_b64_tr_b16 v[28:29], v10 offset:3104
    ds_read_b64_tr_b16 v[30:31], v10 offset:3488
    ds_read_b64_tr_b16 v[32:33], v10 offset:3136
    ds_read_b64_tr_b16 v[34:35], v10 offset:3520
    v_mfma_f32_32x32x16_bf16 v[64:79], v[36:39], v[172:175], v[64:79]
    buffer_load_dwordx4 v[220:223], v5, s[8:11], s25 offen offset:2560 sc1
    s_add_u32 s25, s25, 4096
    v_mul_f32 v155, v156, v156
    v_fmac_f32 v155, v157, v157
    v_mfma_f32_32x32x16_bf16 v[80:95], v[40:43], v[168:171], v[80:95]
    v_swap_b32 v178, v180
    v_swap_b32 v179, v181
    v_mfma_f32_32x32x16_bf16 v[96:111], v[40:43], v[172:175], v[96:111]
    s_mov_b32 s31, 16693248
    buffer_load_dword v16, v2, s[8:11], s31 offen offset:0 sc1
    buffer_load_dword v17, v2, s[8:11], s31 offen offset:1024 sc1
    v_lshlrev_b32 v156, 16, v145
    v_and_b32 v157, s39, v145
    v_mfma_f32_32x32x16_bf16 v[112:127], v[44:47], v[168:171], v[112:127]
    v_add_f32 v154, v154, v156
    v_fmac_f32 v155, v156, v156
    v_add_f32 v154, v154, v157
    v_fmac_f32 v155, v157, v157
    v_lshlrev_b32 v156, 16, v146
    v_and_b32 v157, s39, v146
    v_mfma_f32_32x32x16_bf16 v[128:143], v[44:47], v[172:175], v[128:143]
    buffer_load_dwordx4 v[224:227], v5, s[8:11], s25 offen offset:0 sc1
    v_add_f32 v154, v154, v156
    s_waitcnt lgkmcnt(0)
    v_mfma_f32_32x32x16_bf16 v[48:63], v[24:27], v[176:179], v[48:63]
    ds_read_b64_tr_b16 v[36:37], v10 offset:4608
    ds_read_b64_tr_b16 v[38:39], v10 offset:4992
    ds_read_b64_tr_b16 v[40:41], v10 offset:4640
    ds_read_b64_tr_b16 v[42:43], v10 offset:5024
    ds_read_b64_tr_b16 v[44:45], v10 offset:4672
    ds_read_b64_tr_b16 v[46:47], v10 offset:5056
    v_mfma_f32_32x32x16_bf16 v[64:79], v[24:27], v[180:183], v[64:79]
    buffer_load_dwordx4 v[228:231], v5, s[8:11], s25 offen offset:512 sc1
    v_fmac_f32 v155, v156, v156
    v_add_f32 v154, v154, v157
    v_mfma_f32_32x32x16_bf16 v[80:95], v[28:31], v[176:179], v[80:95]
    s_waitcnt vmcnt(12)
    v_swap_b32 v186, v188
    v_swap_b32 v187, v189
    v_mfma_f32_32x32x16_bf16 v[96:111], v[28:31], v[180:183], v[96:111]
    buffer_load_dwordx4 v[232:235], v5, s[8:11], s25 offen offset:2048 sc1
    v_fmac_f32 v155, v157, v157
    v_lshlrev_b32 v156, 16, v147
    v_mfma_f32_32x32x16_bf16 v[112:127], v[32:35], v[176:179], v[112:127]
    v_and_b32 v157, s39, v147
    v_add_f32 v154, v154, v156
    v_fmac_f32 v155, v156, v156
    v_add_f32 v154, v154, v157
    v_fmac_f32 v155, v157, v157
    v_lshlrev_b32 v156, 16, v148
    v_mfma_f32_32x32x16_bf16 v[128:143], v[32:35], v[180:183], v[128:143]
    buffer_load_dwordx4 v[236:239], v5, s[8:11], s25 offen offset:2560 sc1
    s_add_u32 s25, s25, 4096
    v_and_b32 v157, s39, v148
    s_waitcnt lgkmcnt(0)
    v_mfma_f32_32x32x16_bf16 v[48:63], v[36:39], v[184:187], v[48:63]
    ds_read_b64_tr_b16 v[24:25], v10 offset:6144
    ds_read_b64_tr_b16 v[26:27], v10 offset:6528
    ds_read_b64_tr_b16 v[28:29], v10 offset:6176
    ds_read_b64_tr_b16 v[30:31], v10 offset:6560
    ds_read_b64_tr_b16 v[32:33], v10 offset:6208
    ds_read_b64_tr_b16 v[34:35], v10 offset:6592
    v_mfma_f32_32x32x16_bf16 v[64:79], v[36:39], v[188:191], v[64:79]
    buffer_load_dwordx4 v[240:243], v5, s[8:11], s25 offen offset:0 sc1
    v_add_f32 v154, v154, v156
    v_fmac_f32 v155, v156, v156
    v_mfma_f32_32x32x16_bf16 v[80:95], v[40:43], v[184:187], v[80:95]
    s_waitcnt vmcnt(13)
    v_swap_b32 v194, v196
    v_swap_b32 v195, v197
    v_mfma_f32_32x32x16_bf16 v[96:111], v[40:43], v[188:191], v[96:111]
    buffer_load_dwordx4 v[244:247], v5, s[8:11], s25 offen offset:512 sc1
    v_add_f32 v154, v154, v157
    v_fmac_f32 v155, v157, v157
    v_mfma_f32_32x32x16_bf16 v[112:127], v[44:47], v[184:187], v[112:127]
    v_lshlrev_b32 v156, 16, v149
    v_and_b32 v157, s39, v149
    v_add_f32 v154, v154, v156
    v_fmac_f32 v155, v156, v156
    v_add_f32 v154, v154, v157
    v_fmac_f32 v155, v157, v157
    v_mfma_f32_32x32x16_bf16 v[128:143], v[44:47], v[188:191], v[128:143]
    buffer_load_dwordx4 v[248:251], v5, s[8:11], s25 offen offset:2048 sc1
    v_lshlrev_b32 v156, 16, v150
    s_waitcnt lgkmcnt(0)
    v_mfma_f32_32x32x16_bf16 v[48:63], v[24:27], v[192:195], v[48:63]
    ds_read_b64_tr_b16 v[36:37], v10 offset:7680
    ds_read_b64_tr_b16 v[38:39], v10 offset:8064
    ds_read_b64_tr_b16 v[40:41], v10 offset:7712
    ds_read_b64_tr_b16 v[42:43], v10 offset:8096
    ds_read_b64_tr_b16 v[44:45], v10 offset:7744
    ds_read_b64_tr_b16 v[46:47], v10 offset:8128
    v_mfma_f32_32x32x16_bf16 v[64:79], v[24:27], v[196:199], v[64:79]
    buffer_load_dwordx4 v[252:255], v5, s[8:11], s25 offen offset:2560 sc1
    s_add_u32 s25, s25, 4096
    v_and_b32 v157, s39, v150
    v_add_f32 v154, v154, v156
    v_mfma_f32_32x32x16_bf16 v[80:95], v[28:31], v[192:195], v[80:95]
    s_waitcnt vmcnt(14)
    v_swap_b32 v202, v204
    v_swap_b32 v203, v205
    v_mfma_f32_32x32x16_bf16 v[96:111], v[28:31], v[196:199], v[96:111]
    buffer_load_dwordx4 v[160:163], v5, s[8:11], s25 offen offset:0 sc1
    v_fmac_f32 v155, v156, v156
    v_add_f32 v154, v154, v157
    v_mfma_f32_32x32x16_bf16 v[112:127], v[32:35], v[192:195], v[112:127]
    v_fmac_f32 v155, v157, v157
    v_lshlrev_b32 v156, 16, v151
    v_and_b32 v157, s39, v151
    v_add_f32 v154, v154, v156
    v_fmac_f32 v155, v156, v156
    v_add_f32 v154, v154, v157
    v_mfma_f32_32x32x16_bf16 v[128:143], v[32:35], v[196:199], v[128:143]
    buffer_load_dwordx4 v[164:167], v5, s[8:11], s25 offen offset:512 sc1
    v_fmac_f32 v155, v157, v157
    s_waitcnt lgkmcnt(0)
    v_mfma_f32_32x32x16_bf16 v[48:63], v[36:39], v[200:203], v[48:63]
    ds_read_b64_tr_b16 v[24:25], v10 offset:9216
    ds_read_b64_tr_b16 v[26:27], v10 offset:9600
    ds_read_b64_tr_b16 v[28:29], v10 offset:9248
    ds_read_b64_tr_b16 v[30:31], v10 offset:9632
    ds_read_b64_tr_b16 v[32:33], v10 offset:9280
    ds_read_b64_tr_b16 v[34:35], v10 offset:9664
    v_mfma_f32_32x32x16_bf16 v[64:79], v[36:39], v[204:207], v[64:79]
    buffer_load_dwordx4 v[168:171], v5, s[8:11], s25 offen offset:2048 sc1
    v_lshlrev_b32 v156, 16, v152
    v_and_b32 v157, s39, v152
    v_mfma_f32_32x32x16_bf16 v[80:95], v[40:43], v[200:203], v[80:95]
    s_waitcnt vmcnt(15)
    v_swap_b32 v210, v212
    v_swap_b32 v211, v213
    v_mfma_f32_32x32x16_bf16 v[96:111], v[40:43], v[204:207], v[96:111]
    buffer_load_dwordx4 v[172:175], v5, s[8:11], s25 offen offset:2560 sc1
    s_add_u32 s25, s25, 4096
    v_add_f32 v154, v154, v156
    v_fmac_f32 v155, v156, v156
    v_mfma_f32_32x32x16_bf16 v[112:127], v[44:47], v[200:203], v[112:127]
    v_add_f32 v154, v154, v157
    v_fmac_f32 v155, v157, v157
    v_lshlrev_b32 v156, 16, v153
    v_and_b32 v157, s39, v153
    v_add_f32 v154, v154, v156
    v_fmac_f32 v155, v156, v156
    v_mfma_f32_32x32x16_bf16 v[128:143], v[44:47], v[204:207], v[128:143]
    buffer_load_dwordx4 v[176:179], v5, s[8:11], s25 offen offset:0 sc1
    v_add_f32 v154, v154, v157
    s_waitcnt lgkmcnt(0)
    v_mfma_f32_32x32x16_bf16 v[48:63], v[24:27], v[208:211], v[48:63]
    ds_read_b64_tr_b16 v[36:37], v10 offset:10752
    ds_read_b64_tr_b16 v[38:39], v10 offset:11136
    ds_read_b64_tr_b16 v[40:41], v10 offset:10784
    ds_read_b64_tr_b16 v[42:43], v10 offset:11168
    ds_read_b64_tr_b16 v[44:45], v10 offset:10816
    ds_read_b64_tr_b16 v[46:47], v10 offset:11200
    v_mfma_f32_32x32x16_bf16 v[64:79], v[24:27], v[212:215], v[64:79]
    buffer_load_dwordx4 v[180:183], v5, s[8:11], s25 offen offset:512 sc1
    v_fmac_f32 v155, v157, v157
    s_lshl_b32 s22, s44, 12
    v_mfma_f32_32x32x16_bf16 v[80:95], v[28:31], v[208:211], v[80:95]
    s_waitcnt vmcnt(16)
    v_swap_b32 v218, v220
    v_swap_b32 v219, v221
    v_mfma_f32_32x32x16_bf16 v[96:111], v[28:31], v[212:215], v[96:111]
    buffer_load_dwordx4 v[184:187], v5, s[8:11], s25 offen offset:2048 sc1
    s_lshl_b32 s23, s3, 10
    v_add_f32_dpp v154, v154, v154 row_ror:8 row_mask:0xf bank_mask:0xf
    v_mfma_f32_32x32x16_bf16 v[112:127], v[32:35], v[208:211], v[112:127]
    v_add_f32_dpp v155, v155, v155 row_ror:8 row_mask:0xf bank_mask:0xf
    s_add_u32 s22, s22, s23
    v_mov_b32 v156, v154
    v_mov_b32 v157, v155
    s_lshl_b32 s23, s45, 6
    s_add_u32 s22, s22, s23
    v_mfma_f32_32x32x16_bf16 v[128:143], v[32:35], v[212:215], v[128:143]
    buffer_load_dwordx4 v[188:191], v5, s[8:11], s25 offen offset:2560 sc1
    s_add_u32 s25, s25, 4096
    s_waitcnt lgkmcnt(0)
    v_mfma_f32_32x32x16_bf16 v[48:63], v[36:39], v[216:219], v[48:63]
    ds_read_b64_tr_b16 v[24:25], v10 offset:12288
    ds_read_b64_tr_b16 v[26:27], v10 offset:12672
    ds_read_b64_tr_b16 v[28:29], v10 offset:12320
    ds_read_b64_tr_b16 v[30:31], v10 offset:12704
    ds_read_b64_tr_b16 v[32:33], v10 offset:12352
    ds_read_b64_tr_b16 v[34:35], v10 offset:12736
    v_mfma_f32_32x32x16_bf16 v[64:79], v[36:39], v[220:223], v[64:79]
    buffer_load_dwordx4 v[192:195], v5, s[8:11], s25 offen offset:0 sc1
    v_permlane16_swap_b32 v154, v156
    v_mfma_f32_32x32x16_bf16 v[80:95], v[40:43], v[216:219], v[80:95]
    s_waitcnt vmcnt(15)
    v_swap_b32 v226, v228
    v_swap_b32 v227, v229
    v_mfma_f32_32x32x16_bf16 v[96:111], v[40:43], v[220:223], v[96:111]
    buffer_load_dwordx4 v[196:199], v5, s[8:11], s25 offen offset:512 sc1
    v_permlane16_swap_b32 v155, v157
    v_mfma_f32_32x32x16_bf16 v[112:127], v[44:47], v[216:219], v[112:127]
    s_add_u32 s22, s22, 16236544
    v_lshl_add_u32 v7, v3, 9, v7
    v_add_f32 v154, v154, v156
    v_add_f32 v155, v155, v157
    s_mov_b32 exec_lo, 0xff
    s_mov_b32 exec_hi, 0xff
    s_cmp_eq_u32 s38, 0
    s_cbranch_scc1 L_wt_1010
    buffer_store_dwordx2 v[154:155], v7, s[8:11], s22 offen
L_wb_1011:
    s_mov_b64 exec, -1
    v_mfma_f32_32x32x16_bf16 v[128:143], v[44:47], v[220:223], v[128:143]
    buffer_load_dwordx4 v[200:203], v5, s[8:11], s25 offen offset:2048 sc1
    v_cmp_ne_u32 vcc, s96, v16
    s_nop 0
    s_mov_b64 s[34:35], vcc
    v_cmp_ne_u32 vcc, s96, v17
    s_nop 0
    s_or_b32 s34, s34, vcc_lo
    s_cmp_eq_u64 s[34:35], 0
    s_cbranch_scc0 L_cf_1012
L_cb_1013:
    s_waitcnt lgkmcnt(0)
    v_mfma_f32_32x32x16_bf16 v[48:63], v[24:27], v[224:227], v[48:63]
    ds_read_b64_tr_b16 v[36:37], v10 offset:13824
    ds_read_b64_tr_b16 v[38:39], v10 offset:14208
    ds_read_b64_tr_b16 v[40:41], v10 offset:13856
    ds_read_b64_tr_b16 v[42:43], v10 offset:14240
    ds_read_b64_tr_b16 v[44:45], v10 offset:13888
    ds_read_b64_tr_b16 v[46:47], v10 offset:14272
    v_mfma_f32_32x32x16_bf16 v[64:79], v[24:27], v[228:231], v[64:79]
    buffer_load_dwordx4 v[204:207], v5, s[8:11], s25 offen offset:2560 sc1
    s_add_u32 s25, s25, 4096
    v_mfma_f32_32x32x16_bf16 v[80:95], v[28:31], v[224:227], v[80:95]
    s_waitcnt vmcnt(17)
    v_swap_b32 v234, v236
    v_swap_b32 v235, v237
    v_mfma_f32_32x32x16_bf16 v[96:111], v[28:31], v[228:231], v[96:111]
    buffer_load_dwordx4 v[208:211], v5, s[8:11], s25 offen offset:0 sc1
    v_mfma_f32_32x32x16_bf16 v[112:127], v[32:35], v[224:227], v[112:127]
    v_mfma_f32_32x32x16_bf16 v[128:143], v[32:35], v[228:231], v[128:143]
    buffer_load_dwordx4 v[212:215], v5, s[8:11], s25 offen offset:512 sc1
    s_waitcnt lgkmcnt(0)
    v_mfma_f32_32x32x16_bf16 v[48:63], v[36:39], v[232:235], v[48:63]
    ds_read_b64_tr_b16 v[24:25], v10 offset:15360
    ds_read_b64_tr_b16 v[26:27], v10 offset:15744
    ds_read_b64_tr_b16 v[28:29], v10 offset:15392
    ds_read_b64_tr_b16 v[30:31], v10 offset:15776
    ds_read_b64_tr_b16 v[32:33], v10 offset:15424
    ds_read_b64_tr_b16 v[34:35], v10 offset:15808
    v_mfma_f32_32x32x16_bf16 v[64:79], v[36:39], v[236:239], v[64:79]
    buffer_load_dwordx4 v[216:219], v5, s[8:11], s25 offen offset:2048 sc1
    v_mfma_f32_32x32x16_bf16 v[80:95], v[40:43], v[232:235], v[80:95]
    s_waitcnt vmcnt(18)
    v_swap_b32 v242, v244
    v_swap_b32 v243, v245
    v_mfma_f32_32x32x16_bf16 v[96:111], v[40:43], v[236:239], v[96:111]
    buffer_load_dwordx4 v[220:223], v5, s[8:11], s25 offen offset:2560 sc1
    s_add_u32 s25, s25, 4096
    v_mfma_f32_32x32x16_bf16 v[112:127], v[44:47], v[232:235], v[112:127]
    v_mfma_f32_32x32x16_bf16 v[128:143], v[44:47], v[236:239], v[128:143]
    buffer_load_dwordx4 v[224:227], v5, s[8:11], s25 offen offset:0 sc1
    s_waitcnt lgkmcnt(0)
    v_mfma_f32_32x32x16_bf16 v[48:63], v[24:27], v[240:243], v[48:63]
    ds_read_b64_tr_b16 v[36:37], v10 offset:16896
    ds_read_b64_tr_b16 v[38:39], v10 offset:17280
    ds_read_b64_tr_b16 v[40:41], v10 offset:16928
    ds_read_b64_tr_b16 v[42:43], v10 offset:17312
    ds_read_b64_tr_b16 v[44:45], v10 offset:16960
    ds_read_b64_tr_b16 v[46:47], v10 offset:17344
    v_mfma_f32_32x32x16_bf16 v[64:79], v[24:27], v[244:247], v[64:79]
    buffer_load_dwordx4 v[228:231], v5, s[8:11], s25 offen offset:512 sc1
    v_mfma_f32_32x32x16_bf16 v[80:95], v[28:31], v[240:243], v[80:95]
    s_waitcnt vmcnt(19)
    v_swap_b32 v250, v252
    v_swap_b32 v251, v253
    v_mfma_f32_32x32x16_bf16 v[96:111], v[28:31], v[244:247], v[96:111]
    buffer_load_dwordx4 v[232:235], v5, s[8:11], s25 offen offset:2048 sc1
    v_mfma_f32_32x32x16_bf16 v[112:127], v[32:35], v[240:243], v[112:127]
    v_mfma_f32_32x32x16_bf16 v[128:143], v[32:35], v[244:247], v[128:143]
    buffer_load_dwordx4 v[236:239], v5, s[8:11], s25 offen offset:2560 sc1
    s_add_u32 s25, s25, 4096
    s_waitcnt lgkmcnt(0)
    v_mfma_f32_32x32x16_bf16 v[48:63], v[36:39], v[248:251], v[48:63]
    ds_read_b64_tr_b16 v[24:25], v10 offset:18432
    ds_read_b64_tr_b16 v[26:27], v10 offset:18816
    ds_read_b64_tr_b16 v[28:29], v10 offset:18464
    ds_read_b64_tr_b16 v[30:31], v10 offset:18848
    ds_read_b64_tr_b16 v[32:33], v10 offset:18496
    ds_read_b64_tr_b16 v[34:35], v10 offset:18880
    v_mfma_f32_32x32x16_bf16 v[64:79], v[36:39], v[252:255], v[64:79]
    buffer_load_dwordx4 v[240:243], v5, s[8:11], s25 offen offset:0 sc1
    v_mfma_f32_32x32x16_bf16 v[80:95], v[40:43], v[248:251], v[80:95]
    s_waitcnt vmcnt(20)
    v_swap_b32 v162, v164
    v_swap_b32 v163, v165
    v_mfma_f32_32x32x16_bf16 v[96:111], v[40:43], v[252:255], v[96:111]
    buffer_load_dwordx4 v[244:247], v5, s[8:11], s25 offen offset:512 sc1
    v_mfma_f32_32x32x16_bf16 v[112:127], v[44:47], v[248:251], v[112:127]
    v_mfma_f32_32x32x16_bf16 v[128:143], v[44:47], v[252:255], v[128:143]
    buffer_load_dwordx4 v[248:251], v5, s[8:11], s25 offen offset:2048 sc1
    s_waitcnt lgkmcnt(0)
    v_mfma_f32_32x32x16_bf16 v[48:63], v[24:27], v[160:163], v[48:63]
    ds_read_b64_tr_b16 v[36:37], v10 offset:19968
    ds_read_b64_tr_b16 v[38:39], v10 offset:20352
    ds_read_b64_tr_b16 v[40:41], v10 offset:20000
    ds_read_b64_tr_b16 v[42:43], v10 offset:20384
    ds_read_b64_tr_b16 v[44:45], v10 offset:20032
    ds_read_b64_tr_b16 v[46:47], v10 offset:20416
    v_mfma_f32_32x32x16_bf16 v[64:79], v[24:27], v[164:167], v[64:79]
    buffer_load_dwordx4 v[252:255], v5, s[8:11], s25 offen offset:2560 sc1
    s_add_u32 s25, s25, 4096
    v_mfma_f32_32x32x16_bf16 v[80:95], v[28:31], v[160:163], v[80:95]
    s_waitcnt vmcnt(21)
    v_swap_b32 v170, v172
    v_swap_b32 v171, v173
    v_mfma_f32_32x32x16_bf16 v[96:111], v[28:31], v[164:167], v[96:111]
    s_add_u32 s47, s46, s97
    buffer_load_dwordx4 a[0:3], v2, s[8:11], s47 offen offset:0 sc1
    v_mfma_f32_32x32x16_bf16 v[112:127], v[32:35], v[160:163], v[112:127]
    v_mfma_f32_32x32x16_bf16 v[128:143], v[32:35], v[164:167], v[128:143]
    buffer_load_dwordx4 v[160:163], v5, s[8:11], s25 offen offset:0 sc1
    s_waitcnt lgkmcnt(0)
    v_mfma_f32_32x32x16_bf16 v[48:63], v[36:39], v[168:171], v[48:63]
    ds_read_b64_tr_b16 v[24:25], v10 offset:21504
    ds_read_b64_tr_b16 v[26:27], v10 offset:21888
    ds_read_b64_tr_b16 v[28:29], v10 offset:21536
    ds_read_b64_tr_b16 v[30:31], v10 offset:21920
    ds_read_b64_tr_b16 v[32:33], v10 offset:21568
    ds_read_b64_tr_b16 v[34:35], v10 offset:21952
    v_mfma_f32_32x32x16_bf16 v[64:79], v[36:39], v[172:175], v[64:79]
    buffer_load_dwordx4 v[164:167], v5, s[8:11], s25 offen offset:512 sc1
    v_mfma_f32_32x32x16_bf16 v[80:95], v[40:43], v[168:171], v[80:95]
    s_waitcnt vmcnt(22)
    v_swap_b32 v178, v180
    v_swap_b32 v179, v181
    v_mfma_f32_32x32x16_bf16 v[96:111], v[40:43], v[172:175], v[96:111]
    buffer_load_dwordx4 a[4:7], v2, s[8:11], s47 offen offset:1024 sc1
    v_mfma_f32_32x32x16_bf16 v[112:127], v[44:47], v[168:171], v[112:127]
    v_mfma_f32_32x32x16_bf16 v[128:143], v[44:47], v[172:175], v[128:143]
    buffer_load_dwordx4 v[168:171], v5, s[8:11], s25 offen offset:2048 sc1
    s_waitcnt lgkmcnt(0)
    v_mfma_f32_32x32x16_bf16 v[48:63], v[24:27], v[176:179], v[48:63]
    ds_read_b64_tr_b16 v[36:37], v10 offset:23040
    ds_read_b64_tr_b16 v[38:39], v10 offset:23424
    ds_read_b64_tr_b16 v[40:41], v10 offset:23072
    ds_read_b64_tr_b16 v[42:43], v10 offset:23456
    ds_read_b64_tr_b16 v[44:45], v10 offset:23104
    ds_read_b64_tr_b16 v[46:47], v10 offset:23488
    v_mfma_f32_32x32x16_bf16 v[64:79], v[24:27], v[180:183], v[64:79]
    buffer_load_dwordx4 v[172:175], v5, s[8:11], s25 offen offset:2560 sc1
    s_add_u32 s25, s25, 4096
    v_mfma_f32_32x32x16_bf16 v[80:95], v[28:31], v[176:179], v[80:95]
    s_waitcnt vmcnt(23)
    v_swap_b32 v186, v188
    v_swap_b32 v187, v189
    v_mfma_f32_32x32x16_bf16 v[96:111], v[28:31], v[180:183], v[96:111]
    buffer_load_dwordx4 a[8:11], v2, s[8:11], s47 offen offset:2048 sc1
    v_mfma_f32_32x32x16_bf16 v[112:127], v[32:35], v[176:179], v[112:127]
    v_mfma_f32_32x32x16_bf16 v[128:143], v[32:35], v[180:183], v[128:143]
    buffer_load_dwordx4 v[176:179], v5, s[8:11], s25 offen offset:0 sc1
    s_waitcnt lgkmcnt(0)
    v_mfma_f32_32x32x16_bf16 v[48:63], v[36:39], v[184:187], v[48:63]
    ds_read_b64_tr_b16 v[24:25], v10 offset:24576
    ds_read_b64_tr_b16 v[26:27], v10 offset:24960
    ds_read_b64_tr_b16 v[28:29], v10 offset:24608
    ds_read_b64_tr_b16 v[30:31], v10 offset:24992
    ds_read_b64_tr_b16 v[32:33], v10 offset:24640
    ds_read_b64_tr_b16 v[34:35], v10 offset:25024
    v_mfma_f32_32x32x16_bf16 v[64:79], v[36:39], v[188:191], v[64:79]
    buffer_load_dwordx4 v[180:183], v5, s[8:11], s25 offen offset:512 sc1
    v_mfma_f32_32x32x16_bf16 v[80:95], v[40:43], v[184:187], v[80:95]
    s_waitcnt vmcnt(24)
    v_swap_b32 v194, v196
    v_swap_b32 v195, v197
    v_mfma_f32_32x32x16_bf16 v[96:111], v[40:43], v[188:191], v[96:111]
    buffer_load_dwordx4 a[12:15], v2, s[8:11], s47 offen offset:3072 sc1
    v_mfma_f32_32x32x16_bf16 v[112:127], v[44:47], v[184:187], v[112:127]
    v_mfma_f32_32x32x16_bf16 v[128:143], v[44:47], v[188:191], v[128:143]
    buffer_load_dwordx4 v[184:187], v5, s[8:11], s25 offen offset:2048 sc1
    s_waitcnt lgkmcnt(0)
    v_mfma_f32_32x32x16_bf16 v[48:63], v[24:27], v[192:195], v[48:63]
    ds_read_b64_tr_b16 v[36:37], v10 offset:26112
    ds_read_b64_tr_b16 v[38:39], v10 offset:26496
    ds_read_b64_tr_b16 v[40:41], v10 offset:26144
    ds_read_b64_tr_b16 v[42:43], v10 offset:26528
    ds_read_b64_tr_b16 v[44:45], v10 offset:26176
    ds_read_b64_tr_b16 v[46:47], v10 offset:26560
    v_mfma_f32_32x32x16_bf16 v[64:79], v[24:27], v[196:199], v[64:79]
    buffer_load_dwordx4 v[188:191], v5, s[8:11], s25 offen offset:2560 sc1
    s_add_u32 s25, s25, 4096
    v_mfma_f32_32x32x16_bf16 v[80:95], v[28:31], v[192:195], v[80:95]
    s_waitcnt vmcnt(24)
    v_swap_b32 v202, v204
    v_swap_b32 v203, v205
    v_mfma_f32_32x32x16_bf16 v[96:111], v[28:31], v[196:199], v[96:111]
    buffer_load_dwordx4 a[16:19], v0, s[8:11], s47 offen sc1
    v_mfma_f32_32x32x16_bf16 v[112:127], v[32:35], v[192:195], v[112:127]
    v_mfma_f32_32x32x16_bf16 v[128:143], v[32:35], v[196:199], v[128:143]
    buffer_load_dwordx4 v[192:195], v5, s[8:11], s25 offen offset:0 sc1
    s_waitcnt lgkmcnt(0)
    v_mfma_f32_32x32x16_bf16 v[48:63], v[36:39], v[200:203], v[48:63]
    ds_read_b64_tr_b16 v[24:25], v10 offset:27648
    ds_read_b64_tr_b16 v[26:27], v10 offset:28032
    ds_read_b64_tr_b16 v[28:29], v10 offset:27680
    ds_read_b64_tr_b16 v[30:31], v10 offset:28064
    ds_read_b64_tr_b16 v[32:33], v10 offset:27712
    ds_read_b64_tr_b16 v[34:35], v10 offset:28096
    v_mfma_f32_32x32x16_bf16 v[64:79], v[36:39], v[204:207], v[64:79]
    buffer_load_dwordx4 v[196:199], v5, s[8:11], s25 offen offset:512 sc1
    v_mfma_f32_32x32x16_bf16 v[80:95], v[40:43], v[200:203], v[80:95]
    s_waitcnt vmcnt(25)
    v_swap_b32 v210, v212
    v_swap_b32 v211, v213
    v_mfma_f32_32x32x16_bf16 v[96:111], v[40:43], v[204:207], v[96:111]
    s_add_u32 s47, s46, s97
    s_add_u32 s47, s47, 20480
    buffer_load_dwordx4 a[80:83], v2, s[8:11], s47 offen offset:0 sc1
    v_mfma_f32_32x32x16_bf16 v[112:127], v[44:47], v[200:203], v[112:127]
    v_mfma_f32_32x32x16_bf16 v[128:143], v[44:47], v[204:207], v[128:143]
    buffer_load_dwordx4 v[200:203], v5, s[8:11], s25 offen offset:2048 sc1
    s_waitcnt lgkmcnt(0)
    v_mfma_f32_32x32x16_bf16 v[48:63], v[24:27], v[208:211], v[48:63]
    ds_read_b64_tr_b16 v[36:37], v10 offset:29184
    ds_read_b64_tr_b16 v[38:39], v10 offset:29568
    ds_read_b64_tr_b16 v[40:41], v10 offset:29216
    ds_read_b64_tr_b16 v[42:43], v10 offset:29600
    ds_read_b64_tr_b16 v[44:45], v10 offset:29248
    ds_read_b64_tr_b16 v[46:47], v10 offset:29632
    v_mfma_f32_32x32x16_bf16 v[64:79], v[24:27], v[212:215], v[64:79]
    buffer_load_dwordx4 v[204:207], v5, s[8:11], s25 offen offset:2560 sc1
    s_add_u32 s25, s25, 4096
    v_mfma_f32_32x32x16_bf16 v[80:95], v[28:31], v[208:211], v[80:95]
    s_waitcnt vmcnt(26)
    v_swap_b32 v218, v220
    v_swap_b32 v219, v221
    v_mfma_f32_32x32x16_bf16 v[96:111], v[28:31], v[212:215], v[96:111]
    buffer_load_dwordx4 a[84:87], v2, s[8:11], s47 offen offset:1024 sc1
    v_mfma_f32_32x32x16_bf16 v[112:127], v[32:35], v[208:211], v[112:127]
    v_mfma_f32_32x32x16_bf16 v[128:143], v[32:35], v[212:215], v[128:143]
    buffer_load_dwordx4 v[208:211], v5, s[8:11], s25 offen offset:0 sc1
    s_waitcnt lgkmcnt(0)
    v_mfma_f32_32x32x16_bf16 v[48:63], v[36:39], v[216:219], v[48:63]
    ds_read_b64_tr_b16 v[24:25], v10 offset:30720
    ds_read_b64_tr_b16 v[26:27], v10 offset:31104
    ds_read_b64_tr_b16 v[28:29], v10 offset:30752
    ds_read_b64_tr_b16 v[30:31], v10 offset:31136
    ds_read_b64_tr_b16 v[32:33], v10 offset:30784
    ds_read_b64_tr_b16 v[34:35], v10 offset:31168
    v_mfma_f32_32x32x16_bf16 v[64:79], v[36:39], v[220:223], v[64:79]
    buffer_load_dwordx4 v[212:215], v5, s[8:11], s25 offen offset:512 sc1
    v_mfma_f32_32x32x16_bf16 v[80:95], v[40:43], v[216:219], v[80:95]
    s_waitcnt vmcnt(27)
    v_swap_b32 v226, v228
    v_swap_b32 v227, v229
    v_mfma_f32_32x32x16_bf16 v[96:111], v[40:43], v[220:223], v[96:111]
    buffer_load_dwordx4 a[88:91], v2, s[8:11], s47 offen offset:2048 sc1
    v_mfma_f32_32x32x16_bf16 v[112:127], v[44:47], v[216:219], v[112:127]
    v_mfma_f32_32x32x16_bf16 v[128:143], v[44:47], v[220:223], v[128:143]
    buffer_load_dwordx4 v[216:219], v5, s[8:11], s25 offen offset:2048 sc1
    s_waitcnt lgkmcnt(0)
    v_mfma_f32_32x32x16_bf16 v[48:63], v[24:27], v[224:227], v[48:63]
    ds_read_b64_tr_b16 v[36:37], v10 offset:32256
    ds_read_b64_tr_b16 v[38:39], v10 offset:32640
    ds_read_b64_tr_b16 v[40:41], v10 offset:32288
    ds_read_b64_tr_b16 v[42:43], v10 offset:32672
    ds_read_b64_tr_b16 v[44:45], v10 offset:32320
    ds_read_b64_tr_b16 v[46:47], v10 offset:32704
    v_mfma_f32_32x32x16_bf16 v[64:79], v[24:27], v[228:231], v[64:79]
    buffer_load_dwordx4 v[220:223], v5, s[8:11], s25 offen offset:2560 sc1
    s_add_u32 s25, s25, 4096
    v_mfma_f32_32x32x16_bf16 v[80:95], v[28:31], v[224:227], v[80:95]
    s_waitcnt vmcnt(28)
    v_swap_b32 v234, v236
    v_swap_b32 v235, v237
    v_mfma_f32_32x32x16_bf16 v[96:111], v[28:31], v[228:231], v[96:111]
    buffer_load_dwordx4 a[92:95], v2, s[8:11], s47 offen offset:3072 sc1
    v_mfma_f32_32x32x16_bf16 v[112:127], v[32:35], v[224:227], v[112:127]
    v_mfma_f32_32x32x16_bf16 v[128:143], v[32:35], v[228:231], v[128:143]
    buffer_load_dwordx4 v[224:227], v5, s[8:11], s25 offen offset:0 sc1
    s_waitcnt lgkmcnt(0)
    v_mfma_f32_32x32x16_bf16 v[48:63], v[36:39], v[232:235], v[48:63]
    ds_read_b64_tr_b16 v[24:25], v10 offset:33792
    ds_read_b64_tr_b16 v[26:27], v10 offset:34176
    ds_read_b64_tr_b16 v[28:29], v10 offset:33824
    ds_read_b64_tr_b16 v[30:31], v10 offset:34208
    ds_read_b64_tr_b16 v[32:33], v10 offset:33856
    ds_read_b64_tr_b16 v[34:35], v10 offset:34240
    v_mfma_f32_32x32x16_bf16 v[64:79], v[36:39], v[236:239], v[64:79]
    buffer_load_dwordx4 v[228:231], v5, s[8:11], s25 offen offset:512 sc1
    v_mfma_f32_32x32x16_bf16 v[80:95], v[40:43], v[232:235], v[80:95]
    s_waitcnt vmcnt(29)
    v_swap_b32 v242, v244
    v_swap_b32 v243, v245
    v_mfma_f32_32x32x16_bf16 v[96:111], v[40:43], v[236:239], v[96:111]
    buffer_load_dwordx4 v[144:147], v6, s[8:11], s26 offen offset:0 sc1
    v_mfma_f32_32x32x16_bf16 v[112:127], v[44:47], v[232:235], v[112:127]
    v_mfma_f32_32x32x16_bf16 v[128:143], v[44:47], v[236:239], v[128:143]
    buffer_load_dwordx4 v[232:235], v5, s[8:11], s25 offen offset:2048 sc1
    s_waitcnt lgkmcnt(0)
    v_mfma_f32_32x32x16_bf16 v[48:63], v[24:27], v[240:243], v[48:63]
    ds_read_b64_tr_b16 v[36:37], v10 offset:35328
    ds_read_b64_tr_b16 v[38:39], v10 offset:35712
    ds_read_b64_tr_b16 v[40:41], v10 offset:35360
    ds_read_b64_tr_b16 v[42:43], v10 offset:35744
    ds_read_b64_tr_b16 v[44:45], v10 offset:35392
    ds_read_b64_tr_b16 v[46:47], v10 offset:35776
    v_mfma_f32_32x32x16_bf16 v[64:79], v[24:27], v[244:247], v[64:79]
    buffer_load_dwordx4 v[236:239], v5, s[8:11], s25 offen offset:2560 sc1
    s_add_u32 s25, s25, 4096
    v_mfma_f32_32x32x16_bf16 v[80:95], v[28:31], v[240:243], v[80:95]
    s_waitcnt vmcnt(30)
    v_swap_b32 v250, v252
    v_swap_b32 v251, v253
    v_mfma_f32_32x32x16_bf16 v[96:111], v[28:31], v[244:247], v[96:111]
    buffer_load_dwordx4 v[148:151], v6, s[8:11], s26 offen offset:512 sc1
    v_mfma_f32_32x32x16_bf16 v[112:127], v[32:35], v[240:243], v[112:127]
    v_mfma_f32_32x32x16_bf16 v[128:143], v[32:35], v[244:247], v[128:143]
    buffer_load_dwordx4 v[240:243], v5, s[8:11], s25 offen offset:0 sc1
    s_waitcnt lgkmcnt(0)
    v_mfma_f32_32x32x16_bf16 v[48:63], v[36:39], v[248:251], v[48:63]
    ds_read_b64_tr_b16 v[24:25], v10 offset:36864
    ds_read_b64_tr_b16 v[26:27], v10 offset:37248
    ds_read_b64_tr_b16 v[28:29], v10 offset:36896
    ds_read_b64_tr_b16 v[30:31], v10 offset:37280
    ds_read_b64_tr_b16 v[32:33], v10 offset:36928
    ds_read_b64_tr_b16 v[34:35], v10 offset:37312
    v_mfma_f32_32x32x16_bf16 v[64:79], v[36:39], v[252:255], v[64:79]
    buffer_load_dwordx4 v[244:247], v5, s[8:11], s25 offen offset:512 sc1
    v_mfma_f32_32x32x16_bf16 v[80:95], v[40:43], v[248:251], v[80:95]
    s_waitcnt vmcnt(30)
    v_swap_b32 v162, v164
    v_swap_b32 v163, v165
    v_mfma_f32_32x32x16_bf16 v[96:111], v[40:43], v[252:255], v[96:111]
    buffer_load_dwordx4 v[152:155], v6, s[8:11], s26 offen offset:1024 sc1
    v_mfma_f32_32x32x16_bf16 v[112:127], v[44:47], v[248:251], v[112:127]
    v_mfma_f32_32x32x16_bf16 v[128:143], v[44:47], v[252:255], v[128:143]
    buffer_load_dwordx4 v[156:159], v6, s[8:11], s26 offen offset:1536 sc1
    s_waitcnt lgkmcnt(0)
    v_mfma_f32_32x32x16_bf16 v[48:63], v[24:27], v[160:163], v[48:63]
    ds_read_b64_tr_b16 v[36:37], v10 offset:38400
    ds_read_b64_tr_b16 v[38:39], v10 offset:38784
    ds_read_b64_tr_b16 v[40:41], v10 offset:38432
    ds_read_b64_tr_b16 v[42:43], v10 offset:38816
    ds_read_b64_tr_b16 v[44:45], v10 offset:38464
    ds_read_b64_tr_b16 v[46:47], v10 offset:38848
    v_mfma_f32_32x32x16_bf16 v[64:79], v[24:27], v[164:167], v[64:79]
    buffer_load_dwordx4 v[248:251], v5, s[8:11], s25 offen offset:2048 sc1
    v_mfma_f32_32x32x16_bf16 v[80:95], v[28:31], v[160:163], v[80:95]
    s_waitcnt vmcnt(30)
    v_swap_b32 v170, v172
    v_swap_b32 v171, v173
    v_mfma_f32_32x32x16_bf16 v[96:111], v[28:31], v[164:167], v[96:111]
    buffer_load_dwordx4 v[252:255], v5, s[8:11], s25 offen offset:2560 sc1
    s_add_u32 s25, s25, 4096
    v_mfma_f32_32x32x16_bf16 v[112:127], v[32:35], v[160:163], v[112:127]
    v_mfma_f32_32x32x16_bf16 v[128:143], v[32:35], v[164:167], v[128:143]
    buffer_load_dwordx4 v[160:163], v5, s[8:11], s25 offen offset:0 sc1
    s_waitcnt lgkmcnt(0)
    v_mfma_f32_32x32x16_bf16 v[48:63], v[36:39], v[168:171], v[48:63]
    ds_read_b64_tr_b16 v[24:25], v10 offset:39936
    ds_read_b64_tr_b16 v[26:27], v10 offset:40320
    ds_read_b64_tr_b16 v[28:29], v10 offset:39968
    ds_read_b64_tr_b16 v[30:31], v10 offset:40352
    ds_read_b64_tr_b16 v[32:33], v10 offset:40000
    ds_read_b64_tr_b16 v[34:35], v10 offset:40384
    v_mfma_f32_32x32x16_bf16 v[64:79], v[36:39], v[172:175], v[64:79]
    buffer_load_dwordx4 v[164:167], v5, s[8:11], s25 offen offset:512 sc1
    v_mfma_f32_32x32x16_bf16 v[80:95], v[40:43], v[168:171], v[80:95]
    s_waitcnt vmcnt(30)
    v_swap_b32 v178, v180
    v_swap_b32 v179, v181
    v_mfma_f32_32x32x16_bf16 v[96:111], v[40:43], v[172:175], v[96:111]
    buffer_load_dwordx4 a[96:99], v0, s[8:11], s47 offen sc1
    v_mfma_f32_32x32x16_bf16 v[112:127], v[44:47], v[168:171], v[112:127]
    v_mfma_f32_32x32x16_bf16 v[128:143], v[44:47], v[172:175], v[128:143]
    buffer_load_dwordx4 v[168:171], v5, s[8:11], s25 offen offset:2048 sc1
    s_waitcnt lgkmcnt(0)
    v_mfma_f32_32x32x16_bf16 v[48:63], v[24:27], v[176:179], v[48:63]
    ds_read_b64_tr_b16 v[36:37], v10 offset:41472
    ds_read_b64_tr_b16 v[38:39], v10 offset:41856
    ds_read_b64_tr_b16 v[40:41], v10 offset:41504
    ds_read_b64_tr_b16 v[42:43], v10 offset:41888
    ds_read_b64_tr_b16 v[44:45], v10 offset:41536
    ds_read_b64_tr_b16 v[46:47], v10 offset:41920
    v_mfma_f32_32x32x16_bf16 v[64:79], v[24:27], v[180:183], v[64:79]
    buffer_load_dwordx4 v[172:175], v5, s[8:11], s25 offen offset:2560 sc1
    s_add_u32 s25, s25, 4096
    v_mfma_f32_32x32x16_bf16 v[80:95], v[28:31], v[176:179], v[80:95]
    s_waitcnt vmcnt(30)
    v_swap_b32 v186, v188
    v_swap_b32 v187, v189
    v_mfma_f32_32x32x16_bf16 v[96:111], v[28:31], v[180:183], v[96:111]
    s_add_u32 s47, s46, s97
    s_add_u32 s47, s47, 40960
    buffer_load_dwordx4 a[160:163], v2, s[8:11], s47 offen offset:0 sc1
    v_mfma_f32_32x32x16_bf16 v[112:127], v[32:35], v[176:179], v[112:127]
    v_mfma_f32_32x32x16_bf16 v[128:143], v[32:35], v[180:183], v[128:143]
    buffer_load_dwordx4 v[176:179], v5, s[8:11], s25 offen offset:0 sc1
    s_waitcnt lgkmcnt(0)
    v_mfma_f32_32x32x16_bf16 v[48:63], v[36:39], v[184:187], v[48:63]
    v_mfma_f32_32x32x16_bf16 v[64:79], v[36:39], v[188:191], v[64:79]
    buffer_load_dwordx4 v[180:183], v5, s[8:11], s25 offen offset:512 sc1
    v_mfma_f32_32x32x16_bf16 v[80:95], v[40:43], v[184:187], v[80:95]
    s_waitcnt vmcnt(30)
    v_swap_b32 v194, v196
    v_swap_b32 v195, v197
    v_mfma_f32_32x32x16_bf16 v[96:111], v[40:43], v[188:191], v[96:111]
    buffer_load_dwordx4 a[164:167], v2, s[8:11], s47 offen offset:1024 sc1
    v_mfma_f32_32x32x16_bf16 v[112:127], v[44:47], v[184:187], v[112:127]
    v_mfma_f32_32x32x16_bf16 v[128:143], v[44:47], v[188:191], v[128:143]
    buffer_load_dwordx4 v[184:187], v5, s[8:11], s25 offen offset:2048 sc1
    s_barrier
    ds_read_b64_tr_b16 v[24:25], v10 offset:43008
    ds_read_b64_tr_b16 v[26:27], v10 offset:43392
    ds_read_b64_tr_b16 v[28:29], v10 offset:44544
    ds_read_b64_tr_b16 v[30:31], v10 offset:44928
    ds_read_b64_tr_b16 v[32:33], v10 offset:46080
    ds_read_b64_tr_b16 v[34:35], v10 offset:46464
    s_waitcnt lgkmcnt(4)
    v_mfma_f32_32x32x16_bf16 v[48:63], v[24:27], v[192:195], v[48:63]
    ds_read_b64_tr_b16 v[36:37], v10 offset:47616
    ds_read_b64_tr_b16 v[38:39], v10 offset:48000
    s_waitcnt vmcnt(29)
    v_swap_b32 v202, v204
    v_swap_b32 v203, v205
    v_mfma_f32_32x32x16_bf16 v[64:79], v[24:27], v[196:199], v[64:79]
    buffer_load_dwordx4 v[188:191], v5, s[8:11], s25 offen offset:2560 sc1
    s_add_u32 s25, s25, 4096
    s_waitcnt vmcnt(13)
    v_max_u32 v18, v145, v147
    v_max3_u32 v18, v18, v149, v151
    s_waitcnt lgkmcnt(4)
    v_mfma_f32_32x32x16_bf16 v[48:63], v[28:31], v[200:203], v[48:63]
    ds_read_b64_tr_b16 v[24:25], v10 offset:49152
    ds_read_b64_tr_b16 v[26:27], v10 offset:49536
    v_swap_b32 v210, v212
    v_swap_b32 v211, v213
    v_mfma_f32_32x32x16_bf16 v[64:79], v[28:31], v[204:207], v[64:79]
    buffer_load_dwordx4 a[168:171], v2, s[8:11], s47 offen offset:2048 sc1
    v_max3_u32 v18, v18, v153, v155
    v_max3_u32 v18, v18, v157, v159
    v_cmp_eq_u32 vcc, -1, v18
    s_cbranch_vccnz L_stspin_1014
L_stback_1015:
    s_waitcnt lgkmcnt(4)
    v_mfma_f32_32x32x16_bf16 v[48:63], v[32:35], v[208:211], v[48:63]
    ds_read_b64_tr_b16 v[28:29], v10 offset:50688
    ds_read_b64_tr_b16 v[30:31], v10 offset:51072
    v_swap_b32 v218, v220
    v_swap_b32 v219, v221
    v_mfma_f32_32x32x16_bf16 v[64:79], v[32:35], v[212:215], v[64:79]
    buffer_load_dwordx4 a[172:175], v2, s[8:11], s47 offen offset:3072 sc1
    v_add_f32 v144, v144, v148
    v_add_f32 v152, v152, v156
    v_add_f32 v145, v145, v149
    s_waitcnt lgkmcnt(4)
    v_mfma_f32_32x32x16_bf16 v[48:63], v[36:39], v[216:219], v[48:63]
    ds_read_b64_tr_b16 v[32:33], v10 offset:52224
    ds_read_b64_tr_b16 v[34:35], v10 offset:52608
    v_swap_b32 v226, v228
    v_swap_b32 v227, v229
    v_mfma_f32_32x32x16_bf16 v[64:79], v[36:39], v[220:223], v[64:79]
    buffer_load_dwordx4 a[176:179], v0, s[8:11], s47 offen sc1
    v_add_f32 v153, v153, v157
    v_add_f32 v146, v146, v150
    v_add_f32 v154, v154, v158
    s_waitcnt lgkmcnt(4)
    v_mfma_f32_32x32x16_bf16 v[48:63], v[24:27], v[224:227], v[48:63]
    ds_read_b64_tr_b16 v[36:37], v10 offset:53760
    ds_read_b64_tr_b16 v[38:39], v10 offset:54144
    v_swap_b32 v234, v236
    v_swap_b32 v235, v237
    v_mfma_f32_32x32x16_bf16 v[64:79], v[24:27], v[228:231], v[64:79]
    s_add_u32 s47, s46, s98
    buffer_load_dwordx4 a[20:23], v2, s[8:11], s47 offen offset:0 sc1
    v_add_f32 v147, v147, v151
    v_add_f32 v155, v155, v159
    v_add_f32 v144, v144, v152
    s_waitcnt lgkmcnt(4)
    v_mfma_f32_32x32x16_bf16 v[48:63], v[28:31], v[232:235], v[48:63]
    ds_read_b64_tr_b16 v[24:25], v10 offset:55296
    ds_read_b64_tr_b16 v[26:27], v10 offset:55680
    v_swap_b32 v242, v244
    v_swap_b32 v243, v245
    v_mfma_f32_32x32x16_bf16 v[64:79], v[28:31], v[236:239], v[64:79]
    buffer_load_dwordx4 a[24:27], v2, s[8:11], s47 offen offset:1024 sc1
    v_add_f32 v145, v145, v153
    v_add_f32 v146, v146, v154
    v_add_f32 v147, v147, v155
    s_waitcnt lgkmcnt(4)
    v_mfma_f32_32x32x16_bf16 v[48:63], v[32:35], v[240:243], v[48:63]
    ds_read_b64_tr_b16 v[28:29], v10 offset:56832
    ds_read_b64_tr_b16 v[30:31], v10 offset:57216
    s_waitcnt vmcnt(16)
    v_swap_b32 v250, v252
    v_swap_b32 v251, v253
    v_mfma_f32_32x32x16_bf16 v[64:79], v[32:35], v[244:247], v[64:79]
    buffer_load_dwordx4 a[28:31], v2, s[8:11], s47 offen offset:2048 sc1
    v_mov_b32 v148, v144
    v_mov_b32 v149, v145
    v_mov_b32 v150, v146
    s_waitcnt lgkmcnt(4)
    v_mfma_f32_32x32x16_bf16 v[48:63], v[36:39], v[248:251], v[48:63]
    ds_read_b64_tr_b16 v[32:33], v10 offset:58368
    ds_read_b64_tr_b16 v[34:35], v10 offset:58752
    s_waitcnt vmcnt(15)
    v_swap_b32 v162, v164
    v_swap_b32 v163, v165
    v_mfma_f32_32x32x16_bf16 v[64:79], v[36:39], v[252:255], v[64:79]
    buffer_load_dwordx4 a[32:35], v2, s[8:11], s47 offen offset:3072 sc1
    v_mov_b32 v151, v147
    v_permlane32_swap_b32 v144, v148
    s_waitcnt lgkmcnt(4)
    v_mfma_f32_32x32x16_bf16 v[48:63], v[24:27], v[160:163], v[48:63]
    ds_read_b64_tr_b16 v[36:37], v10 offset:59904
    ds_read_b64_tr_b16 v[38:39], v10 offset:60288
    s_waitcnt vmcnt(13)
    v_swap_b32 v170, v172
    v_swap_b32 v171, v173
    v_mfma_f32_32x32x16_bf16 v[64:79], v[24:27], v[164:167], v[64:79]
    buffer_load_dwordx4 a[36:39], v0, s[8:11], s47 offen sc1
    v_permlane32_swap_b32 v145, v149
    s_waitcnt lgkmcnt(4)
    v_mfma_f32_32x32x16_bf16 v[48:63], v[28:31], v[168:171], v[48:63]
    s_waitcnt vmcnt(11)
    v_swap_b32 v178, v180
    v_swap_b32 v179, v181
    v_mfma_f32_32x32x16_bf16 v[64:79], v[28:31], v[172:175], v[64:79]
    s_add_u32 s47, s46, s99
    buffer_load_dwordx4 a[40:43], v2, s[8:11], s47 offen offset:0 sc1
    v_permlane32_swap_b32 v146, v150
    s_waitcnt lgkmcnt(2)
    v_mfma_f32_32x32x16_bf16 v[48:63], v[32:35], v[176:179], v[48:63]
    ds_read_b64_tr_b16 v[28:29], v10 offset:43040
    ds_read_b64_tr_b16 v[30:31], v10 offset:43424
    s_waitcnt vmcnt(9)
    v_swap_b32 v186, v188
    v_swap_b32 v187, v189
    v_mfma_f32_32x32x16_bf16 v[64:79], v[32:35], v[180:183], v[64:79]
    buffer_load_dwordx4 a[44:47], v2, s[8:11], s47 offen offset:1024 sc1
    v_permlane32_swap_b32 v147, v151
    v_add_f32 v144, v144, v148
    s_waitcnt lgkmcnt(2)
    v_mfma_f32_32x32x16_bf16 v[48:63], v[36:39], v[184:187], v[48:63]
    ds_read_b64_tr_b16 v[32:33], v10 offset:44576
    ds_read_b64_tr_b16 v[34:35], v10 offset:44960
    buffer_load_dwordx4 a[48:51], v2, s[8:11], s47 offen offset:2048 sc1
    v_add_f32 v145, v145, v149
    v_add_f32 v146, v146, v150
    v_add_f32 v147, v147, v151
    v_mfma_f32_32x32x16_bf16 v[64:79], v[36:39], v[188:191], v[64:79]
    buffer_load_dwordx4 a[52:55], v2, s[8:11], s47 offen offset:3072 sc1
    v_mul_f32 v148, 0x3acccccd, v144
    v_mul_f32 v150, 0x3acccccd, v146
    v_mul_f32 v149, 0x3acccccd, v145
    v_mul_f32 v151, 0x3acccccd, v147
    v_fma_f32 v149, -v148, v148, v149
    v_fma_f32 v151, -v150, v150, v151
    v_max_f32 v149, 0, v149
    v_max_f32 v151, 0, v151
    v_cvt_pk_bf16_f32 v40, -v148, -v148
    v_cvt_pk_bf16_f32 v44, -v150, -v150
    v_cvt_pk_bf16_f32 v149, v149, v149
    v_cvt_pk_bf16_f32 v151, v151, v151
    v_lshlrev_b32 v149, 16, v149
    v_lshlrev_b32 v151, 16, v151
    v_and_b32 v41, 0xffff, v40
    v_and_b32 v45, 0xffff, v44
    v_add_f32 v149, 0x3727c5ac, v149
    v_add_f32 v151, 0x3727c5ac, v151
    v_cvt_pk_bf16_f32 v149, v149, v149
    v_cvt_pk_bf16_f32 v151, v151, v151
    v_lshlrev_b32 v149, 16, v149
    v_lshlrev_b32 v151, 16, v151
    v_sqrt_f32 v149, v149
    v_sqrt_f32 v151, v151
    v_mov_b32 v42, v40
    v_mov_b32 v46, v44
    v_cvt_pk_bf16_f32 v149, v149, v149
    v_cvt_pk_bf16_f32 v151, v151, v151
    v_lshlrev_b32 v149, 16, v149
    v_lshlrev_b32 v151, 16, v151
    v_mul_f32 v16, v149, v149
    v_mul_f32 v17, v151, v151
    v_rcp_f32 v149, v149
    v_rcp_f32 v151, v151
    v_mov_b32 v43, v41
    v_mov_b32 v47, v45
    v_mul_f32 v12, 0xc0135761, v149
    v_mul_f32 v13, 0xc0135761, v151
    v_mul_f32 v14, v149, v149
    v_mul_f32 v15, v151, v151
    v_mul_f32 v149, 0xbdd2d3e8, v149
    v_mul_f32 v151, 0xbdd2d3e8, v151
    v_mul_f32 v14, v14, v149
    v_mul_f32 v15, v15, v151
    s_lshl_b32 s29, s24, 2
    s_lshr_b32 s34, s21, 3
    s_add_u32 s29, s29, s34
    s_lshl_b32 s29, s29, 7
    s_add_u32 s29, s29, 16629760
    s_lshl_b32 s34, s45, 2
    v_mov_b32 v8, s34
    v_mov_b32 v9, s96
    s_lshl_b32 s36, s44, 2
    s_add_u32 s36, s36, s3
    s_lshl_b32 s36, s36, 7
    s_add_u32 s36, s36, 16629760
    v_mfma_f32_32x32x16_bf16 v[48:63], a[240:243], v[40:43], v[48:63]
    ds_read_b64_tr_b16 v[36:37], v10 offset:46112
    ds_read_b64_tr_b16 v[38:39], v10 offset:46496
    buffer_load_dwordx4 a[56:59], v0, s[8:11], s47 offen sc1
    v_mfma_f32_32x32x16_bf16 v[64:79], a[240:243], v[44:47], v[64:79]
    s_add_u32 s47, s46, s100
    buffer_load_dwordx4 a[60:63], v2, s[8:11], s47 offen offset:0 sc1
    s_waitcnt lgkmcnt(4)
    v_mfma_f32_32x32x16_bf16 v[80:95], v[28:31], v[192:195], v[80:95]
    ds_read_b64_tr_b16 v[24:25], v10 offset:47648
    ds_read_b64_tr_b16 v[26:27], v10 offset:48032
    buffer_load_dwordx4 a[64:67], v2, s[8:11], s47 offen offset:1024 sc1
    s_nop 3
    v_mul_f32 v144, v48, v48
    v_mul_f32 v145, v49, v49
    v_mfma_f32_32x32x16_bf16 v[96:111], v[28:31], v[196:199], v[96:111]
    buffer_load_dwordx4 a[68:71], v2, s[8:11], s47 offen offset:2048 sc1
    v_mul_f32 v146, v50, v50
    v_mul_f32 v147, v51, v51
    v_mul_f32 v148, v52, v52
    s_waitcnt lgkmcnt(4)
    v_mfma_f32_32x32x16_bf16 v[80:95], v[32:35], v[200:203], v[80:95]
    ds_read_b64_tr_b16 v[28:29], v10 offset:49184
    ds_read_b64_tr_b16 v[30:31], v10 offset:49568
    buffer_load_dwordx4 a[72:75], v2, s[8:11], s47 offen offset:3072 sc1
    v_mul_f32 v149, v53, v53
    v_mul_f32 v150, v54, v54
    v_mul_f32 v151, v55, v55
    v_mfma_f32_32x32x16_bf16 v[96:111], v[32:35], v[204:207], v[96:111]
    buffer_load_dwordx4 a[76:79], v0, s[8:11], s47 offen sc1
    v_fma_f32 v144, v144, v14, v12
    v_fma_f32 v145, v145, v14, v12
    v_fma_f32 v146, v146, v14, v12
    s_waitcnt lgkmcnt(4)
    v_mfma_f32_32x32x16_bf16 v[80:95], v[36:39], v[208:211], v[80:95]
    ds_read_b64_tr_b16 v[32:33], v10 offset:50720
    ds_read_b64_tr_b16 v[34:35], v10 offset:51104
    s_add_u32 s47, s46, s98
    s_add_u32 s47, s47, 20480
    buffer_load_dwordx4 a[100:103], v2, s[8:11], s47 offen offset:0 sc1
    v_fma_f32 v147, v147, v14, v12
    v_fma_f32 v148, v148, v14, v12
    v_fma_f32 v149, v149, v14, v12
    v_mfma_f32_32x32x16_bf16 v[96:111], v[36:39], v[212:215], v[96:111]
    buffer_load_dwordx4 a[104:107], v2, s[8:11], s47 offen offset:1024 sc1
    v_fma_f32 v150, v150, v14, v12
    v_fma_f32 v151, v151, v14, v12
    v_mul_f32 v144, v144, v48
    s_waitcnt lgkmcnt(4)
    v_mfma_f32_32x32x16_bf16 v[80:95], v[24:27], v[216:219], v[80:95]
    ds_read_b64_tr_b16 v[36:37], v10 offset:52256
    ds_read_b64_tr_b16 v[38:39], v10 offset:52640
    buffer_load_dwordx4 a[108:111], v2, s[8:11], s47 offen offset:2048 sc1
    v_mul_f32 v145, v145, v49
    v_mul_f32 v146, v146, v50
    v_mul_f32 v147, v147, v51
    v_mfma_f32_32x32x16_bf16 v[96:111], v[24:27], v[220:223], v[96:111]
    buffer_load_dwordx4 a[112:115], v2, s[8:11], s47 offen offset:3072 sc1
    v_mul_f32 v148, v148, v52
    v_mul_f32 v149, v149, v53
    v_mul_f32 v150, v150, v54
    s_waitcnt lgkmcnt(4)
    v_mfma_f32_32x32x16_bf16 v[80:95], v[28:31], v[224:227], v[80:95]
    ds_read_b64_tr_b16 v[24:25], v10 offset:53792
    ds_read_b64_tr_b16 v[26:27], v10 offset:54176
    buffer_load_dwordx4 a[116:119], v0, s[8:11], s47 offen sc1
    v_mul_f32 v151, v151, v55
    v_exp_f32 v144, v144
    v_mfma_f32_32x32x16_bf16 v[96:111], v[28:31], v[228:231], v[96:111]
    s_add_u32 s47, s46, s99
    s_add_u32 s47, s47, 20480
    buffer_load_dwordx4 a[120:123], v2, s[8:11], s47 offen offset:0 sc1
    v_mul_f32 v48, v48, v56
    v_exp_f32 v145, v145
    s_waitcnt lgkmcnt(4)
    v_mfma_f32_32x32x16_bf16 v[80:95], v[32:35], v[232:235], v[80:95]
    ds_read_b64_tr_b16 v[28:29], v10 offset:55328
    ds_read_b64_tr_b16 v[30:31], v10 offset:55712
    buffer_load_dwordx4 a[124:127], v2, s[8:11], s47 offen offset:1024 sc1
    v_mul_f32 v49, v49, v57
    v_exp_f32 v146, v146
    v_mfma_f32_32x32x16_bf16 v[96:111], v[32:35], v[236:239], v[96:111]
    buffer_load_dwordx4 a[128:131], v2, s[8:11], s47 offen offset:2048 sc1
    v_mul_f32 v50, v50, v58
    v_exp_f32 v147, v147
    s_waitcnt lgkmcnt(4)
    v_mfma_f32_32x32x16_bf16 v[80:95], v[36:39], v[240:243], v[80:95]
    ds_read_b64_tr_b16 v[32:33], v10 offset:56864
    ds_read_b64_tr_b16 v[34:35], v10 offset:57248
    buffer_load_dwordx4 a[132:135], v2, s[8:11], s47 offen offset:3072 sc1
    v_mul_f32 v51, v51, v59
    v_exp_f32 v148, v148
    v_mfma_f32_32x32x16_bf16 v[96:111], v[36:39], v[244:247], v[96:111]
    buffer_load_dwordx4 a[136:139], v0, s[8:11], s47 offen sc1
    v_mul_f32 v52, v52, v60
    v_exp_f32 v149, v149
    s_waitcnt lgkmcnt(4)
    v_mfma_f32_32x32x16_bf16 v[80:95], v[24:27], v[248:251], v[80:95]
    ds_read_b64_tr_b16 v[36:37], v10 offset:58400
    ds_read_b64_tr_b16 v[38:39], v10 offset:58784
    s_add_u32 s47, s46, s100
    s_add_u32 s47, s47, 20480
    buffer_load_dwordx4 a[140:143], v2, s[8:11], s47 offen offset:0 sc1
    v_mul_f32 v53, v53, v61
    v_exp_f32 v150, v150
    v_mfma_f32_32x32x16_bf16 v[96:111], v[24:27], v[252:255], v[96:111]
    buffer_load_dwordx4 a[144:147], v2, s[8:11], s47 offen offset:1024 sc1
    v_mul_f32 v54, v54, v62
    v_exp_f32 v151, v151
    s_waitcnt lgkmcnt(4)
    v_mfma_f32_32x32x16_bf16 v[80:95], v[28:31], v[160:163], v[80:95]
    ds_read_b64_tr_b16 v[24:25], v10 offset:59936
    ds_read_b64_tr_b16 v[26:27], v10 offset:60320
    buffer_load_dwordx4 a[148:151], v2, s[8:11], s47 offen offset:2048 sc1
    v_mul_f32 v55, v55, v63
    v_fma_f32 v144, v144, v16, v16
    v_fma_f32 v145, v145, v16, v16
    v_mfma_f32_32x32x16_bf16 v[96:111], v[28:31], v[164:167], v[96:111]
    buffer_load_dwordx4 a[152:155], v2, s[8:11], s47 offen offset:3072 sc1
    v_fma_f32 v146, v146, v16, v16
    v_fma_f32 v147, v147, v16, v16
    v_fma_f32 v148, v148, v16, v16
    s_waitcnt lgkmcnt(4)
    v_mfma_f32_32x32x16_bf16 v[80:95], v[32:35], v[168:171], v[80:95]
    buffer_load_dwordx4 a[156:159], v0, s[8:11], s47 offen sc1
    v_fma_f32 v149, v149, v16, v16
    v_fma_f32 v150, v150, v16, v16
    v_fma_f32 v151, v151, v16, v16
    v_mfma_f32_32x32x16_bf16 v[96:111], v[32:35], v[172:175], v[96:111]
    s_add_u32 s47, s46, s98
    s_add_u32 s47, s47, 40960
    buffer_load_dwordx4 a[180:183], v2, s[8:11], s47 offen offset:0 sc1
    v_rcp_f32 v144, v144
    s_waitcnt lgkmcnt(2)
    v_mfma_f32_32x32x16_bf16 v[80:95], v[36:39], v[176:179], v[80:95]
    ds_read_b64_tr_b16 v[32:33], v10 offset:43072
    ds_read_b64_tr_b16 v[34:35], v10 offset:43456
    buffer_load_dwordx4 a[184:187], v2, s[8:11], s47 offen offset:1024 sc1
    v_rcp_f32 v145, v145
    v_mfma_f32_32x32x16_bf16 v[96:111], v[36:39], v[180:183], v[96:111]
    buffer_load_dwordx4 a[188:191], v2, s[8:11], s47 offen offset:2048 sc1
    v_rcp_f32 v146, v146
    s_waitcnt lgkmcnt(2)
    v_mfma_f32_32x32x16_bf16 v[80:95], v[24:27], v[184:187], v[80:95]
    ds_read_b64_tr_b16 v[36:37], v10 offset:44608
    ds_read_b64_tr_b16 v[38:39], v10 offset:44992
    buffer_load_dwordx4 a[192:195], v2, s[8:11], s47 offen offset:3072 sc1
    v_rcp_f32 v147, v147
    v_mfma_f32_32x32x16_bf16 v[96:111], v[24:27], v[188:191], v[96:111]
    buffer_load_dwordx4 a[196:199], v0, s[8:11], s47 offen sc1
    v_rcp_f32 v148, v148
    v_mfma_f32_32x32x16_bf16 v[80:95], a[244:247], v[40:43], v[80:95]
    ds_read_b64_tr_b16 v[24:25], v10 offset:46144
    ds_read_b64_tr_b16 v[26:27], v10 offset:46528
    s_add_u32 s47, s46, s99
    s_add_u32 s47, s47, 40960
    buffer_load_dwordx4 a[200:203], v2, s[8:11], s47 offen offset:0 sc1
    v_rcp_f32 v149, v149
    v_mfma_f32_32x32x16_bf16 v[96:111], a[244:247], v[44:47], v[96:111]
    buffer_load_dwordx4 a[204:207], v2, s[8:11], s47 offen offset:1024 sc1
    v_rcp_f32 v150, v150
    v_rcp_f32 v151, v151
    v_mul_f32 v48, v48, v144
    v_mul_f32 v49, v49, v145
    v_mul_f32 v50, v50, v146
    v_mul_f32 v51, v51, v147
    v_mul_f32 v52, v52, v148
    v_mul_f32 v53, v53, v149
    v_mul_f32 v54, v54, v150
    v_mul_f32 v55, v55, v151
    v_cvt_pk_bf16_f32 v56, v48, v49
    v_cvt_pk_bf16_f32 v57, v50, v51
    v_cvt_pk_bf16_f32 v58, v52, v53
    v_cvt_pk_bf16_f32 v59, v54, v55
    buffer_store_dwordx4 v[56:59], v2, s[8:11], s27 offen offset:0 sc1
    v_mul_f32 v152, v64, v64
    v_mul_f32 v153, v65, v65
    v_mul_f32 v154, v66, v66
    v_mul_f32 v155, v67, v67
    v_mul_f32 v156, v68, v68
    v_mul_f32 v157, v69, v69
    v_mul_f32 v158, v70, v70
    v_mul_f32 v159, v71, v71
    v_fma_f32 v152, v152, v15, v13
    v_fma_f32 v153, v153, v15, v13
    v_fma_f32 v154, v154, v15, v13
    v_fma_f32 v155, v155, v15, v13
    v_fma_f32 v156, v156, v15, v13
    v_fma_f32 v157, v157, v15, v13
    v_fma_f32 v158, v158, v15, v13
    v_fma_f32 v159, v159, v15, v13
    v_mul_f32 v152, v152, v64
    v_mul_f32 v153, v153, v65
    v_mul_f32 v154, v154, v66
    v_mul_f32 v155, v155, v67
    v_mul_f32 v156, v156, v68
    v_mul_f32 v157, v157, v69
    v_mul_f32 v158, v158, v70
    v_mul_f32 v159, v159, v71
    v_exp_f32 v152, v152
    v_mul_f32 v64, v64, v72
    v_exp_f32 v153, v153
    v_mul_f32 v65, v65, v73
    v_exp_f32 v154, v154
    v_mul_f32 v66, v66, v74
    v_exp_f32 v155, v155
    v_mul_f32 v67, v67, v75
    v_exp_f32 v156, v156
    v_mul_f32 v68, v68, v76
    v_exp_f32 v157, v157
    v_mul_f32 v69, v69, v77
    v_exp_f32 v158, v158
    v_mul_f32 v70, v70, v78
    v_exp_f32 v159, v159
    v_mul_f32 v71, v71, v79
    v_fma_f32 v152, v152, v17, v17
    v_fma_f32 v153, v153, v17, v17
    v_fma_f32 v154, v154, v17, v17
    v_fma_f32 v155, v155, v17, v17
    v_fma_f32 v156, v156, v17, v17
    v_fma_f32 v157, v157, v17, v17
    v_fma_f32 v158, v158, v17, v17
    v_fma_f32 v159, v159, v17, v17
    v_rcp_f32 v152, v152
    v_rcp_f32 v153, v153
    v_rcp_f32 v154, v154
    v_rcp_f32 v155, v155
    v_rcp_f32 v156, v156
    v_rcp_f32 v157, v157
    v_rcp_f32 v158, v158
    v_rcp_f32 v159, v159
    v_mul_f32 v64, v64, v152
    v_mul_f32 v65, v65, v153
    v_mul_f32 v66, v66, v154
    v_mul_f32 v67, v67, v155
    v_mul_f32 v68, v68, v156
    v_mul_f32 v69, v69, v157
    v_mul_f32 v70, v70, v158
    v_mul_f32 v71, v71, v159
    v_cvt_pk_bf16_f32 v72, v64, v65
    v_cvt_pk_bf16_f32 v73, v66, v67
    v_cvt_pk_bf16_f32 v74, v68, v69
    v_cvt_pk_bf16_f32 v75, v70, v71
    buffer_store_dwordx4 v[72:75], v2, s[8:11], s28 offen offset:0 sc1
    s_waitcnt lgkmcnt(4)
    v_mfma_f32_32x32x16_bf16 v[112:127], v[32:35], v[192:195], v[112:127]
    ds_read_b64_tr_b16 v[28:29], v10 offset:47680
    ds_read_b64_tr_b16 v[30:31], v10 offset:48064
    buffer_load_dwordx4 a[208:211], v2, s[8:11], s47 offen offset:2048 sc1
    s_nop 3
    v_mul_f32 v144, v80, v80
    v_mul_f32 v145, v81, v81
    v_mfma_f32_32x32x16_bf16 v[128:143], v[32:35], v[196:199], v[128:143]
    buffer_load_dwordx4 a[212:215], v2, s[8:11], s47 offen offset:3072 sc1
    v_mul_f32 v146, v82, v82
    v_mul_f32 v147, v83, v83
    v_mul_f32 v148, v84, v84
    s_waitcnt lgkmcnt(4)
    v_mfma_f32_32x32x16_bf16 v[112:127], v[36:39], v[200:203], v[112:127]
    ds_read_b64_tr_b16 v[32:33], v10 offset:49216
    ds_read_b64_tr_b16 v[34:35], v10 offset:49600
    buffer_load_dwordx4 a[216:219], v0, s[8:11], s47 offen sc1
    v_mul_f32 v149, v85, v85
    v_mul_f32 v150, v86, v86
    v_mul_f32 v151, v87, v87
    v_mfma_f32_32x32x16_bf16 v[128:143], v[36:39], v[204:207], v[128:143]
    s_add_u32 s47, s46, s100
    s_add_u32 s47, s47, 40960
    buffer_load_dwordx4 a[220:223], v2, s[8:11], s47 offen offset:0 sc1
    v_fma_f32 v144, v144, v14, v12
    v_fma_f32 v145, v145, v14, v12
    v_fma_f32 v146, v146, v14, v12
    s_waitcnt lgkmcnt(4)
    v_mfma_f32_32x32x16_bf16 v[112:127], v[24:27], v[208:211], v[112:127]
    ds_read_b64_tr_b16 v[36:37], v10 offset:50752
    ds_read_b64_tr_b16 v[38:39], v10 offset:51136
    buffer_load_dwordx4 a[224:227], v2, s[8:11], s47 offen offset:1024 sc1
    v_fma_f32 v147, v147, v14, v12
    v_fma_f32 v148, v148, v14, v12
    v_fma_f32 v149, v149, v14, v12
    v_mfma_f32_32x32x16_bf16 v[128:143], v[24:27], v[212:215], v[128:143]
    buffer_load_dwordx4 a[228:231], v2, s[8:11], s47 offen offset:2048 sc1
    v_fma_f32 v150, v150, v14, v12
    v_fma_f32 v151, v151, v14, v12
    v_mul_f32 v144, v144, v80
    s_waitcnt lgkmcnt(4)
    v_mfma_f32_32x32x16_bf16 v[112:127], v[28:31], v[216:219], v[112:127]
    ds_read_b64_tr_b16 v[24:25], v10 offset:52288
    ds_read_b64_tr_b16 v[26:27], v10 offset:52672
    buffer_load_dwordx4 a[232:235], v2, s[8:11], s47 offen offset:3072 sc1
    v_mul_f32 v145, v145, v81
    v_mul_f32 v146, v146, v82
    v_mul_f32 v147, v147, v83
    v_mfma_f32_32x32x16_bf16 v[128:143], v[28:31], v[220:223], v[128:143]
    buffer_load_dwordx4 a[236:239], v0, s[8:11], s47 offen sc1
    v_mul_f32 v148, v148, v84
    v_mul_f32 v149, v149, v85
    v_mul_f32 v150, v150, v86
    s_waitcnt lgkmcnt(4)
    v_mfma_f32_32x32x16_bf16 v[112:127], v[32:35], v[224:227], v[112:127]
    ds_read_b64_tr_b16 v[28:29], v10 offset:53824
    ds_read_b64_tr_b16 v[30:31], v10 offset:54208
    v_mul_f32 v151, v151, v87
    v_exp_f32 v144, v144
    v_mul_f32 v80, v80, v88
    v_mfma_f32_32x32x16_bf16 v[128:143], v[32:35], v[228:231], v[128:143]
    v_exp_f32 v145, v145
    v_mul_f32 v81, v81, v89
    v_exp_f32 v146, v146
    s_waitcnt lgkmcnt(4)
    v_mfma_f32_32x32x16_bf16 v[112:127], v[36:39], v[232:235], v[112:127]
    ds_read_b64_tr_b16 v[32:33], v10 offset:55360
    ds_read_b64_tr_b16 v[34:35], v10 offset:55744
    v_mul_f32 v82, v82, v90
    v_exp_f32 v147, v147
    v_mul_f32 v83, v83, v91
    v_mfma_f32_32x32x16_bf16 v[128:143], v[36:39], v[236:239], v[128:143]
    v_exp_f32 v148, v148
    s_waitcnt vmcnt(8)
    s_mov_b64 exec, 1
    s_cmp_eq_u32 s38, 0
    s_cbranch_scc1 L_wt_1016
    buffer_store_dword v9, v8, s[8:11], s29 offen offset:0
L_wb_1017:
    s_mov_b64 exec, -1
    v_mul_f32 v84, v84, v92
    s_waitcnt lgkmcnt(4)
    v_mfma_f32_32x32x16_bf16 v[112:127], v[24:27], v[240:243], v[112:127]
    ds_read_b64_tr_b16 v[36:37], v10 offset:56896
    ds_read_b64_tr_b16 v[38:39], v10 offset:57280
    v_exp_f32 v149, v149
    v_mul_f32 v85, v85, v93
    v_exp_f32 v150, v150
    v_mfma_f32_32x32x16_bf16 v[128:143], v[24:27], v[244:247], v[128:143]
    v_mul_f32 v86, v86, v94
    v_exp_f32 v151, v151
    v_mul_f32 v87, v87, v95
    v_fma_f32 v144, v144, v16, v16
    s_waitcnt lgkmcnt(4)
    v_mfma_f32_32x32x16_bf16 v[112:127], v[28:31], v[248:251], v[112:127]
    ds_read_b64_tr_b16 v[24:25], v10 offset:58432
    ds_read_b64_tr_b16 v[26:27], v10 offset:58816
    v_fma_f32 v145, v145, v16, v16
    v_fma_f32 v146, v146, v16, v16
    v_fma_f32 v147, v147, v16, v16
    v_fma_f32 v148, v148, v16, v16
    v_fma_f32 v149, v149, v16, v16
    v_mfma_f32_32x32x16_bf16 v[128:143], v[28:31], v[252:255], v[128:143]
    v_fma_f32 v150, v150, v16, v16
    v_fma_f32 v151, v151, v16, v16
    v_rcp_f32 v144, v144
    s_waitcnt lgkmcnt(4)
    v_mfma_f32_32x32x16_bf16 v[112:127], v[32:35], v[160:163], v[112:127]
    ds_read_b64_tr_b16 v[28:29], v10 offset:59968
    ds_read_b64_tr_b16 v[30:31], v10 offset:60352
    v_rcp_f32 v145, v145
    v_rcp_f32 v146, v146
    v_mfma_f32_32x32x16_bf16 v[128:143], v[32:35], v[164:167], v[128:143]
    v_rcp_f32 v147, v147
    v_rcp_f32 v148, v148
    s_waitcnt lgkmcnt(4)
    v_mfma_f32_32x32x16_bf16 v[112:127], v[36:39], v[168:171], v[112:127]
    v_rcp_f32 v149, v149
    v_rcp_f32 v150, v150
    v_mfma_f32_32x32x16_bf16 v[128:143], v[36:39], v[172:175], v[128:143]
    v_rcp_f32 v151, v151
    v_mul_f32 v80, v80, v144
    v_mul_f32 v81, v81, v145
    v_mul_f32 v82, v82, v146
    s_waitcnt lgkmcnt(2)
    v_mfma_f32_32x32x16_bf16 v[112:127], v[24:27], v[176:179], v[112:127]
    v_mul_f32 v83, v83, v147
    v_mul_f32 v84, v84, v148
    v_mul_f32 v85, v85, v149
    v_mul_f32 v86, v86, v150
    v_mul_f32 v87, v87, v151
    v_mfma_f32_32x32x16_bf16 v[128:143], v[24:27], v[180:183], v[128:143]
    v_cvt_pk_bf16_f32 v88, v80, v81
    v_cvt_pk_bf16_f32 v89, v82, v83
    v_cvt_pk_bf16_f32 v90, v84, v85
    v_cvt_pk_bf16_f32 v91, v86, v87
    buffer_store_dwordx4 v[88:91], v2, s[8:11], s27 offen offset:1024 sc1
    s_waitcnt lgkmcnt(0)
    v_mfma_f32_32x32x16_bf16 v[112:127], v[28:31], v[184:187], v[112:127]
    v_mul_f32 v152, v96, v96
    v_mul_f32 v153, v97, v97
    v_mul_f32 v154, v98, v98
    v_mul_f32 v155, v99, v99
    v_mul_f32 v156, v100, v100
    v_mfma_f32_32x32x16_bf16 v[128:143], v[28:31], v[188:191], v[128:143]
    v_mul_f32 v157, v101, v101
    v_mul_f32 v158, v102, v102
    v_mul_f32 v159, v103, v103
    v_fma_f32 v152, v152, v15, v13
    v_fma_f32 v153, v153, v15, v13
    v_mfma_f32_32x32x16_bf16 v[112:127], a[246:249], v[40:43], v[112:127]
    v_fma_f32 v154, v154, v15, v13
    v_fma_f32 v155, v155, v15, v13
    v_fma_f32 v156, v156, v15, v13
    v_fma_f32 v157, v157, v15, v13
    v_fma_f32 v158, v158, v15, v13
    v_mfma_f32_32x32x16_bf16 v[128:143], a[246:249], v[44:47], v[128:143]
    v_fma_f32 v159, v159, v15, v13
    v_mul_f32 v152, v152, v96
    v_mul_f32 v153, v153, v97
    v_mul_f32 v154, v154, v98
    v_mul_f32 v155, v155, v99
    v_mul_f32 v156, v156, v100
    v_mul_f32 v157, v157, v101
    v_mul_f32 v158, v158, v102
    v_mul_f32 v159, v159, v103
    v_exp_f32 v152, v152
    v_mul_f32 v96, v96, v104
    v_exp_f32 v153, v153
    v_mul_f32 v97, v97, v105
    v_exp_f32 v154, v154
    v_mul_f32 v98, v98, v106
    v_exp_f32 v155, v155
    v_mul_f32 v99, v99, v107
    v_exp_f32 v156, v156
    v_mul_f32 v100, v100, v108
    v_exp_f32 v157, v157
    v_mul_f32 v101, v101, v109
    v_exp_f32 v158, v158
    v_mul_f32 v102, v102, v110
    v_exp_f32 v159, v159
    v_mul_f32 v103, v103, v111
    v_fma_f32 v152, v152, v17, v17
    v_fma_f32 v153, v153, v17, v17
    v_fma_f32 v154, v154, v17, v17
    v_fma_f32 v155, v155, v17, v17
    v_fma_f32 v156, v156, v17, v17
    buffer_load_dword v18, v11, s[8:11], s36 offen sc1
    v_fma_f32 v157, v157, v17, v17
    v_fma_f32 v158, v158, v17, v17
    v_fma_f32 v159, v159, v17, v17
    v_rcp_f32 v152, v152
    v_rcp_f32 v153, v153
    v_rcp_f32 v154, v154
    v_rcp_f32 v155, v155
    v_rcp_f32 v156, v156
    v_rcp_f32 v157, v157
    v_rcp_f32 v158, v158
    v_rcp_f32 v159, v159
    v_mul_f32 v96, v96, v152
    v_mul_f32 v97, v97, v153
    v_mul_f32 v98, v98, v154
    v_mul_f32 v99, v99, v155
    v_mul_f32 v100, v100, v156
    v_mul_f32 v101, v101, v157
    v_mul_f32 v102, v102, v158
    v_mul_f32 v103, v103, v159
    v_cvt_pk_bf16_f32 v104, v96, v97
    v_cvt_pk_bf16_f32 v105, v98, v99
    v_cvt_pk_bf16_f32 v106, v100, v101
    v_cvt_pk_bf16_f32 v107, v102, v103
    buffer_store_dwordx4 v[104:107], v2, s[8:11], s28 offen offset:1024 sc1
L_g2:
    s_waitcnt vmcnt(1)
    v_cmp_eq_u32 vcc, s96, v18
    s_nop 0
    s_and_b32 s34, vcc_lo, 0xff
    s_cmp_lg_u32 s34, 0xff
    s_cbranch_scc1 L_spin_1018
L_back_1019:
    v_pk_mul_f32 v[144:145], v[112:113], v[112:113]
    s_add_u32 s31, s40, s4
    buffer_load_dwordx4 v[160:163], v22, s[8:11], s31 offen offset:0 sc1
    v_pk_mul_f32 v[146:147], v[114:115], v[114:115]
    v_pk_mul_f32 v[148:149], v[116:117], v[116:117]
    v_pk_mul_f32 v[150:151], v[118:119], v[118:119]
    v_pk_fma_f32 v[144:145], v[144:145], v[14:15], v[12:13] op_sel:[0,0,0] op_sel_hi:[1,0,0]
    v_pk_fma_f32 v[146:147], v[146:147], v[14:15], v[12:13] op_sel:[0,0,0] op_sel_hi:[1,0,0]
    v_pk_fma_f32 v[148:149], v[148:149], v[14:15], v[12:13] op_sel:[0,0,0] op_sel_hi:[1,0,0]
    v_pk_fma_f32 v[150:151], v[150:151], v[14:15], v[12:13] op_sel:[0,0,0] op_sel_hi:[1,0,0]
    v_pk_mul_f32 v[144:145], v[144:145], v[112:113]
    s_add_u32 s31, s41, s4
    buffer_load_dwordx4 v[164:167], v22, s[8:11], s31 offen offset:0 sc1
    v_pk_mul_f32 v[146:147], v[146:147], v[114:115]
    v_pk_mul_f32 v[148:149], v[148:149], v[116:117]
    v_pk_mul_f32 v[150:151], v[150:151], v[118:119]
    v_exp_f32 v144, v144
    v_exp_f32 v145, v145
    v_exp_f32 v146, v146
    v_exp_f32 v147, v147
    v_exp_f32 v148, v148
    s_add_u32 s31, s42, s4
    buffer_load_dwordx4 v[168:171], v22, s[8:11], s31 offen offset:0 sc1
    v_exp_f32 v149, v149
    v_exp_f32 v150, v150
    v_exp_f32 v151, v151
    v_pk_mul_f32 v[112:113], v[112:113], v[120:121]
    v_pk_mul_f32 v[114:115], v[114:115], v[122:123]
    v_pk_mul_f32 v[116:117], v[116:117], v[124:125]
    v_pk_mul_f32 v[118:119], v[118:119], v[126:127]
    v_pk_fma_f32 v[144:145], v[144:145], v[16:17], v[16:17] op_sel:[0,0,0] op_sel_hi:[1,0,0]
    s_add_u32 s31, s43, s4
    buffer_load_dwordx4 v[172:175], v22, s[8:11], s31 offen offset:0 sc1
    v_pk_fma_f32 v[146:147], v[146:147], v[16:17], v[16:17] op_sel:[0,0,0] op_sel_hi:[1,0,0]
    v_pk_fma_f32 v[148:149], v[148:149], v[16:17], v[16:17] op_sel:[0,0,0] op_sel_hi:[1,0,0]
    v_pk_fma_f32 v[150:151], v[150:151], v[16:17], v[16:17] op_sel:[0,0,0] op_sel_hi:[1,0,0]
    v_rcp_f32 v144, v144
    v_rcp_f32 v145, v145
    v_rcp_f32 v146, v146
    v_rcp_f32 v147, v147
    v_rcp_f32 v148, v148
    s_add_u32 s31, s40, s5
    buffer_load_dwordx4 v[176:179], v22, s[8:11], s31 offen offset:0 sc1
    v_rcp_f32 v149, v149
    v_rcp_f32 v150, v150
    v_rcp_f32 v151, v151
    v_pk_mul_f32 v[112:113], v[112:113], v[144:145]
    v_pk_mul_f32 v[114:115], v[114:115], v[146:147]
    v_pk_mul_f32 v[116:117], v[116:117], v[148:149]
    v_pk_mul_f32 v[118:119], v[118:119], v[150:151]
    v_cvt_pk_bf16_f32 v120, v112, v113
    s_add_u32 s31, s41, s5
    buffer_load_dwordx4 v[180:183], v22, s[8:11], s31 offen offset:0 sc1
    v_cvt_pk_bf16_f32 v121, v114, v115
    v_cvt_pk_bf16_f32 v122, v116, v117
    v_cvt_pk_bf16_f32 v123, v118, v119
    s_cmp_eq_u32 s37, 0
    s_cbranch_scc1 L_wt_1020
    buffer_store_dwordx4 v[120:123], v2, s[8:11], s27 offen offset:2048
L_wb_1021:
    s_waitcnt vmcnt(7)
    s_mov_b64 exec, 1
    s_cmp_eq_u32 s38, 0
    s_cbranch_scc1 L_wt_1022
    buffer_store_dword v9, v8, s[8:11], s29 offen offset:32
L_wb_1023:
    s_mov_b64 exec, -1
    v_pk_mul_f32 v[152:153], v[128:129], v[128:129]
    v_pk_mul_f32 v[154:155], v[130:131], v[130:131]
    v_pk_mul_f32 v[156:157], v[132:133], v[132:133]
    s_add_u32 s31, s42, s5
    buffer_load_dwordx4 v[184:187], v22, s[8:11], s31 offen offset:0 sc1
    v_pk_mul_f32 v[158:159], v[134:135], v[134:135]
    v_pk_fma_f32 v[152:153], v[152:153], v[14:15], v[12:13] op_sel:[0,1,1] op_sel_hi:[1,1,1]
    v_pk_fma_f32 v[154:155], v[154:155], v[14:15], v[12:13] op_sel:[0,1,1] op_sel_hi:[1,1,1]
    v_pk_fma_f32 v[156:157], v[156:157], v[14:15], v[12:13] op_sel:[0,1,1] op_sel_hi:[1,1,1]
    v_pk_fma_f32 v[158:159], v[158:159], v[14:15], v[12:13] op_sel:[0,1,1] op_sel_hi:[1,1,1]
    v_pk_mul_f32 v[152:153], v[152:153], v[128:129]
    v_pk_mul_f32 v[154:155], v[154:155], v[130:131]
    v_pk_mul_f32 v[156:157], v[156:157], v[132:133]
    s_add_u32 s31, s43, s5
    buffer_load_dwordx4 v[188:191], v22, s[8:11], s31 offen offset:0 sc1
    v_pk_mul_f32 v[158:159], v[158:159], v[134:135]
    v_exp_f32 v152, v152
    v_exp_f32 v153, v153
    v_exp_f32 v154, v154
    v_exp_f32 v155, v155
    v_exp_f32 v156, v156
    v_exp_f32 v157, v157
    v_exp_f32 v158, v158
    s_add_u32 s31, s40, s6
    buffer_load_dwordx4 v[192:195], v22, s[8:11], s31 offen offset:0 sc1
    v_exp_f32 v159, v159
    v_pk_mul_f32 v[128:129], v[128:129], v[136:137]
    v_pk_mul_f32 v[130:131], v[130:131], v[138:139]
    v_pk_mul_f32 v[132:133], v[132:133], v[140:141]
    v_pk_mul_f32 v[134:135], v[134:135], v[142:143]
    v_pk_fma_f32 v[152:153], v[152:153], v[16:17], v[16:17] op_sel:[0,1,1] op_sel_hi:[1,1,1]
    v_pk_fma_f32 v[154:155], v[154:155], v[16:17], v[16:17] op_sel:[0,1,1] op_sel_hi:[1,1,1]
    v_pk_fma_f32 v[156:157], v[156:157], v[16:17], v[16:17] op_sel:[0,1,1] op_sel_hi:[1,1,1]
    s_add_u32 s31, s41, s6
    buffer_load_dwordx4 v[196:199], v22, s[8:11], s31 offen offset:0 sc1
    v_pk_fma_f32 v[158:159], v[158:159], v[16:17], v[16:17] op_sel:[0,1,1] op_sel_hi:[1,1,1]
    v_rcp_f32 v152, v152
    v_rcp_f32 v153, v153
    v_rcp_f32 v154, v154
    v_rcp_f32 v155, v155
    v_rcp_f32 v156, v156
    v_rcp_f32 v157, v157
    v_rcp_f32 v158, v158
    s_add_u32 s31, s42, s6
    buffer_load_dwordx4 v[200:203], v22, s[8:11], s31 offen offset:0 sc1
    v_rcp_f32 v159, v159
    v_pk_mul_f32 v[128:129], v[128:129], v[152:153]
    v_pk_mul_f32 v[130:131], v[130:131], v[154:155]
    v_pk_mul_f32 v[132:133], v[132:133], v[156:157]
    v_pk_mul_f32 v[134:135], v[134:135], v[158:159]
    v_cvt_pk_bf16_f32 v136, v128, v129
    v_cvt_pk_bf16_f32 v137, v130, v131
    v_cvt_pk_bf16_f32 v138, v132, v133
    s_add_u32 s31, s43, s6
    buffer_load_dwordx4 v[204:207], v22, s[8:11], s31 offen offset:0 sc1
    v_cvt_pk_bf16_f32 v139, v134, v135
    s_cmp_eq_u32 s37, 0
    s_cbranch_scc1 L_wt_1024
    buffer_store_dwordx4 v[136:139], v2, s[8:11], s28 offen offset:2048
L_wb_1025:
    buffer_load_dword v18, v11, s[8:11], s36 offen sc1
    s_waitcnt vmcnt(12)
    v_mfma_f32_16x16x32_bf16 v[24:27], a[0:3], v[160:163], 0
    s_add_u32 s31, s40, s7
    buffer_load_dwordx4 v[208:211], v22, s[8:11], s31 offen offset:0 sc1
    v_mfma_f32_16x16x32_bf16 v[28:31], a[4:7], v[160:163], 0
    v_mfma_f32_16x16x32_bf16 v[32:35], a[8:11], v[160:163], 0
    v_mfma_f32_16x16x32_bf16 v[36:39], a[12:15], v[160:163], 0
    v_mfma_f32_16x16x32_bf16 v[40:43], a[16:19], v[160:163], 0
    s_add_u32 s31, s41, s7
    buffer_load_dwordx4 v[212:215], v22, s[8:11], s31 offen offset:0 sc1
    v_mfma_f32_16x16x32_bf16 v[44:47], a[0:3], v[164:167], 0
    v_mfma_f32_16x16x32_bf16 v[48:51], a[4:7], v[164:167], 0
    v_mfma_f32_16x16x32_bf16 v[52:55], a[8:11], v[164:167], 0
    v_mfma_f32_16x16x32_bf16 v[56:59], a[12:15], v[164:167], 0
    s_add_u32 s31, s42, s7
    buffer_load_dwordx4 v[216:219], v22, s[8:11], s31 offen offset:0 sc1
    v_mfma_f32_16x16x32_bf16 v[60:63], a[16:19], v[164:167], 0
    v_mfma_f32_16x16x32_bf16 v[64:67], a[0:3], v[168:171], 0
    v_mfma_f32_16x16x32_bf16 v[68:71], a[4:7], v[168:171], 0
    v_mfma_f32_16x16x32_bf16 v[72:75], a[8:11], v[168:171], 0
    s_add_u32 s31, s43, s7
    buffer_load_dwordx4 v[220:223], v22, s[8:11], s31 offen offset:0 sc1
    v_mfma_f32_16x16x32_bf16 v[76:79], a[12:15], v[168:171], 0
    v_mfma_f32_16x16x32_bf16 v[80:83], a[16:19], v[168:171], 0
    v_mfma_f32_16x16x32_bf16 v[84:87], a[0:3], v[172:175], 0
    v_mfma_f32_16x16x32_bf16 v[88:91], a[4:7], v[172:175], 0
    v_mfma_f32_16x16x32_bf16 v[92:95], a[8:11], v[172:175], 0
    v_mfma_f32_16x16x32_bf16 v[96:99], a[12:15], v[172:175], 0
    v_mfma_f32_16x16x32_bf16 v[100:103], a[16:19], v[172:175], 0
    s_waitcnt vmcnt(4)
    v_cmp_eq_u32 vcc, s96, v18
    s_nop 0
    s_and_b32 s34, vcc_lo, 0xff00
    s_cmp_lg_u32 s34, 0xff00
    s_cbranch_scc1 L_spin_1026
L_back_1027:
    v_mfma_f32_16x16x32_bf16 v[24:27], a[20:23], v[176:179], v[24:27]
    s_add_u32 s31, s40, s4
    buffer_load_dwordx4 v[224:227], v22, s[8:11], s31 offen offset:1024 sc1
    v_mfma_f32_16x16x32_bf16 v[28:31], a[24:27], v[176:179], v[28:31]
    v_mfma_f32_16x16x32_bf16 v[32:35], a[28:31], v[176:179], v[32:35]
    v_mfma_f32_16x16x32_bf16 v[36:39], a[32:35], v[176:179], v[36:39]
    v_mfma_f32_16x16x32_bf16 v[40:43], a[36:39], v[176:179], v[40:43]
    s_add_u32 s31, s41, s4
    buffer_load_dwordx4 v[228:231], v22, s[8:11], s31 offen offset:1024 sc1
    v_mfma_f32_16x16x32_bf16 v[44:47], a[20:23], v[180:183], v[44:47]
    v_mfma_f32_16x16x32_bf16 v[48:51], a[24:27], v[180:183], v[48:51]
    v_mfma_f32_16x16x32_bf16 v[52:55], a[28:31], v[180:183], v[52:55]
    s_mov_b64 exec, 1
    s_cmp_eq_u32 s38, 0
    s_cbranch_scc1 L_wt_1028
    buffer_store_dword v9, v8, s[8:11], s29 offen offset:64
L_wb_1029:
    s_mov_b64 exec, -1
    v_mfma_f32_16x16x32_bf16 v[56:59], a[32:35], v[180:183], v[56:59]
    s_add_u32 s31, s42, s4
    buffer_load_dwordx4 v[232:235], v22, s[8:11], s31 offen offset:1024 sc1
    v_mfma_f32_16x16x32_bf16 v[60:63], a[36:39], v[180:183], v[60:63]
    s_mul_i32 s32, s44, 81920
    v_mfma_f32_16x16x32_bf16 v[64:67], a[20:23], v[184:187], v[64:67]
    s_mul_i32 s33, s45, 10240
    v_mfma_f32_16x16x32_bf16 v[68:71], a[24:27], v[184:187], v[68:71]
    s_add_u32 s32, s32, s33
    v_mfma_f32_16x16x32_bf16 v[72:75], a[28:31], v[184:187], v[72:75]
    s_add_u32 s31, s43, s4
    buffer_load_dwordx4 v[236:239], v22, s[8:11], s31 offen offset:1024 sc1
    v_mfma_f32_16x16x32_bf16 v[76:79], a[32:35], v[184:187], v[76:79]
    s_lshr_b32 s33, s3, 1
    v_mfma_f32_16x16x32_bf16 v[80:83], a[36:39], v[184:187], v[80:83]
    s_lshl_b32 s33, s33, 8
    v_mfma_f32_16x16x32_bf16 v[84:87], a[20:23], v[188:191], v[84:87]
    s_and_b32 s34, s3, 1
    v_mfma_f32_16x16x32_bf16 v[88:91], a[24:27], v[188:191], v[88:91]
    s_add_u32 s31, s40, s5
    buffer_load_dwordx4 v[240:243], v22, s[8:11], s31 offen offset:1024 sc1
    v_mfma_f32_16x16x32_bf16 v[92:95], a[28:31], v[188:191], v[92:95]
    s_lshl_b32 s34, s34, 3
    v_mfma_f32_16x16x32_bf16 v[96:99], a[32:35], v[188:191], v[96:99]
    s_add_u32 s33, s33, s34
    v_mfma_f32_16x16x32_bf16 v[100:103], a[36:39], v[188:191], v[100:103]
    s_add_u32 s32, s32, s33
    v_mfma_f32_16x16x32_bf16 v[24:27], a[40:43], v[192:195], v[24:27]
    s_add_u32 s31, s41, s5
    buffer_load_dwordx4 v[244:247], v22, s[8:11], s31 offen offset:1024 sc1
    v_mfma_f32_16x16x32_bf16 v[28:31], a[44:47], v[192:195], v[28:31]
    s_add_u32 s34, s3, 0
    v_mfma_f32_16x16x32_bf16 v[32:35], a[48:51], v[192:195], v[32:35]
    s_and_b32 s34, s34, 3
    v_mfma_f32_16x16x32_bf16 v[36:39], a[52:55], v[192:195], v[36:39]
    s_mul_i32 s34, s34, 5120
    v_mfma_f32_16x16x32_bf16 v[40:43], a[56:59], v[192:195], v[40:43]
    s_add_u32 s31, s42, s5
    buffer_load_dwordx4 v[248:251], v22, s[8:11], s31 offen offset:1024 sc1
    v_mfma_f32_16x16x32_bf16 v[44:47], a[40:43], v[196:199], v[44:47]
    s_add_u32 s34, s34, 122880
    v_mfma_f32_16x16x32_bf16 v[48:51], a[44:47], v[196:199], v[48:51]
    v_add_u32 v104, s34, v2
    v_mfma_f32_16x16x32_bf16 v[52:55], a[48:51], v[196:199], v[52:55]
    s_add_u32 s34, s3, 1
    v_mfma_f32_16x16x32_bf16 v[56:59], a[52:55], v[196:199], v[56:59]
    s_add_u32 s31, s43, s5
    buffer_load_dwordx4 v[252:255], v22, s[8:11], s31 offen offset:1024 sc1
    v_mfma_f32_16x16x32_bf16 v[60:63], a[56:59], v[196:199], v[60:63]
    s_and_b32 s34, s34, 3
    v_mfma_f32_16x16x32_bf16 v[64:67], a[40:43], v[200:203], v[64:67]
    s_mul_i32 s34, s34, 5120
    v_mfma_f32_16x16x32_bf16 v[68:71], a[44:47], v[200:203], v[68:71]
    s_add_u32 s34, s34, 122880
    v_mfma_f32_16x16x32_bf16 v[72:75], a[48:51], v[200:203], v[72:75]
    s_add_u32 s31, s40, s6
    buffer_load_dwordx4 v[112:115], v22, s[8:11], s31 offen offset:1024 sc1
    v_mfma_f32_16x16x32_bf16 v[76:79], a[52:55], v[200:203], v[76:79]
    v_add_u32 v105, s34, v2
    v_mfma_f32_16x16x32_bf16 v[80:83], a[56:59], v[200:203], v[80:83]
    s_add_u32 s34, s3, 2
    v_mfma_f32_16x16x32_bf16 v[84:87], a[40:43], v[204:207], v[84:87]
    s_and_b32 s34, s34, 3
    v_mfma_f32_16x16x32_bf16 v[88:91], a[44:47], v[204:207], v[88:91]
    s_add_u32 s31, s41, s6
    buffer_load_dwordx4 v[116:119], v22, s[8:11], s31 offen offset:1024 sc1
    v_mfma_f32_16x16x32_bf16 v[92:95], a[48:51], v[204:207], v[92:95]
    s_mul_i32 s34, s34, 5120
    v_mfma_f32_16x16x32_bf16 v[96:99], a[52:55], v[204:207], v[96:99]
    s_add_u32 s34, s34, 122880
    v_mfma_f32_16x16x32_bf16 v[100:103], a[56:59], v[204:207], v[100:103]
    v_add_u32 v106, s34, v2
    s_waitcnt vmcnt(11)
    v_mfma_f32_16x16x32_bf16 v[24:27], a[60:63], v[208:211], v[24:27]
    s_add_u32 s31, s42, s6
    buffer_load_dwordx4 v[120:123], v22, s[8:11], s31 offen offset:1024 sc1
    v_mfma_f32_16x16x32_bf16 v[28:31], a[64:67], v[208:211], v[28:31]
    s_add_u32 s34, s3, 3
    v_mfma_f32_16x16x32_bf16 v[32:35], a[68:71], v[208:211], v[32:35]
    s_and_b32 s34, s34, 3
    v_mfma_f32_16x16x32_bf16 v[36:39], a[72:75], v[208:211], v[36:39]
    s_mul_i32 s34, s34, 5120
    v_mfma_f32_16x16x32_bf16 v[40:43], a[76:79], v[208:211], v[40:43]
    s_add_u32 s31, s43, s6
    buffer_load_dwordx4 v[124:127], v22, s[8:11], s31 offen offset:1024 sc1
    v_mfma_f32_16x16x32_bf16 v[44:47], a[60:63], v[212:215], v[44:47]
    buffer_load_dword v18, v11, s[8:11], s36 offen sc1
    v_mfma_f32_16x16x32_bf16 v[48:51], a[64:67], v[212:215], v[48:51]
    s_add_u32 s34, s34, 122880
    v_mfma_f32_16x16x32_bf16 v[52:55], a[68:71], v[212:215], v[52:55]
    v_add_u32 v107, s34, v2
    v_mfma_f32_16x16x32_bf16 v[56:59], a[72:75], v[212:215], v[56:59]
    s_add_u32 s31, s40, s7
    buffer_load_dwordx4 v[128:131], v22, s[8:11], s31 offen offset:1024 sc1
    v_mfma_f32_16x16x32_bf16 v[60:63], a[76:79], v[212:215], v[60:63]
    v_mul_u32_u24 v23, 320, v19
    v_mfma_f32_16x16x32_bf16 v[64:67], a[60:63], v[216:219], v[64:67]
    v_lshl_add_u32 v23, v20, 3, v23
    v_mfma_f32_16x16x32_bf16 v[68:71], a[64:67], v[216:219], v[68:71]
    s_mul_i32 s46, s33, 20
    v_mfma_f32_16x16x32_bf16 v[72:75], a[68:71], v[216:219], v[72:75]
    s_add_u32 s31, s41, s7
    buffer_load_dwordx4 v[132:135], v22, s[8:11], s31 offen offset:1024 sc1
    v_mfma_f32_16x16x32_bf16 v[76:79], a[72:75], v[216:219], v[76:79]
    s_add_u32 s46, s46, 143360
    v_mfma_f32_16x16x32_bf16 v[80:83], a[76:79], v[216:219], v[80:83]
    v_add_u32 v23, s46, v23
    v_mfma_f32_16x16x32_bf16 v[84:87], a[60:63], v[220:223], v[84:87]
    s_mul_i32 s47, s44, 81920
    v_mfma_f32_16x16x32_bf16 v[88:91], a[64:67], v[220:223], v[88:91]
    s_add_u32 s31, s42, s7
    buffer_load_dwordx4 v[136:139], v22, s[8:11], s31 offen offset:1024 sc1
    v_mfma_f32_16x16x32_bf16 v[92:95], a[68:71], v[220:223], v[92:95]
    s_mul_i32 s46, s45, 160
    v_mfma_f32_16x16x32_bf16 v[96:99], a[72:75], v[220:223], v[96:99]
    s_add_u32 s47, s47, s46
    v_mfma_f32_16x16x32_bf16 v[100:103], a[76:79], v[220:223], v[100:103]
    s_lshl_b32 s46, s3, 6
    s_waitcnt vmcnt(12)
    v_mfma_f32_16x16x32_bf16 v[24:27], a[80:83], v[224:227], v[24:27]
    s_add_u32 s31, s43, s7
    buffer_load_dwordx4 v[140:143], v22, s[8:11], s31 offen offset:1024 sc1
    v_mfma_f32_16x16x32_bf16 v[28:31], a[84:87], v[224:227], v[28:31]
    v_add_u32 v12, s46, v1
    v_mfma_f32_16x16x32_bf16 v[32:35], a[88:91], v[224:227], v[32:35]
    v_lshlrev_b32 v108, 4, v12
    v_mfma_f32_16x16x32_bf16 v[36:39], a[92:95], v[224:227], v[36:39]
    v_add_u32 v108, 143360, v108
    v_add_u32 v13, 0, v12
    v_mul_u32_u24 v14, 6554, v13
    v_lshrrev_b32 v14, 16, v14
    v_mul_u32_u24 v14, 1120, v14
    v_lshl_add_u32 v109, v13, 4, v14
    v_add_u32 v13, 256, v12
    v_mul_u32_u24 v14, 6554, v13
    v_lshrrev_b32 v14, 16, v14
    v_mul_u32_u24 v14, 1120, v14
    v_lshl_add_u32 v110, v13, 4, v14
    v_add_u32 v13, 512, v12
    v_mul_u32_u24 v14, 6554, v13
    v_lshrrev_b32 v14, 16, v14
    v_mul_u32_u24 v14, 1120, v14
    v_lshl_add_u32 v111, v13, 4, v14
    v_mov_b32 v13, 0x80000000
    v_cmp_gt_u32 vcc, 128, v12
    s_nop 1
    v_cndmask_b32 v111, v13, v111, vcc
    s_lshl_b32 s22, s44, 12
    s_lshl_b32 s26, s3, 10
    s_add_u32 s26, s26, s22
    s_add_u32 s26, s26, 16367616
    s_lshr_b32 s27, s45, 1
    s_lshl_b32 s27, s27, 8
    s_and_b32 s28, s45, 1
    s_lshl_b32 s28, s28, 3
    s_add_u32 s27, s27, s28
    s_add_u32 s27, s27, s26
    s_lshl_b32 s28, s45, 9
    s_add_u32 s22, s22, s28
    s_add_u32 s22, s22, s33
    s_add_u32 s22, s22, 16498688
    s_add_u32 s23, s32, 2637824
    s_add_u32 s25, s23, 4096
    s_add_u32 s28, s23, 8192
    s_waitcnt vmcnt(4)
    v_cmp_eq_u32 vcc, s96, v18
    s_nop 0
    s_and_b32 s34, vcc_lo, 0xff0000
    s_cmp_lg_u32 s34, 0xff0000
    s_cbranch_scc1 L_spin_1030
L_back_1031:
    v_mfma_f32_16x16x32_bf16 v[40:43], a[96:99], v[224:227], v[40:43]
    s_add_u32 s31, s40, s4
    buffer_load_dwordx4 v[144:147], v22, s[8:11], s31 offen offset:2048 sc1
    v_mfma_f32_16x16x32_bf16 v[44:47], a[80:83], v[228:231], v[44:47]
    v_mfma_f32_16x16x32_bf16 v[48:51], a[84:87], v[228:231], v[48:51]
    v_mfma_f32_16x16x32_bf16 v[52:55], a[88:91], v[228:231], v[52:55]
    v_mfma_f32_16x16x32_bf16 v[56:59], a[92:95], v[228:231], v[56:59]
    s_add_u32 s31, s41, s4
    buffer_load_dwordx4 v[148:151], v22, s[8:11], s31 offen offset:2048 sc1
    v_mfma_f32_16x16x32_bf16 v[60:63], a[96:99], v[228:231], v[60:63]
    v_mfma_f32_16x16x32_bf16 v[64:67], a[80:83], v[232:235], v[64:67]
    v_mfma_f32_16x16x32_bf16 v[68:71], a[84:87], v[232:235], v[68:71]
    v_mfma_f32_16x16x32_bf16 v[72:75], a[88:91], v[232:235], v[72:75]
    s_add_u32 s31, s42, s4
    buffer_load_dwordx4 v[152:155], v22, s[8:11], s31 offen offset:2048 sc1
    v_mfma_f32_16x16x32_bf16 v[76:79], a[92:95], v[232:235], v[76:79]
    v_mfma_f32_16x16x32_bf16 v[80:83], a[96:99], v[232:235], v[80:83]
    v_mfma_f32_16x16x32_bf16 v[84:87], a[80:83], v[236:239], v[84:87]
    v_mfma_f32_16x16x32_bf16 v[88:91], a[84:87], v[236:239], v[88:91]
    s_add_u32 s31, s43, s4
    buffer_load_dwordx4 v[156:159], v22, s[8:11], s31 offen offset:2048 sc1
    v_mfma_f32_16x16x32_bf16 v[92:95], a[88:91], v[236:239], v[92:95]
    v_mfma_f32_16x16x32_bf16 v[96:99], a[92:95], v[236:239], v[96:99]
    v_mfma_f32_16x16x32_bf16 v[100:103], a[96:99], v[236:239], v[100:103]
    v_mfma_f32_16x16x32_bf16 v[24:27], a[100:103], v[240:243], v[24:27]
    s_add_u32 s31, s40, s5
    buffer_load_dwordx4 v[160:163], v22, s[8:11], s31 offen offset:2048 sc1
    v_mfma_f32_16x16x32_bf16 v[28:31], a[104:107], v[240:243], v[28:31]
    v_mfma_f32_16x16x32_bf16 v[32:35], a[108:111], v[240:243], v[32:35]
    v_mfma_f32_16x16x32_bf16 v[36:39], a[112:115], v[240:243], v[36:39]
    v_mfma_f32_16x16x32_bf16 v[40:43], a[116:119], v[240:243], v[40:43]
    s_add_u32 s31, s41, s5
    buffer_load_dwordx4 v[164:167], v22, s[8:11], s31 offen offset:2048 sc1
    v_mfma_f32_16x16x32_bf16 v[44:47], a[100:103], v[244:247], v[44:47]
    v_mfma_f32_16x16x32_bf16 v[48:51], a[104:107], v[244:247], v[48:51]
    v_mfma_f32_16x16x32_bf16 v[52:55], a[108:111], v[244:247], v[52:55]
    v_mfma_f32_16x16x32_bf16 v[56:59], a[112:115], v[244:247], v[56:59]
    s_add_u32 s31, s42, s5
    buffer_load_dwordx4 v[168:171], v22, s[8:11], s31 offen offset:2048 sc1
    v_mfma_f32_16x16x32_bf16 v[60:63], a[116:119], v[244:247], v[60:63]
    v_mfma_f32_16x16x32_bf16 v[64:67], a[100:103], v[248:251], v[64:67]
    v_mfma_f32_16x16x32_bf16 v[68:71], a[104:107], v[248:251], v[68:71]
    v_mfma_f32_16x16x32_bf16 v[72:75], a[108:111], v[248:251], v[72:75]
    s_add_u32 s31, s43, s5
    buffer_load_dwordx4 v[172:175], v22, s[8:11], s31 offen offset:2048 sc1
    v_mfma_f32_16x16x32_bf16 v[76:79], a[112:115], v[248:251], v[76:79]
    v_mfma_f32_16x16x32_bf16 v[80:83], a[116:119], v[248:251], v[80:83]
    v_mfma_f32_16x16x32_bf16 v[84:87], a[100:103], v[252:255], v[84:87]
    v_mfma_f32_16x16x32_bf16 v[88:91], a[104:107], v[252:255], v[88:91]
    s_add_u32 s31, s40, s6
    buffer_load_dwordx4 v[176:179], v22, s[8:11], s31 offen offset:2048 sc1
    v_mfma_f32_16x16x32_bf16 v[92:95], a[108:111], v[252:255], v[92:95]
    v_mfma_f32_16x16x32_bf16 v[96:99], a[112:115], v[252:255], v[96:99]
    v_mfma_f32_16x16x32_bf16 v[100:103], a[116:119], v[252:255], v[100:103]
    v_mfma_f32_16x16x32_bf16 v[24:27], a[120:123], v[112:115], v[24:27]
    s_add_u32 s31, s41, s6
    buffer_load_dwordx4 v[180:183], v22, s[8:11], s31 offen offset:2048 sc1
    v_mfma_f32_16x16x32_bf16 v[28:31], a[124:127], v[112:115], v[28:31]
    v_mfma_f32_16x16x32_bf16 v[32:35], a[128:131], v[112:115], v[32:35]
    v_mfma_f32_16x16x32_bf16 v[36:39], a[132:135], v[112:115], v[36:39]
    v_mfma_f32_16x16x32_bf16 v[40:43], a[136:139], v[112:115], v[40:43]
    s_add_u32 s31, s42, s6
    buffer_load_dwordx4 v[184:187], v22, s[8:11], s31 offen offset:2048 sc1
    v_mfma_f32_16x16x32_bf16 v[44:47], a[120:123], v[116:119], v[44:47]
    v_mfma_f32_16x16x32_bf16 v[48:51], a[124:127], v[116:119], v[48:51]
    v_mfma_f32_16x16x32_bf16 v[52:55], a[128:131], v[116:119], v[52:55]
    v_mfma_f32_16x16x32_bf16 v[56:59], a[132:135], v[116:119], v[56:59]
    s_add_u32 s31, s43, s6
    buffer_load_dwordx4 v[188:191], v22, s[8:11], s31 offen offset:2048 sc1
    v_mfma_f32_16x16x32_bf16 v[60:63], a[136:139], v[116:119], v[60:63]
    v_mfma_f32_16x16x32_bf16 v[64:67], a[120:123], v[120:123], v[64:67]
    v_mfma_f32_16x16x32_bf16 v[68:71], a[124:127], v[120:123], v[68:71]
    v_mfma_f32_16x16x32_bf16 v[72:75], a[128:131], v[120:123], v[72:75]
    s_add_u32 s31, s40, s7
    buffer_load_dwordx4 v[192:195], v22, s[8:11], s31 offen offset:2048 sc1
    v_mfma_f32_16x16x32_bf16 v[76:79], a[132:135], v[120:123], v[76:79]
    v_mfma_f32_16x16x32_bf16 v[80:83], a[136:139], v[120:123], v[80:83]
    v_mfma_f32_16x16x32_bf16 v[84:87], a[120:123], v[124:127], v[84:87]
    v_mfma_f32_16x16x32_bf16 v[88:91], a[124:127], v[124:127], v[88:91]
    s_add_u32 s31, s41, s7
    buffer_load_dwordx4 v[196:199], v22, s[8:11], s31 offen offset:2048 sc1
    v_mfma_f32_16x16x32_bf16 v[92:95], a[128:131], v[124:127], v[92:95]
    v_mfma_f32_16x16x32_bf16 v[96:99], a[132:135], v[124:127], v[96:99]
    v_mfma_f32_16x16x32_bf16 v[100:103], a[136:139], v[124:127], v[100:103]
    s_waitcnt vmcnt(14)
    v_mfma_f32_16x16x32_bf16 v[24:27], a[140:143], v[128:131], v[24:27]
    s_add_u32 s31, s42, s7
    buffer_load_dwordx4 v[200:203], v22, s[8:11], s31 offen offset:2048 sc1
    v_mfma_f32_16x16x32_bf16 v[28:31], a[144:147], v[128:131], v[28:31]
    v_mfma_f32_16x16x32_bf16 v[32:35], a[148:151], v[128:131], v[32:35]
    v_mfma_f32_16x16x32_bf16 v[36:39], a[152:155], v[128:131], v[36:39]
    v_mfma_f32_16x16x32_bf16 v[40:43], a[156:159], v[128:131], v[40:43]
    s_add_u32 s31, s43, s7
    buffer_load_dwordx4 v[204:207], v22, s[8:11], s31 offen offset:2048 sc1
    v_mfma_f32_16x16x32_bf16 v[44:47], a[140:143], v[132:135], v[44:47]
    v_mfma_f32_16x16x32_bf16 v[48:51], a[144:147], v[132:135], v[48:51]
    v_mfma_f32_16x16x32_bf16 v[52:55], a[148:151], v[132:135], v[52:55]
    v_mfma_f32_16x16x32_bf16 v[56:59], a[152:155], v[132:135], v[56:59]
    s_add_u32 s30, s32, 2637824
    buffer_load_dwordx2 v[208:209], v21, s[8:11], s30 offen offset:0 sc1
    v_mfma_f32_16x16x32_bf16 v[60:63], a[156:159], v[132:135], v[60:63]
    v_mfma_f32_16x16x32_bf16 v[64:67], a[140:143], v[136:139], v[64:67]
    v_mfma_f32_16x16x32_bf16 v[68:71], a[144:147], v[136:139], v[68:71]
    v_mfma_f32_16x16x32_bf16 v[72:75], a[148:151], v[136:139], v[72:75]
    buffer_load_dwordx2 v[210:211], v21, s[8:11], s30 offen offset:2048 sc1
    v_mfma_f32_16x16x32_bf16 v[76:79], a[152:155], v[136:139], v[76:79]
    v_mfma_f32_16x16x32_bf16 v[80:83], a[156:159], v[136:139], v[80:83]
    v_mfma_f32_16x16x32_bf16 v[84:87], a[140:143], v[140:143], v[84:87]
    v_mfma_f32_16x16x32_bf16 v[88:91], a[144:147], v[140:143], v[88:91]
    s_add_u32 s30, s32, 2641920
    buffer_load_dwordx2 v[212:213], v21, s[8:11], s30 offen offset:0 sc1
    v_mfma_f32_16x16x32_bf16 v[92:95], a[148:151], v[140:143], v[92:95]
    v_mfma_f32_16x16x32_bf16 v[96:99], a[152:155], v[140:143], v[96:99]
    v_mfma_f32_16x16x32_bf16 v[100:103], a[156:159], v[140:143], v[100:103]
    s_waitcnt vmcnt(15)
    v_mfma_f32_16x16x32_bf16 v[24:27], a[160:163], v[144:147], v[24:27]
    buffer_load_dwordx2 v[214:215], v21, s[8:11], s30 offen offset:2048 sc1
    v_mfma_f32_16x16x32_bf16 v[28:31], a[164:167], v[144:147], v[28:31]
    v_mfma_f32_16x16x32_bf16 v[32:35], a[168:171], v[144:147], v[32:35]
    v_mfma_f32_16x16x32_bf16 v[36:39], a[172:175], v[144:147], v[36:39]
    v_mfma_f32_16x16x32_bf16 v[40:43], a[176:179], v[144:147], v[40:43]
    s_add_u32 s30, s32, 2646016
    buffer_load_dwordx2 v[216:217], v21, s[8:11], s30 offen offset:0 sc1
    v_mfma_f32_16x16x32_bf16 v[44:47], a[160:163], v[148:151], v[44:47]
    v_mfma_f32_16x16x32_bf16 v[48:51], a[164:167], v[148:151], v[48:51]
    v_mfma_f32_16x16x32_bf16 v[52:55], a[168:171], v[148:151], v[52:55]
    v_mfma_f32_16x16x32_bf16 v[56:59], a[172:175], v[148:151], v[56:59]
    s_add_u32 s30, s32, 5259264
    buffer_load_dwordx2 v[224:225], v21, s[8:11], s30 offen offset:0 sc1
    v_mfma_f32_16x16x32_bf16 v[60:63], a[176:179], v[148:151], v[60:63]
    v_mfma_f32_16x16x32_bf16 v[64:67], a[160:163], v[152:155], v[64:67]
    v_mfma_f32_16x16x32_bf16 v[68:71], a[164:167], v[152:155], v[68:71]
    v_mfma_f32_16x16x32_bf16 v[72:75], a[168:171], v[152:155], v[72:75]
    buffer_load_dwordx2 v[226:227], v21, s[8:11], s30 offen offset:2048 sc1
    v_mfma_f32_16x16x32_bf16 v[76:79], a[172:175], v[152:155], v[76:79]
    v_mfma_f32_16x16x32_bf16 v[80:83], a[176:179], v[152:155], v[80:83]
    v_mfma_f32_16x16x32_bf16 v[84:87], a[160:163], v[156:159], v[84:87]
    v_mfma_f32_16x16x32_bf16 v[88:91], a[164:167], v[156:159], v[88:91]
    s_add_u32 s30, s32, 5263360
    buffer_load_dwordx2 v[228:229], v21, s[8:11], s30 offen offset:0 sc1
    v_mfma_f32_16x16x32_bf16 v[92:95], a[168:171], v[156:159], v[92:95]
    v_mfma_f32_16x16x32_bf16 v[96:99], a[172:175], v[156:159], v[96:99]
    v_mfma_f32_16x16x32_bf16 v[100:103], a[176:179], v[156:159], v[100:103]
    s_waitcnt vmcnt(16)
    v_mfma_f32_16x16x32_bf16 v[44:47], a[180:183], v[164:167], v[44:47]
    buffer_load_dwordx2 v[230:231], v21, s[8:11], s30 offen offset:2048 sc1
    v_mfma_f32_16x16x32_bf16 v[48:51], a[184:187], v[164:167], v[48:51]
    v_mfma_f32_16x16x32_bf16 v[52:55], a[188:191], v[164:167], v[52:55]
    s_add_u32 s30, s32, 5267456
    buffer_load_dwordx2 v[232:233], v21, s[8:11], s30 offen offset:0 sc1
    v_mfma_f32_16x16x32_bf16 v[56:59], a[192:195], v[164:167], v[56:59]
    v_mfma_f32_16x16x32_bf16 v[60:63], a[196:199], v[164:167], v[60:63]
    s_waitcnt vmcnt(14)
    v_mfma_f32_16x16x32_bf16 v[44:47], a[200:203], v[180:183], v[44:47]
    v_mfma_f32_16x16x32_bf16 v[48:51], a[204:207], v[180:183], v[48:51]
    v_mfma_f32_16x16x32_bf16 v[52:55], a[208:211], v[180:183], v[52:55]
    v_mfma_f32_16x16x32_bf16 v[56:59], a[212:215], v[180:183], v[56:59]
    v_mfma_f32_16x16x32_bf16 v[60:63], a[216:219], v[180:183], v[60:63]
    s_waitcnt vmcnt(10)
    v_mfma_f32_16x16x32_bf16 v[44:47], a[220:223], v[196:199], v[44:47]
    v_mfma_f32_16x16x32_bf16 v[48:51], a[224:227], v[196:199], v[48:51]
    v_mfma_f32_16x16x32_bf16 v[52:55], a[228:231], v[196:199], v[52:55]
    v_mfma_f32_16x16x32_bf16 v[56:59], a[232:235], v[196:199], v[56:59]
    v_mfma_f32_16x16x32_bf16 v[60:63], a[236:239], v[196:199], v[60:63]
    v_mfma_f32_16x16x32_bf16 v[64:67], a[180:183], v[168:171], v[64:67]
    v_mfma_f32_16x16x32_bf16 v[68:71], a[184:187], v[168:171], v[68:71]
    s_nop 1
    ds_write_b128 v105, v[44:47] offset:0
    v_mfma_f32_16x16x32_bf16 v[72:75], a[188:191], v[168:171], v[72:75]
    v_mfma_f32_16x16x32_bf16 v[76:79], a[192:195], v[168:171], v[76:79]
    ds_write_b128 v105, v[48:51] offset:1024
    v_mfma_f32_16x16x32_bf16 v[80:83], a[196:199], v[168:171], v[80:83]
    v_mfma_f32_16x16x32_bf16 v[64:67], a[200:203], v[184:187], v[64:67]
    v_mfma_f32_16x16x32_bf16 v[68:71], a[204:207], v[184:187], v[68:71]
    ds_write_b128 v105, v[52:55] offset:2048
    v_mfma_f32_16x16x32_bf16 v[72:75], a[208:211], v[184:187], v[72:75]
    v_mfma_f32_16x16x32_bf16 v[76:79], a[212:215], v[184:187], v[76:79]
    ds_write_b128 v105, v[56:59] offset:3072
    v_mfma_f32_16x16x32_bf16 v[80:83], a[216:219], v[184:187], v[80:83]
    v_mfma_f32_16x16x32_bf16 v[64:67], a[220:223], v[200:203], v[64:67]
    v_mfma_f32_16x16x32_bf16 v[68:71], a[224:227], v[200:203], v[68:71]
    ds_write_b128 v105, v[60:63] offset:4096
    v_mfma_f32_16x16x32_bf16 v[72:75], a[228:231], v[200:203], v[72:75]
    v_mfma_f32_16x16x32_bf16 v[76:79], a[232:235], v[200:203], v[76:79]
    v_mfma_f32_16x16x32_bf16 v[80:83], a[236:239], v[200:203], v[80:83]
    v_mfma_f32_16x16x32_bf16 v[84:87], a[180:183], v[172:175], v[84:87]
    s_getpc_b64 s[34:35]
L_pc_1032:
    s_add_u32 s34, s34, L_mid-L_pc_1032
    s_addc_u32 s35, s35, 0
    s_lshl_b32 s30, s21, 2
    s_add_u32 s30, s30, s3
    s_mul_i32 s30, s30, 128
    v_lshl_add_u32 v7, v1, 7, s30
    v_min_u32 v7, L_mega_last-L_mid, v7
    s_mov_b64 exec, 1
    global_load_dword a252, v7, s[34:35]
    s_mov_b64 exec, -1
    v_mfma_f32_16x16x32_bf16 v[88:91], a[184:187], v[172:175], v[88:91]
    s_or_b32 s34, s21, s3
    s_cmp_lt_u32 s34, s101
    s_cbranch_scc1 L_wb_1033
    buffer_load_dword a255, v11, s[8:11], s36 offen
L_wbd_1034:
    v_mfma_f32_16x16x32_bf16 v[92:95], a[188:191], v[172:175], v[92:95]
    s_waitcnt lgkmcnt(0)
    s_barrier
    v_mfma_f32_16x16x32_bf16 v[96:99], a[192:195], v[172:175], v[96:99]
    ds_write_b128 v106, v[64:67] offset:20480
    v_mfma_f32_16x16x32_bf16 v[100:103], a[196:199], v[172:175], v[100:103]
    ds_read_b128 v[44:47], v104 offset:0
    v_mfma_f32_16x16x32_bf16 v[84:87], a[200:203], v[188:191], v[84:87]
    ds_write_b128 v106, v[68:71] offset:21504
    v_mfma_f32_16x16x32_bf16 v[88:91], a[204:207], v[188:191], v[88:91]
    ds_read_b128 v[48:51], v104 offset:1024
    v_mfma_f32_16x16x32_bf16 v[92:95], a[208:211], v[188:191], v[92:95]
    ds_write_b128 v106, v[72:75] offset:22528
    v_mfma_f32_16x16x32_bf16 v[96:99], a[212:215], v[188:191], v[96:99]
    ds_read_b128 v[52:55], v104 offset:2048
    v_mfma_f32_16x16x32_bf16 v[100:103], a[216:219], v[188:191], v[100:103]
    ds_write_b128 v106, v[76:79] offset:23552
    v_mfma_f32_16x16x32_bf16 v[84:87], a[220:223], v[204:207], v[84:87]
    ds_read_b128 v[56:59], v104 offset:3072
    v_mfma_f32_16x16x32_bf16 v[88:91], a[224:227], v[204:207], v[88:91]
    ds_write_b128 v106, v[80:83] offset:24576
    v_mfma_f32_16x16x32_bf16 v[92:95], a[228:231], v[204:207], v[92:95]
    ds_read_b128 v[60:63], v104 offset:4096
    v_mfma_f32_16x16x32_bf16 v[96:99], a[232:235], v[204:207], v[96:99]
    v_mfma_f32_16x16x32_bf16 v[100:103], a[236:239], v[204:207], v[100:103]
    v_mfma_f32_16x16x32_bf16 v[24:27], a[180:183], v[160:163], v[24:27]
    v_mfma_f32_16x16x32_bf16 v[28:31], a[184:187], v[160:163], v[28:31]
    v_mfma_f32_16x16x32_bf16 v[32:35], a[188:191], v[160:163], v[32:35]
    s_waitcnt lgkmcnt(0)
    s_barrier
    v_mfma_f32_16x16x32_bf16 v[36:39], a[192:195], v[160:163], v[36:39]
    ds_write_b128 v107, v[84:87] offset:0
    v_mfma_f32_16x16x32_bf16 v[40:43], a[196:199], v[160:163], v[40:43]
    ds_read_b128 v[64:67], v104 offset:20480
    v_mfma_f32_16x16x32_bf16 v[24:27], a[200:203], v[176:179], v[24:27]
    ds_write_b128 v107, v[88:91] offset:1024
    v_mfma_f32_16x16x32_bf16 v[28:31], a[204:207], v[176:179], v[28:31]
    ds_read_b128 v[68:71], v104 offset:21504
    v_mfma_f32_16x16x32_bf16 v[32:35], a[208:211], v[176:179], v[32:35]
    ds_write_b128 v107, v[92:95] offset:2048
    v_mfma_f32_16x16x32_bf16 v[36:39], a[212:215], v[176:179], v[36:39]
    ds_read_b128 v[72:75], v104 offset:22528
    v_mfma_f32_16x16x32_bf16 v[40:43], a[216:219], v[176:179], v[40:43]
    ds_write_b128 v107, v[96:99] offset:3072
    v_mfma_f32_16x16x32_bf16 v[24:27], a[220:223], v[192:195], v[24:27]
    ds_read_b128 v[76:79], v104 offset:23552
    v_mfma_f32_16x16x32_bf16 v[28:31], a[224:227], v[192:195], v[28:31]
    ds_write_b128 v107, v[100:103] offset:4096
    v_mfma_f32_16x16x32_bf16 v[32:35], a[228:231], v[192:195], v[32:35]
    ds_read_b128 v[80:83], v104 offset:24576
    v_mfma_f32_16x16x32_bf16 v[36:39], a[232:235], v[192:195], v[36:39]
    v_mfma_f32_16x16x32_bf16 v[40:43], a[236:239], v[192:195], v[40:43]
    s_waitcnt lgkmcnt(0)
    s_barrier
    ds_read_b128 v[84:87], v104 offset:0
    ds_read_b128 v[88:91], v104 offset:1024
    ds_read_b128 v[92:95], v104 offset:2048
    ds_read_b128 v[96:99], v104 offset:3072
    ds_read_b128 v[100:103], v104 offset:4096
    s_waitcnt vmcnt(7)
    v_lshlrev_b32 v112, 16, v208
    v_and_b32 v113, s39, v208
    v_lshlrev_b32 v114, 16, v209
    v_and_b32 v115, s39, v209
    v_lshlrev_b32 v116, 16, v210
    v_and_b32 v117, s39, v210
    v_lshlrev_b32 v118, 16, v211
    v_and_b32 v119, s39, v211
    v_lshlrev_b32 v120, 16, v212
    v_and_b32 v121, s39, v212
    v_lshlrev_b32 v122, 16, v213
    v_and_b32 v123, s39, v213
    v_lshlrev_b32 v124, 16, v214
    v_and_b32 v125, s39, v214
    v_lshlrev_b32 v126, 16, v215
    v_and_b32 v127, s39, v215
    v_lshlrev_b32 v128, 16, v216
    v_and_b32 v129, s39, v216
    v_lshlrev_b32 v130, 16, v217
    v_and_b32 v131, s39, v217
.p2align 3
    v_pk_add_f32 v[24:25], v[24:25], v[112:113]
    v_pk_add_f32 v[26:27], v[26:27], v[114:115]
    v_pk_add_f32 v[28:29], v[28:29], v[116:117]
    v_pk_add_f32 v[30:31], v[30:31], v[118:119]
    v_pk_add_f32 v[32:33], v[32:33], v[120:121]
    v_pk_add_f32 v[34:35], v[34:35], v[122:123]
    v_pk_add_f32 v[36:37], v[36:37], v[124:125]
    v_pk_add_f32 v[38:39], v[38:39], v[126:127]
    v_pk_add_f32 v[40:41], v[40:41], v[128:129]
    v_pk_add_f32 v[42:43], v[42:43], v[130:131]
    v_pk_add_f32 v[24:25], v[24:25], v[44:45]
    v_pk_add_f32 v[26:27], v[26:27], v[46:47]
    v_pk_add_f32 v[28:29], v[28:29], v[48:49]
    v_pk_add_f32 v[30:31], v[30:31], v[50:51]
    v_pk_add_f32 v[32:33], v[32:33], v[52:53]
    v_pk_add_f32 v[34:35], v[34:35], v[54:55]
    v_pk_add_f32 v[36:37], v[36:37], v[56:57]
    v_pk_add_f32 v[38:39], v[38:39], v[58:59]
    v_pk_add_f32 v[40:41], v[40:41], v[60:61]
    v_pk_add_f32 v[42:43], v[42:43], v[62:63]
    v_pk_add_f32 v[24:25], v[24:25], v[64:65]
    v_pk_add_f32 v[26:27], v[26:27], v[66:67]
    v_pk_add_f32 v[28:29], v[28:29], v[68:69]
    v_pk_add_f32 v[30:31], v[30:31], v[70:71]
    v_pk_add_f32 v[32:33], v[32:33], v[72:73]
    v_pk_add_f32 v[34:35], v[34:35], v[74:75]
    v_pk_add_f32 v[36:37], v[36:37], v[76:77]
    v_pk_add_f32 v[38:39], v[38:39], v[78:79]
    v_pk_add_f32 v[40:41], v[40:41], v[80:81]
    v_pk_add_f32 v[42:43], v[42:43], v[82:83]
    s_waitcnt lgkmcnt(0)
.p2align 3
    v_pk_add_f32 v[24:25], v[24:25], v[84:85]
    v_pk_add_f32 v[26:27], v[26:27], v[86:87]
    v_pk_add_f32 v[28:29], v[28:29], v[88:89]
    v_pk_add_f32 v[30:31], v[30:31], v[90:91]
    v_pk_add_f32 v[32:33], v[32:33], v[92:93]
    v_pk_add_f32 v[34:35], v[34:35], v[94:95]
    v_pk_add_f32 v[36:37], v[36:37], v[96:97]
    v_pk_add_f32 v[38:39], v[38:39], v[98:99]
    v_pk_add_f32 v[40:41], v[40:41], v[100:101]
    v_pk_add_f32 v[42:43], v[42:43], v[102:103]
    s_cmp_eq_u32 s101, 0
    s_cbranch_scc1 L_mid
.p2align 3
    v_cvt_pk_bf16_f32 v44, v24, v25
    v_cvt_pk_bf16_f32 v45, v26, v27
    v_cvt_pk_bf16_f32 v46, v28, v29
    v_cvt_pk_bf16_f32 v47, v30, v31
    v_cvt_pk_bf16_f32 v48, v32, v33
    v_cvt_pk_bf16_f32 v49, v34, v35
    v_cvt_pk_bf16_f32 v50, v36, v37
    v_cvt_pk_bf16_f32 v51, v38, v39
    v_cvt_pk_bf16_f32 v52, v40, v41
    v_cvt_pk_bf16_f32 v53, v42, v43
    ds_write_b64 v23, v[44:45] offset:0
    ds_write_b64 v23, v[46:47] offset:32
    ds_write_b64 v23, v[48:49] offset:64
    ds_write_b64 v23, v[50:51] offset:96
    ds_write_b64 v23, v[52:53] offset:128
    s_waitcnt lgkmcnt(0)
    s_barrier
    ds_read_b128 v[56:59], v108 offset:0
    ds_read_b128 v[60:63], v108 offset:4096
    ds_read_b128 v[64:67], v108 offset:8192
    s_waitcnt lgkmcnt(2)
    buffer_store_dwordx4 v[56:59], v109, s[12:15], s47 offen
    s_waitcnt lgkmcnt(1)
    buffer_store_dwordx4 v[60:63], v110, s[12:15], s47 offen
    s_waitcnt lgkmcnt(0)
    buffer_store_dwordx4 v[64:67], v111, s[12:15], s47 offen
    s_endpgm
L_mid:
.p2align 3
    v_pk_add_f32 v[12:13], v[24:25], v[26:27]
    v_pk_mul_f32 v[14:15], v[24:25], v[24:25]
    v_pk_fma_f32 v[14:15], v[26:27], v[26:27], v[14:15]
    v_pk_add_f32 v[12:13], v[12:13], v[28:29]
    v_pk_fma_f32 v[14:15], v[28:29], v[28:29], v[14:15]
    v_pk_add_f32 v[12:13], v[12:13], v[30:31]
    v_pk_fma_f32 v[14:15], v[30:31], v[30:31], v[14:15]
    v_pk_add_f32 v[12:13], v[12:13], v[32:33]
    v_pk_fma_f32 v[14:15], v[32:33], v[32:33], v[14:15]
    v_pk_add_f32 v[12:13], v[12:13], v[34:35]
    v_pk_fma_f32 v[14:15], v[34:35], v[34:35], v[14:15]
    v_pk_add_f32 v[12:13], v[12:13], v[36:37]
    v_pk_fma_f32 v[14:15], v[36:37], v[36:37], v[14:15]
    v_pk_add_f32 v[12:13], v[12:13], v[38:39]
    v_pk_fma_f32 v[14:15], v[38:39], v[38:39], v[14:15]
    v_pk_add_f32 v[12:13], v[12:13], v[40:41]
    v_pk_fma_f32 v[14:15], v[40:41], v[40:41], v[14:15]
    v_pk_add_f32 v[12:13], v[12:13], v[42:43]
    v_pk_fma_f32 v[14:15], v[42:43], v[42:43], v[14:15]
    v_add_f32 v12, v12, v13
    v_add_f32 v13, v14, v15
    v_mov_b32 v14, v12
    v_mov_b32 v15, v13
    s_nop 0
    v_permlane16_swap_b32 v12, v14
    v_permlane16_swap_b32 v13, v15
    v_pk_add_f32 v[12:13], v[12:13], v[14:15]
    v_mov_b32 v14, v12
    v_mov_b32 v15, v13
    s_nop 0
    v_permlane32_swap_b32 v12, v14
    v_permlane32_swap_b32 v13, v15
    v_pk_add_f32 v[12:13], v[12:13], v[14:15]
    s_mov_b64 exec, 0xffff
    s_cmp_eq_u32 s38, 0
    s_cbranch_scc1 L_wt_1035
    buffer_store_dwordx2 v[12:13], v2, s[8:11], s27 offen
L_wb_1036:
    s_mov_b64 exec, -1
.p2align 3
    v_cvt_pk_bf16_f32 v44, v24, v25
    v_cvt_pk_bf16_f32 v45, v26, v27
    v_cvt_pk_bf16_f32 v46, v28, v29
    v_cvt_pk_bf16_f32 v47, v30, v31
    v_cvt_pk_bf16_f32 v48, v32, v33
    v_cvt_pk_bf16_f32 v49, v34, v35
    v_cvt_pk_bf16_f32 v50, v36, v37
    v_cvt_pk_bf16_f32 v51, v38, v39
    v_cvt_pk_bf16_f32 v52, v40, v41
    v_cvt_pk_bf16_f32 v53, v42, v43
    s_waitcnt vmcnt(3)
    v_lshlrev_b32 v160, 16, v224
    v_and_b32 v161, s39, v224
    v_lshlrev_b32 v162, 16, v225
    v_and_b32 v163, s39, v225
    v_lshlrev_b32 v164, 16, v226
    v_and_b32 v165, s39, v226
    v_lshlrev_b32 v166, 16, v227
    v_and_b32 v167, s39, v227
    v_lshlrev_b32 v168, 16, v228
    v_and_b32 v169, s39, v228
    v_lshlrev_b32 v170, 16, v229
    v_and_b32 v171, s39, v229
    v_lshlrev_b32 v172, 16, v230
    v_and_b32 v173, s39, v230
    v_lshlrev_b32 v174, 16, v231
    v_and_b32 v175, s39, v231
    v_lshlrev_b32 v176, 16, v232
    v_and_b32 v177, s39, v232
    v_lshlrev_b32 v178, 16, v233
    v_and_b32 v179, s39, v233
    v_lshlrev_b32 v24, 16, v44
    v_and_b32 v25, s39, v44
    v_lshlrev_b32 v26, 16, v45
    v_and_b32 v27, s39, v45
    v_lshlrev_b32 v28, 16, v46
    v_and_b32 v29, s39, v46
    v_lshlrev_b32 v30, 16, v47
    v_and_b32 v31, s39, v47
    v_lshlrev_b32 v32, 16, v48
    v_and_b32 v33, s39, v48
    v_lshlrev_b32 v34, 16, v49
    v_and_b32 v35, s39, v49
    v_lshlrev_b32 v36, 16, v50
    v_and_b32 v37, s39, v50
    v_lshlrev_b32 v38, 16, v51
    v_and_b32 v39, s39, v51
    v_lshlrev_b32 v40, 16, v52
    v_and_b32 v41, s39, v52
    v_lshlrev_b32 v42, 16, v53
    v_and_b32 v43, s39, v53
.p2align 3
    buffer_load_dwordx4 v[76:79], v2, s[8:11], s26 offen sc1
    v_pk_mul_f32 v[56:57], v[24:25], v[160:161]
    v_pk_mul_f32 v[58:59], v[26:27], v[162:163]
    v_pk_mul_f32 v[60:61], v[28:29], v[164:165]
    v_pk_mul_f32 v[62:63], v[30:31], v[166:167]
    v_pk_mul_f32 v[64:65], v[32:33], v[168:169]
    v_pk_mul_f32 v[66:67], v[34:35], v[170:171]
    v_pk_mul_f32 v[68:69], v[36:37], v[172:173]
    v_pk_mul_f32 v[70:71], v[38:39], v[174:175]
    v_pk_mul_f32 v[72:73], v[40:41], v[176:177]
    v_pk_mul_f32 v[74:75], v[42:43], v[178:179]
    s_lshl_b32 s29, s44, 7
    s_add_u32 s29, s29, 16662528
    s_lshl_b32 s34, s45, 4
    s_lshl_b32 s35, s3, 2
    s_add_u32 s34, s34, s35
    v_mov_b32 v8, s34
    s_lshl_b32 s36, s24, 7
    s_add_u32 s36, s36, 16662528
    s_mov_b32 s35, 262144
L_g2poll_1037:
    s_waitcnt vmcnt(0)
    v_max_u32 v17, v77, v79
    v_cmp_eq_u32 vcc, -1, v17
    s_cbranch_vccz L_g2ok_1038
    buffer_load_dwordx4 v[76:79], v2, s[8:11], s26 offen sc1
    s_sub_u32 s35, s35, 1
    s_cbranch_scc0 L_g2poll_1037
    s_waitcnt vmcnt(0)
L_g2ok_1038:
    v_pk_add_f32 v[12:13], v[76:77], v[78:79]
    v_mov_b32 v14, v12
    v_mov_b32 v15, v13
    s_nop 0
    v_permlane16_swap_b32 v12, v14
    v_permlane16_swap_b32 v13, v15
    v_pk_add_f32 v[12:13], v[12:13], v[14:15]
    v_mov_b32 v14, v12
    v_mov_b32 v15, v13
    s_nop 0
    v_permlane32_swap_b32 v12, v14
    v_permlane32_swap_b32 v13, v15
    v_pk_add_f32 v[12:13], v[12:13], v[14:15]
    v_mul_f32 v14, 0x3acccccd, v12
    v_mul_f32 v15, 0x3acccccd, v13
    v_fma_f32 v15, -v14, v14, v15
    v_max_f32 v15, 0, v15
    v_cvt_pk_bf16_f32 v14, v14, v14
    v_lshlrev_b32 v14, 16, v14
    v_cvt_pk_bf16_f32 v15, v15, v15
    v_lshlrev_b32 v15, 16, v15
    v_add_f32 v15, 0x3727c5ac, v15
    v_cvt_pk_bf16_f32 v15, v15, v15
    v_lshlrev_b32 v15, 16, v15
    v_sqrt_f32 v15, v15
    s_nop 0
    v_cvt_pk_bf16_f32 v15, v15, v15
    v_lshlrev_b32 v15, 16, v15
    v_rcp_f32 v15, v15
    s_nop 0
    v_mul_f32 v14, v14, v15
.p2align 3
    v_pk_fma_f32 v[24:25], v[56:57], v[14:15], v[24:25] op_sel:[0,1,0] op_sel_hi:[1,1,1]
    v_pk_fma_f32 v[26:27], v[58:59], v[14:15], v[26:27] op_sel:[0,1,0] op_sel_hi:[1,1,1]
    v_pk_fma_f32 v[28:29], v[60:61], v[14:15], v[28:29] op_sel:[0,1,0] op_sel_hi:[1,1,1]
    v_pk_fma_f32 v[30:31], v[62:63], v[14:15], v[30:31] op_sel:[0,1,0] op_sel_hi:[1,1,1]
    v_pk_fma_f32 v[32:33], v[64:65], v[14:15], v[32:33] op_sel:[0,1,0] op_sel_hi:[1,1,1]
    v_pk_fma_f32 v[34:35], v[66:67], v[14:15], v[34:35] op_sel:[0,1,0] op_sel_hi:[1,1,1]
    v_pk_fma_f32 v[36:37], v[68:69], v[14:15], v[36:37] op_sel:[0,1,0] op_sel_hi:[1,1,1]
    v_pk_fma_f32 v[38:39], v[70:71], v[14:15], v[38:39] op_sel:[0,1,0] op_sel_hi:[1,1,1]
    v_pk_fma_f32 v[40:41], v[72:73], v[14:15], v[40:41] op_sel:[0,1,0] op_sel_hi:[1,1,1]
    v_pk_fma_f32 v[42:43], v[74:75], v[14:15], v[42:43] op_sel:[0,1,0] op_sel_hi:[1,1,1]
    v_pk_fma_f32 v[24:25], v[160:161], v[14:15], v[24:25] op_sel_hi:[1,0,1] neg_lo:[0,1,0] neg_hi:[0,1,0]
    v_pk_fma_f32 v[26:27], v[162:163], v[14:15], v[26:27] op_sel_hi:[1,0,1] neg_lo:[0,1,0] neg_hi:[0,1,0]
    v_pk_fma_f32 v[28:29], v[164:165], v[14:15], v[28:29] op_sel_hi:[1,0,1] neg_lo:[0,1,0] neg_hi:[0,1,0]
    v_pk_fma_f32 v[30:31], v[166:167], v[14:15], v[30:31] op_sel_hi:[1,0,1] neg_lo:[0,1,0] neg_hi:[0,1,0]
    v_pk_fma_f32 v[32:33], v[168:169], v[14:15], v[32:33] op_sel_hi:[1,0,1] neg_lo:[0,1,0] neg_hi:[0,1,0]
    v_pk_fma_f32 v[34:35], v[170:171], v[14:15], v[34:35] op_sel_hi:[1,0,1] neg_lo:[0,1,0] neg_hi:[0,1,0]
    v_pk_fma_f32 v[36:37], v[172:173], v[14:15], v[36:37] op_sel_hi:[1,0,1] neg_lo:[0,1,0] neg_hi:[0,1,0]
    v_pk_fma_f32 v[38:39], v[174:175], v[14:15], v[38:39] op_sel_hi:[1,0,1] neg_lo:[0,1,0] neg_hi:[0,1,0]
    v_pk_fma_f32 v[40:41], v[176:177], v[14:15], v[40:41] op_sel_hi:[1,0,1] neg_lo:[0,1,0] neg_hi:[0,1,0]
    v_pk_fma_f32 v[42:43], v[178:179], v[14:15], v[42:43] op_sel_hi:[1,0,1] neg_lo:[0,1,0] neg_hi:[0,1,0]
    v_cvt_pk_bf16_f32 v44, v24, v25
    v_cvt_pk_bf16_f32 v45, v26, v27
    v_cvt_pk_bf16_f32 v46, v28, v29
    v_cvt_pk_bf16_f32 v47, v30, v31
    v_cvt_pk_bf16_f32 v48, v32, v33
    v_cvt_pk_bf16_f32 v49, v34, v35
    v_cvt_pk_bf16_f32 v50, v36, v37
    v_cvt_pk_bf16_f32 v51, v38, v39
    v_cvt_pk_bf16_f32 v52, v40, v41
    v_cvt_pk_bf16_f32 v53, v42, v43
    s_cmp_eq_u32 s38, 0
    s_cbranch_scc1 L_wt_1039
    buffer_store_dwordx2 v[44:45], v21, s[8:11], s23 offen offset:0
    buffer_store_dwordx2 v[46:47], v21, s[8:11], s23 offen offset:2048
    buffer_store_dwordx2 v[48:49], v21, s[8:11], s25 offen offset:0
    buffer_store_dwordx2 v[50:51], v21, s[8:11], s25 offen offset:2048
    buffer_store_dwordx2 v[52:53], v21, s[8:11], s28 offen offset:0
L_wb_1040:
.p2align 3
    v_pk_add_f32 v[12:13], v[24:25], v[26:27]
    v_pk_mul_f32 v[14:15], v[24:25], v[24:25]
    v_pk_fma_f32 v[14:15], v[26:27], v[26:27], v[14:15]
    v_pk_add_f32 v[12:13], v[12:13], v[28:29]
    v_pk_fma_f32 v[14:15], v[28:29], v[28:29], v[14:15]
    v_pk_add_f32 v[12:13], v[12:13], v[30:31]
    v_pk_fma_f32 v[14:15], v[30:31], v[30:31], v[14:15]
    v_pk_add_f32 v[12:13], v[12:13], v[32:33]
    v_pk_fma_f32 v[14:15], v[32:33], v[32:33], v[14:15]
    v_pk_add_f32 v[12:13], v[12:13], v[34:35]
    v_pk_fma_f32 v[14:15], v[34:35], v[34:35], v[14:15]
    v_pk_add_f32 v[12:13], v[12:13], v[36:37]
    v_pk_fma_f32 v[14:15], v[36:37], v[36:37], v[14:15]
    v_pk_add_f32 v[12:13], v[12:13], v[38:39]
    v_pk_fma_f32 v[14:15], v[38:39], v[38:39], v[14:15]
    v_pk_add_f32 v[12:13], v[12:13], v[40:41]
    v_pk_fma_f32 v[14:15], v[40:41], v[40:41], v[14:15]
    v_pk_add_f32 v[12:13], v[12:13], v[42:43]
    v_pk_fma_f32 v[14:15], v[42:43], v[42:43], v[14:15]
    v_add_f32 v12, v12, v13
    v_add_f32 v13, v14, v15
    s_waitcnt vmcnt(0)
    s_mov_b64 exec, 1
    s_cmp_eq_u32 s38, 0
    s_cbranch_scc1 L_wt_1041
    buffer_store_dword v9, v8, s[8:11], s29 offen offset:0
L_wb_1042:
    s_mov_b64 exec, -1
    v_mov_b32 v14, v12
    v_mov_b32 v15, v13
    s_nop 0
    v_permlane16_swap_b32 v12, v14
    v_permlane16_swap_b32 v13, v15
    v_pk_add_f32 v[12:13], v[12:13], v[14:15]
    v_mov_b32 v14, v12
    v_mov_b32 v15, v13
    s_nop 0
    v_permlane32_swap_b32 v12, v14
    v_permlane32_swap_b32 v13, v15
    v_pk_add_f32 v[12:13], v[12:13], v[14:15]
    s_mov_b64 exec, 0xffff
    s_cmp_eq_u32 s38, 0
    s_cbranch_scc1 L_wt_1043
    buffer_store_dwordx2 v[12:13], v2, s[8:11], s22 offen
L_wb_1044:
    s_mov_b64 exec, -1
    ds_read_b64_tr_b16 v[24:25], v10 offset:0
    ds_read_b64_tr_b16 v[26:27], v10 offset:384
    ds_read_b64_tr_b16 v[28:29], v10 offset:32
    ds_read_b64_tr_b16 v[30:31], v10 offset:416
    ds_read_b64_tr_b16 v[32:33], v10 offset:64
    ds_read_b64_tr_b16 v[34:35], v10 offset:448
    buffer_load_dword v18, v11, s[8:11], s36 offen sc1
    s_mov_b32 s101, 1
    s_mov_b32 s37, s38
    s_waitcnt vmcnt(0)
    v_cmp_eq_u32 vcc, s96, v18
    s_nop 0
    s_and_b32 s34, vcc_lo, 0xffffffff
    s_cmp_lg_u32 s34, 0xffffffff
    s_cbranch_scc1 L_spin_1045
L_back_1046:
L_g1_1:
    s_mul_i32 s25, s24, 81920
    s_add_u32 s25, s25, 2637824
    buffer_load_dwordx4 v[160:163], v5, s[8:11], s25 offen offset:0 sc1
    buffer_load_dwordx4 v[164:167], v5, s[8:11], s25 offen offset:512 sc1
    buffer_load_dwordx4 v[168:171], v5, s[8:11], s25 offen offset:2048 sc1
    buffer_load_dwordx4 v[172:175], v5, s[8:11], s25 offen offset:2560 sc1
    s_add_u32 s25, s25, 4096
    buffer_load_dwordx4 v[176:179], v5, s[8:11], s25 offen offset:0 sc1
    buffer_load_dwordx4 v[180:183], v5, s[8:11], s25 offen offset:512 sc1
    buffer_load_dwordx4 v[184:187], v5, s[8:11], s25 offen offset:2048 sc1
    buffer_load_dwordx4 v[188:191], v5, s[8:11], s25 offen offset:2560 sc1
    s_add_u32 s25, s25, 4096
    s_waitcnt vmcnt(6)
    v_swap_b32 v162, v164
    v_swap_b32 v163, v165
    s_waitcnt lgkmcnt(0)
    s_nop 0
    v_mfma_f32_32x32x16_bf16 v[48:63], v[24:27], v[160:163], 0
    ds_read_b64_tr_b16 v[36:37], v10 offset:1536
    ds_read_b64_tr_b16 v[38:39], v10 offset:1920
    ds_read_b64_tr_b16 v[40:41], v10 offset:1568
    ds_read_b64_tr_b16 v[42:43], v10 offset:1952
    ds_read_b64_tr_b16 v[44:45], v10 offset:1600
    ds_read_b64_tr_b16 v[46:47], v10 offset:1984
    v_mfma_f32_32x32x16_bf16 v[64:79], v[24:27], v[164:167], 0
    buffer_load_dwordx4 v[192:195], v5, s[8:11], s25 offen offset:0 sc1
    s_lshl_b32 s26, s24, 12
    s_add_u32 s26, s26, 16498688
    v_mfma_f32_32x32x16_bf16 v[80:95], v[28:31], v[160:163], 0
    s_waitcnt vmcnt(5)
    v_swap_b32 v170, v172
    v_swap_b32 v171, v173
    v_mfma_f32_32x32x16_bf16 v[96:111], v[28:31], v[164:167], 0
    buffer_load_dwordx4 v[196:199], v5, s[8:11], s25 offen offset:512 sc1
    s_mul_i32 s27, s24, 196608
    s_mul_i32 s28, s21, 3072
    v_mfma_f32_32x32x16_bf16 v[112:127], v[32:35], v[160:163], 0
    s_add_u32 s27, s27, s28
    s_add_u32 s27, s27, 7880704
    s_add_u32 s28, s27, 98304
    v_mfma_f32_32x32x16_bf16 v[128:143], v[32:35], v[164:167], 0
    buffer_load_dwordx4 v[200:203], v5, s[8:11], s25 offen offset:2048 sc1
    s_waitcnt lgkmcnt(0)
    v_mfma_f32_32x32x16_bf16 v[48:63], v[36:39], v[168:171], v[48:63]
    ds_read_b64_tr_b16 v[24:25], v10 offset:3072
    ds_read_b64_tr_b16 v[26:27], v10 offset:3456
    ds_read_b64_tr_b16 v[28:29], v10 offset:3104
    ds_read_b64_tr_b16 v[30:31], v10 offset:3488
    ds_read_b64_tr_b16 v[32:33], v10 offset:3136
    ds_read_b64_tr_b16 v[34:35], v10 offset:3520
    v_mfma_f32_32x32x16_bf16 v[64:79], v[36:39], v[172:175], v[64:79]
    buffer_load_dwordx4 v[204:207], v5, s[8:11], s25 offen offset:2560 sc1
    s_add_u32 s25, s25, 4096
    v_mfma_f32_32x32x16_bf16 v[80:95], v[40:43], v[168:171], v[80:95]
    s_waitcnt vmcnt(6)
    v_swap_b32 v178, v180
    v_swap_b32 v179, v181
    v_mfma_f32_32x32x16_bf16 v[96:111], v[40:43], v[172:175], v[96:111]
    buffer_load_dwordx4 v[208:211], v5, s[8:11], s25 offen offset:0 sc1
    v_mfma_f32_32x32x16_bf16 v[112:127], v[44:47], v[168:171], v[112:127]
    v_mfma_f32_32x32x16_bf16 v[128:143], v[44:47], v[172:175], v[128:143]
    buffer_load_dwordx4 v[212:215], v5, s[8:11], s25 offen offset:512 sc1
    s_waitcnt lgkmcnt(0)
    v_mfma_f32_32x32x16_bf16 v[48:63], v[24:27], v[176:179], v[48:63]
    ds_read_b64_tr_b16 v[36:37], v10 offset:4608
    ds_read_b64_tr_b16 v[38:39], v10 offset:4992
    ds_read_b64_tr_b16 v[40:41], v10 offset:4640
    ds_read_b64_tr_b16 v[42:43], v10 offset:5024
    ds_read_b64_tr_b16 v[44:45], v10 offset:4672
    ds_read_b64_tr_b16 v[46:47], v10 offset:5056
    v_mfma_f32_32x32x16_bf16 v[64:79], v[24:27], v[180:183], v[64:79]
    buffer_load_dwordx4 v[216:219], v5, s[8:11], s25 offen offset:2048 sc1
    v_mfma_f32_32x32x16_bf16 v[80:95], v[28:31], v[176:179], v[80:95]
    s_waitcnt vmcnt(7)
    v_swap_b32 v186, v188
    v_swap_b32 v187, v189
    v_mfma_f32_32x32x16_bf16 v[96:111], v[28:31], v[180:183], v[96:111]
    buffer_load_dwordx4 v[220:223], v5, s[8:11], s25 offen offset:2560 sc1
    s_add_u32 s25, s25, 4096
    v_mfma_f32_32x32x16_bf16 v[112:127], v[32:35], v[176:179], v[112:127]
    v_mfma_f32_32x32x16_bf16 v[128:143], v[32:35], v[180:183], v[128:143]
    buffer_load_dwordx4 v[224:227], v5, s[8:11], s25 offen offset:0 sc1
    s_waitcnt lgkmcnt(0)
    v_mfma_f32_32x32x16_bf16 v[48:63], v[36:39], v[184:187], v[48:63]
    ds_read_b64_tr_b16 v[24:25], v10 offset:6144
    ds_read_b64_tr_b16 v[26:27], v10 offset:6528
    ds_read_b64_tr_b16 v[28:29], v10 offset:6176
    ds_read_b64_tr_b16 v[30:31], v10 offset:6560
    ds_read_b64_tr_b16 v[32:33], v10 offset:6208
    ds_read_b64_tr_b16 v[34:35], v10 offset:6592
    v_mfma_f32_32x32x16_bf16 v[64:79], v[36:39], v[188:191], v[64:79]
    buffer_load_dwordx4 v[228:231], v5, s[8:11], s25 offen offset:512 sc1
    v_mfma_f32_32x32x16_bf16 v[80:95], v[40:43], v[184:187], v[80:95]
    s_waitcnt vmcnt(8)
    v_swap_b32 v194, v196
    v_swap_b32 v195, v197
    v_mfma_f32_32x32x16_bf16 v[96:111], v[40:43], v[188:191], v[96:111]
    buffer_load_dwordx4 v[232:235], v5, s[8:11], s25 offen offset:2048 sc1
    v_mfma_f32_32x32x16_bf16 v[112:127], v[44:47], v[184:187], v[112:127]
    v_mfma_f32_32x32x16_bf16 v[128:143], v[44:47], v[188:191], v[128:143]
    buffer_load_dwordx4 v[236:239], v5, s[8:11], s25 offen offset:2560 sc1
    s_add_u32 s25, s25, 4096
    s_waitcnt lgkmcnt(0)
    v_mfma_f32_32x32x16_bf16 v[48:63], v[24:27], v[192:195], v[48:63]
    ds_read_b64_tr_b16 v[36:37], v10 offset:7680
    ds_read_b64_tr_b16 v[38:39], v10 offset:8064
    ds_read_b64_tr_b16 v[40:41], v10 offset:7712
    ds_read_b64_tr_b16 v[42:43], v10 offset:8096
    ds_read_b64_tr_b16 v[44:45], v10 offset:7744
    ds_read_b64_tr_b16 v[46:47], v10 offset:8128
    v_mfma_f32_32x32x16_bf16 v[64:79], v[24:27], v[196:199], v[64:79]
    buffer_load_dwordx4 v[240:243], v5, s[8:11], s25 offen offset:0 sc1
    v_mfma_f32_32x32x16_bf16 v[80:95], v[28:31], v[192:195], v[80:95]
    s_waitcnt vmcnt(9)
    v_swap_b32 v202, v204
    v_swap_b32 v203, v205
    v_mfma_f32_32x32x16_bf16 v[96:111], v[28:31], v[196:199], v[96:111]
    buffer_load_dwordx4 v[244:247], v5, s[8:11], s25 offen offset:512 sc1
    v_mfma_f32_32x32x16_bf16 v[112:127], v[32:35], v[192:195], v[112:127]
    v_mfma_f32_32x32x16_bf16 v[128:143], v[32:35], v[196:199], v[128:143]
    buffer_load_dwordx4 v[248:251], v5, s[8:11], s25 offen offset:2048 sc1
    s_waitcnt lgkmcnt(0)
    v_mfma_f32_32x32x16_bf16 v[48:63], v[36:39], v[200:203], v[48:63]
    ds_read_b64_tr_b16 v[24:25], v10 offset:9216
    ds_read_b64_tr_b16 v[26:27], v10 offset:9600
    ds_read_b64_tr_b16 v[28:29], v10 offset:9248
    ds_read_b64_tr_b16 v[30:31], v10 offset:9632
    ds_read_b64_tr_b16 v[32:33], v10 offset:9280
    ds_read_b64_tr_b16 v[34:35], v10 offset:9664
    v_mfma_f32_32x32x16_bf16 v[64:79], v[36:39], v[204:207], v[64:79]
    buffer_load_dwordx4 v[252:255], v5, s[8:11], s25 offen offset:2560 sc1
    s_add_u32 s25, s25, 4096
    v_mfma_f32_32x32x16_bf16 v[80:95], v[40:43], v[200:203], v[80:95]
    s_waitcnt vmcnt(10)
    v_swap_b32 v210, v212
    v_swap_b32 v211, v213
    v_mfma_f32_32x32x16_bf16 v[96:111], v[40:43], v[204:207], v[96:111]
    buffer_load_dwordx4 v[160:163], v5, s[8:11], s25 offen offset:0 sc1
    v_mfma_f32_32x32x16_bf16 v[112:127], v[44:47], v[200:203], v[112:127]
    v_mfma_f32_32x32x16_bf16 v[128:143], v[44:47], v[204:207], v[128:143]
    buffer_load_dwordx4 v[164:167], v5, s[8:11], s25 offen offset:512 sc1
    s_waitcnt lgkmcnt(0)
    v_mfma_f32_32x32x16_bf16 v[48:63], v[24:27], v[208:211], v[48:63]
    ds_read_b64_tr_b16 v[36:37], v10 offset:10752
    ds_read_b64_tr_b16 v[38:39], v10 offset:11136
    ds_read_b64_tr_b16 v[40:41], v10 offset:10784
    ds_read_b64_tr_b16 v[42:43], v10 offset:11168
    ds_read_b64_tr_b16 v[44:45], v10 offset:10816
    ds_read_b64_tr_b16 v[46:47], v10 offset:11200
    v_mfma_f32_32x32x16_bf16 v[64:79], v[24:27], v[212:215], v[64:79]
    buffer_load_dwordx4 v[168:171], v5, s[8:11], s25 offen offset:2048 sc1
    v_mfma_f32_32x32x16_bf16 v[80:95], v[28:31], v[208:211], v[80:95]
    s_waitcnt vmcnt(11)
    v_swap_b32 v218, v220
    v_swap_b32 v219, v221
    v_mfma_f32_32x32x16_bf16 v[96:111], v[28:31], v[212:215], v[96:111]
    buffer_load_dwordx4 v[172:175], v5, s[8:11], s25 offen offset:2560 sc1
    s_add_u32 s25, s25, 4096
    v_mfma_f32_32x32x16_bf16 v[112:127], v[32:35], v[208:211], v[112:127]
    v_mfma_f32_32x32x16_bf16 v[128:143], v[32:35], v[212:215], v[128:143]
    buffer_load_dwordx4 v[176:179], v5, s[8:11], s25 offen offset:0 sc1
    s_waitcnt lgkmcnt(0)
    v_mfma_f32_32x32x16_bf16 v[48:63], v[36:39], v[216:219], v[48:63]
    ds_read_b64_tr_b16 v[24:25], v10 offset:12288
    ds_read_b64_tr_b16 v[26:27], v10 offset:12672
    ds_read_b64_tr_b16 v[28:29], v10 offset:12320
    ds_read_b64_tr_b16 v[30:31], v10 offset:12704
    ds_read_b64_tr_b16 v[32:33], v10 offset:12352
    ds_read_b64_tr_b16 v[34:35], v10 offset:12736
    v_mfma_f32_32x32x16_bf16 v[64:79], v[36:39], v[220:223], v[64:79]
    buffer_load_dwordx4 v[180:183], v5, s[8:11], s25 offen offset:512 sc1
    v_mfma_f32_32x32x16_bf16 v[80:95], v[40:43], v[216:219], v[80:95]
    s_waitcnt vmcnt(12)
    v_swap_b32 v226, v228
    v_swap_b32 v227, v229
    v_mfma_f32_32x32x16_bf16 v[96:111], v[40:43], v[220:223], v[96:111]
    buffer_load_dwordx4 v[184:187], v5, s[8:11], s25 offen offset:2048 sc1
    v_mfma_f32_32x32x16_bf16 v[112:127], v[44:47], v[216:219], v[112:127]
    v_mfma_f32_32x32x16_bf16 v[128:143], v[44:47], v[220:223], v[128:143]
    buffer_load_dwordx4 v[188:191], v5, s[8:11], s25 offen offset:2560 sc1
    s_add_u32 s25, s25, 4096
    s_waitcnt lgkmcnt(0)
    v_mfma_f32_32x32x16_bf16 v[48:63], v[24:27], v[224:227], v[48:63]
    ds_read_b64_tr_b16 v[36:37], v10 offset:13824
    ds_read_b64_tr_b16 v[38:39], v10 offset:14208
    ds_read_b64_tr_b16 v[40:41], v10 offset:13856
    ds_read_b64_tr_b16 v[42:43], v10 offset:14240
    ds_read_b64_tr_b16 v[44:45], v10 offset:13888
    ds_read_b64_tr_b16 v[46:47], v10 offset:14272
    v_mfma_f32_32x32x16_bf16 v[64:79], v[24:27], v[228:231], v[64:79]
    buffer_load_dwordx4 v[192:195], v5, s[8:11], s25 offen offset:0 sc1
    v_mfma_f32_32x32x16_bf16 v[80:95], v[28:31], v[224:227], v[80:95]
    s_waitcnt vmcnt(13)
    v_swap_b32 v234, v236
    v_swap_b32 v235, v237
    v_mfma_f32_32x32x16_bf16 v[96:111], v[28:31], v[228:231], v[96:111]
    buffer_load_dwordx4 v[196:199], v5, s[8:11], s25 offen offset:512 sc1
    v_mfma_f32_32x32x16_bf16 v[112:127], v[32:35], v[224:227], v[112:127]
    v_mfma_f32_32x32x16_bf16 v[128:143], v[32:35], v[228:231], v[128:143]
    buffer_load_dwordx4 v[200:203], v5, s[8:11], s25 offen offset:2048 sc1
    s_waitcnt lgkmcnt(0)
    v_mfma_f32_32x32x16_bf16 v[48:63], v[36:39], v[232:235], v[48:63]
    ds_read_b64_tr_b16 v[24:25], v10 offset:15360
    ds_read_b64_tr_b16 v[26:27], v10 offset:15744
    ds_read_b64_tr_b16 v[28:29], v10 offset:15392
    ds_read_b64_tr_b16 v[30:31], v10 offset:15776
    ds_read_b64_tr_b16 v[32:33], v10 offset:15424
    ds_read_b64_tr_b16 v[34:35], v10 offset:15808
    v_mfma_f32_32x32x16_bf16 v[64:79], v[36:39], v[236:239], v[64:79]
    buffer_load_dwordx4 v[204:207], v5, s[8:11], s25 offen offset:2560 sc1
    s_add_u32 s25, s25, 4096
    v_mfma_f32_32x32x16_bf16 v[80:95], v[40:43], v[232:235], v[80:95]
    s_waitcnt vmcnt(14)
    v_swap_b32 v242, v244
    v_swap_b32 v243, v245
    v_mfma_f32_32x32x16_bf16 v[96:111], v[40:43], v[236:239], v[96:111]
    buffer_load_dwordx4 v[208:211], v5, s[8:11], s25 offen offset:0 sc1
    v_mfma_f32_32x32x16_bf16 v[112:127], v[44:47], v[232:235], v[112:127]
    v_mfma_f32_32x32x16_bf16 v[128:143], v[44:47], v[236:239], v[128:143]
    buffer_load_dwordx4 v[212:215], v5, s[8:11], s25 offen offset:512 sc1
    s_waitcnt lgkmcnt(0)
    v_mfma_f32_32x32x16_bf16 v[48:63], v[24:27], v[240:243], v[48:63]
    ds_read_b64_tr_b16 v[36:37], v10 offset:16896
    ds_read_b64_tr_b16 v[38:39], v10 offset:17280
    ds_read_b64_tr_b16 v[40:41], v10 offset:16928
    ds_read_b64_tr_b16 v[42:43], v10 offset:17312
    ds_read_b64_tr_b16 v[44:45], v10 offset:16960
    ds_read_b64_tr_b16 v[46:47], v10 offset:17344
    v_mfma_f32_32x32x16_bf16 v[64:79], v[24:27], v[244:247], v[64:79]
    buffer_load_dwordx4 v[216:219], v5, s[8:11], s25 offen offset:2048 sc1
    v_mfma_f32_32x32x16_bf16 v[80:95], v[28:31], v[240:243], v[80:95]
    s_waitcnt vmcnt(15)
    v_swap_b32 v250, v252
    v_swap_b32 v251, v253
    v_mfma_f32_32x32x16_bf16 v[96:111], v[28:31], v[244:247], v[96:111]
    buffer_load_dwordx4 v[220:223], v5, s[8:11], s25 offen offset:2560 sc1
    s_add_u32 s25, s25, 4096
    v_mfma_f32_32x32x16_bf16 v[112:127], v[32:35], v[240:243], v[112:127]
    v_mfma_f32_32x32x16_bf16 v[128:143], v[32:35], v[244:247], v[128:143]
    buffer_load_dwordx4 v[224:227], v5, s[8:11], s25 offen offset:0 sc1
    s_waitcnt lgkmcnt(0)
    v_mfma_f32_32x32x16_bf16 v[48:63], v[36:39], v[248:251], v[48:63]
    ds_read_b64_tr_b16 v[24:25], v10 offset:18432
    ds_read_b64_tr_b16 v[26:27], v10 offset:18816
    ds_read_b64_tr_b16 v[28:29], v10 offset:18464
    ds_read_b64_tr_b16 v[30:31], v10 offset:18848
    ds_read_b64_tr_b16 v[32:33], v10 offset:18496
    ds_read_b64_tr_b16 v[34:35], v10 offset:18880
    v_mfma_f32_32x32x16_bf16 v[64:79], v[36:39], v[252:255], v[64:79]
    buffer_load_dwordx4 v[228:231], v5, s[8:11], s25 offen offset:512 sc1
    v_mfma_f32_32x32x16_bf16 v[80:95], v[40:43], v[248:251], v[80:95]
    s_waitcnt vmcnt(16)
    v_swap_b32 v162, v164
    v_swap_b32 v163, v165
    v_mfma_f32_32x32x16_bf16 v[96:111], v[40:43], v[252:255], v[96:111]
    buffer_load_dwordx4 v[232:235], v5, s[8:11], s25 offen offset:2048 sc1
    v_mfma_f32_32x32x16_bf16 v[112:127], v[44:47], v[248:251], v[112:127]
    v_mfma_f32_32x32x16_bf16 v[128:143], v[44:47], v[252:255], v[128:143]
    buffer_load_dwordx4 v[236:239], v5, s[8:11], s25 offen offset:2560 sc1
    s_add_u32 s25, s25, 4096
    s_waitcnt lgkmcnt(0)
    v_mfma_f32_32x32x16_bf16 v[48:63], v[24:27], v[160:163], v[48:63]
    ds_read_b64_tr_b16 v[36:37], v10 offset:19968
    ds_read_b64_tr_b16 v[38:39], v10 offset:20352
    ds_read_b64_tr_b16 v[40:41], v10 offset:20000
    ds_read_b64_tr_b16 v[42:43], v10 offset:20384
    ds_read_b64_tr_b16 v[44:45], v10 offset:20032
    ds_read_b64_tr_b16 v[46:47], v10 offset:20416
    v_mfma_f32_32x32x16_bf16 v[64:79], v[24:27], v[164:167], v[64:79]
    buffer_load_dwordx4 v[240:243], v5, s[8:11], s25 offen offset:0 sc1
    v_mfma_f32_32x32x16_bf16 v[80:95], v[28:31], v[160:163], v[80:95]
    s_waitcnt vmcnt(17)
    v_swap_b32 v170, v172
    v_swap_b32 v171, v173
    v_mfma_f32_32x32x16_bf16 v[96:111], v[28:31], v[164:167], v[96:111]
    buffer_load_dwordx4 v[244:247], v5, s[8:11], s25 offen offset:512 sc1
    v_mfma_f32_32x32x16_bf16 v[112:127], v[32:35], v[160:163], v[112:127]
    v_mfma_f32_32x32x16_bf16 v[128:143], v[32:35], v[164:167], v[128:143]
    buffer_load_dwordx4 v[248:251], v5, s[8:11], s25 offen offset:2048 sc1
    s_waitcnt lgkmcnt(0)
    v_mfma_f32_32x32x16_bf16 v[48:63], v[36:39], v[168:171], v[48:63]
    ds_read_b64_tr_b16 v[24:25], v10 offset:21504
    ds_read_b64_tr_b16 v[26:27], v10 offset:21888
    ds_read_b64_tr_b16 v[28:29], v10 offset:21536
    ds_read_b64_tr_b16 v[30:31], v10 offset:21920
    ds_read_b64_tr_b16 v[32:33], v10 offset:21568
    ds_read_b64_tr_b16 v[34:35], v10 offset:21952
    v_mfma_f32_32x32x16_bf16 v[64:79], v[36:39], v[172:175], v[64:79]
    buffer_load_dwordx4 v[252:255], v5, s[8:11], s25 offen offset:2560 sc1
    s_add_u32 s25, s25, 4096
    v_mfma_f32_32x32x16_bf16 v[80:95], v[40:43], v[168:171], v[80:95]
    s_waitcnt vmcnt(18)
    v_swap_b32 v178, v180
    v_swap_b32 v179, v181
    v_mfma_f32_32x32x16_bf16 v[96:111], v[40:43], v[172:175], v[96:111]
    buffer_load_dwordx4 v[160:163], v5, s[8:11], s25 offen offset:0 sc1
    v_mfma_f32_32x32x16_bf16 v[112:127], v[44:47], v[168:171], v[112:127]
    v_mfma_f32_32x32x16_bf16 v[128:143], v[44:47], v[172:175], v[128:143]
    buffer_load_dwordx4 v[164:167], v5, s[8:11], s25 offen offset:512 sc1
    s_waitcnt lgkmcnt(0)
    v_mfma_f32_32x32x16_bf16 v[48:63], v[24:27], v[176:179], v[48:63]
    ds_read_b64_tr_b16 v[36:37], v10 offset:23040
    ds_read_b64_tr_b16 v[38:39], v10 offset:23424
    ds_read_b64_tr_b16 v[40:41], v10 offset:23072
    ds_read_b64_tr_b16 v[42:43], v10 offset:23456
    ds_read_b64_tr_b16 v[44:45], v10 offset:23104
    ds_read_b64_tr_b16 v[46:47], v10 offset:23488
    v_mfma_f32_32x32x16_bf16 v[64:79], v[24:27], v[180:183], v[64:79]
    buffer_load_dwordx4 v[168:171], v5, s[8:11], s25 offen offset:2048 sc1
    v_mfma_f32_32x32x16_bf16 v[80:95], v[28:31], v[176:179], v[80:95]
    s_waitcnt vmcnt(19)
    v_swap_b32 v186, v188
    v_swap_b32 v187, v189
    v_mfma_f32_32x32x16_bf16 v[96:111], v[28:31], v[180:183], v[96:111]
    buffer_load_dwordx4 v[172:175], v5, s[8:11], s25 offen offset:2560 sc1
    s_add_u32 s25, s25, 4096
    v_mfma_f32_32x32x16_bf16 v[112:127], v[32:35], v[176:179], v[112:127]
    v_mfma_f32_32x32x16_bf16 v[128:143], v[32:35], v[180:183], v[128:143]
    buffer_load_dwordx4 v[176:179], v5, s[8:11], s25 offen offset:0 sc1
    s_waitcnt lgkmcnt(0)
    v_mfma_f32_32x32x16_bf16 v[48:63], v[36:39], v[184:187], v[48:63]
    ds_read_b64_tr_b16 v[24:25], v10 offset:24576
    ds_read_b64_tr_b16 v[26:27], v10 offset:24960
    ds_read_b64_tr_b16 v[28:29], v10 offset:24608
    ds_read_b64_tr_b16 v[30:31], v10 offset:24992
    ds_read_b64_tr_b16 v[32:33], v10 offset:24640
    ds_read_b64_tr_b16 v[34:35], v10 offset:25024
    v_mfma_f32_32x32x16_bf16 v[64:79], v[36:39], v[188:191], v[64:79]
    buffer_load_dwordx4 v[180:183], v5, s[8:11], s25 offen offset:512 sc1
    v_mfma_f32_32x32x16_bf16 v[80:95], v[40:43], v[184:187], v[80:95]
    s_waitcnt vmcnt(20)
    v_swap_b32 v194, v196
    v_swap_b32 v195, v197
    v_mfma_f32_32x32x16_bf16 v[96:111], v[40:43], v[188:191], v[96:111]
    v_mfma_f32_32x32x16_bf16 v[112:127], v[44:47], v[184:187], v[112:127]
    v_mfma_f32_32x32x16_bf16 v[128:143], v[44:47], v[188:191], v[128:143]
    buffer_load_dwordx4 v[184:187], v5, s[8:11], s25 offen offset:2048 sc1
    s_waitcnt lgkmcnt(0)
    v_mfma_f32_32x32x16_bf16 v[48:63], v[24:27], v[192:195], v[48:63]
    ds_read_b64_tr_b16 v[36:37], v10 offset:26112
    ds_read_b64_tr_b16 v[38:39], v10 offset:26496
    ds_read_b64_tr_b16 v[40:41], v10 offset:26144
    ds_read_b64_tr_b16 v[42:43], v10 offset:26528
    ds_read_b64_tr_b16 v[44:45], v10 offset:26176
    ds_read_b64_tr_b16 v[46:47], v10 offset:26560
    v_mfma_f32_32x32x16_bf16 v[64:79], v[24:27], v[196:199], v[64:79]
    buffer_load_dwordx4 v[188:191], v5, s[8:11], s25 offen offset:2560 sc1
    s_add_u32 s25, s25, 4096
    v_mfma_f32_32x32x16_bf16 v[80:95], v[28:31], v[192:195], v[80:95]
    s_waitcnt vmcnt(20)
    v_swap_b32 v202, v204
    v_swap_b32 v203, v205
    v_mfma_f32_32x32x16_bf16 v[96:111], v[28:31], v[196:199], v[96:111]
    v_mfma_f32_32x32x16_bf16 v[112:127], v[32:35], v[192:195], v[112:127]
    v_mfma_f32_32x32x16_bf16 v[128:143], v[32:35], v[196:199], v[128:143]
    buffer_load_dwordx4 v[192:195], v5, s[8:11], s25 offen offset:0 sc1
    s_waitcnt lgkmcnt(0)
    v_mfma_f32_32x32x16_bf16 v[48:63], v[36:39], v[200:203], v[48:63]
    ds_read_b64_tr_b16 v[24:25], v10 offset:27648
    ds_read_b64_tr_b16 v[26:27], v10 offset:28032
    ds_read_b64_tr_b16 v[28:29], v10 offset:27680
    ds_read_b64_tr_b16 v[30:31], v10 offset:28064
    ds_read_b64_tr_b16 v[32:33], v10 offset:27712
    ds_read_b64_tr_b16 v[34:35], v10 offset:28096
    v_mfma_f32_32x32x16_bf16 v[64:79], v[36:39], v[204:207], v[64:79]
    buffer_load_dwordx4 v[196:199], v5, s[8:11], s25 offen offset:512 sc1
    v_mfma_f32_32x32x16_bf16 v[80:95], v[40:43], v[200:203], v[80:95]
    s_waitcnt vmcnt(20)
    v_swap_b32 v210, v212
    v_swap_b32 v211, v213
    v_mfma_f32_32x32x16_bf16 v[96:111], v[40:43], v[204:207], v[96:111]
    v_mfma_f32_32x32x16_bf16 v[112:127], v[44:47], v[200:203], v[112:127]
    v_mfma_f32_32x32x16_bf16 v[128:143], v[44:47], v[204:207], v[128:143]
    buffer_load_dwordx4 v[200:203], v5, s[8:11], s25 offen offset:2048 sc1
    s_waitcnt lgkmcnt(0)
    v_mfma_f32_32x32x16_bf16 v[48:63], v[24:27], v[208:211], v[48:63]
    ds_read_b64_tr_b16 v[36:37], v10 offset:29184
    ds_read_b64_tr_b16 v[38:39], v10 offset:29568
    ds_read_b64_tr_b16 v[40:41], v10 offset:29216
    ds_read_b64_tr_b16 v[42:43], v10 offset:29600
    ds_read_b64_tr_b16 v[44:45], v10 offset:29248
    ds_read_b64_tr_b16 v[46:47], v10 offset:29632
    v_mfma_f32_32x32x16_bf16 v[64:79], v[24:27], v[212:215], v[64:79]
    buffer_load_dwordx4 v[204:207], v5, s[8:11], s25 offen offset:2560 sc1
    s_add_u32 s25, s25, 4096
    v_mfma_f32_32x32x16_bf16 v[80:95], v[28:31], v[208:211], v[80:95]
    s_waitcnt vmcnt(20)
    v_swap_b32 v218, v220
    v_swap_b32 v219, v221
    v_mfma_f32_32x32x16_bf16 v[96:111], v[28:31], v[212:215], v[96:111]
    v_mfma_f32_32x32x16_bf16 v[112:127], v[32:35], v[208:211], v[112:127]
    v_mfma_f32_32x32x16_bf16 v[128:143], v[32:35], v[212:215], v[128:143]
    buffer_load_dwordx4 v[208:211], v5, s[8:11], s25 offen offset:0 sc1
    s_waitcnt lgkmcnt(0)
    v_mfma_f32_32x32x16_bf16 v[48:63], v[36:39], v[216:219], v[48:63]
    ds_read_b64_tr_b16 v[24:25], v10 offset:30720
    ds_read_b64_tr_b16 v[26:27], v10 offset:31104
    ds_read_b64_tr_b16 v[28:29], v10 offset:30752
    ds_read_b64_tr_b16 v[30:31], v10 offset:31136
    ds_read_b64_tr_b16 v[32:33], v10 offset:30784
    ds_read_b64_tr_b16 v[34:35], v10 offset:31168
    v_mfma_f32_32x32x16_bf16 v[64:79], v[36:39], v[220:223], v[64:79]
    buffer_load_dwordx4 v[212:215], v5, s[8:11], s25 offen offset:512 sc1
    v_mfma_f32_32x32x16_bf16 v[80:95], v[40:43], v[216:219], v[80:95]
    s_waitcnt vmcnt(20)
    v_swap_b32 v226, v228
    v_swap_b32 v227, v229
    v_mfma_f32_32x32x16_bf16 v[96:111], v[40:43], v[220:223], v[96:111]
    v_mfma_f32_32x32x16_bf16 v[112:127], v[44:47], v[216:219], v[112:127]
    v_mfma_f32_32x32x16_bf16 v[128:143], v[44:47], v[220:223], v[128:143]
    buffer_load_dwordx4 v[216:219], v5, s[8:11], s25 offen offset:2048 sc1
    s_waitcnt lgkmcnt(0)
    v_mfma_f32_32x32x16_bf16 v[48:63], v[24:27], v[224:227], v[48:63]
    ds_read_b64_tr_b16 v[36:37], v10 offset:32256
    ds_read_b64_tr_b16 v[38:39], v10 offset:32640
    ds_read_b64_tr_b16 v[40:41], v10 offset:32288
    ds_read_b64_tr_b16 v[42:43], v10 offset:32672
    ds_read_b64_tr_b16 v[44:45], v10 offset:32320
    ds_read_b64_tr_b16 v[46:47], v10 offset:32704
    v_mfma_f32_32x32x16_bf16 v[64:79], v[24:27], v[228:231], v[64:79]
    buffer_load_dwordx4 v[220:223], v5, s[8:11], s25 offen offset:2560 sc1
    s_add_u32 s25, s25, 4096
    v_mfma_f32_32x32x16_bf16 v[80:95], v[28:31], v[224:227], v[80:95]
    s_waitcnt vmcnt(20)
    v_swap_b32 v234, v236
    v_swap_b32 v235, v237
    v_mfma_f32_32x32x16_bf16 v[96:111], v[28:31], v[228:231], v[96:111]
    v_mfma_f32_32x32x16_bf16 v[112:127], v[32:35], v[224:227], v[112:127]
    v_mfma_f32_32x32x16_bf16 v[128:143], v[32:35], v[228:231], v[128:143]
    buffer_load_dwordx4 v[224:227], v5, s[8:11], s25 offen offset:0 sc1
    s_waitcnt lgkmcnt(0)
    v_mfma_f32_32x32x16_bf16 v[48:63], v[36:39], v[232:235], v[48:63]
    ds_read_b64_tr_b16 v[24:25], v10 offset:33792
    ds_read_b64_tr_b16 v[26:27], v10 offset:34176
    ds_read_b64_tr_b16 v[28:29], v10 offset:33824
    ds_read_b64_tr_b16 v[30:31], v10 offset:34208
    ds_read_b64_tr_b16 v[32:33], v10 offset:33856
    ds_read_b64_tr_b16 v[34:35], v10 offset:34240
    v_mfma_f32_32x32x16_bf16 v[64:79], v[36:39], v[236:239], v[64:79]
    buffer_load_dwordx4 v[228:231], v5, s[8:11], s25 offen offset:512 sc1
    v_mfma_f32_32x32x16_bf16 v[80:95], v[40:43], v[232:235], v[80:95]
    s_waitcnt vmcnt(20)
    v_swap_b32 v242, v244
    v_swap_b32 v243, v245
    v_mfma_f32_32x32x16_bf16 v[96:111], v[40:43], v[236:239], v[96:111]
    buffer_load_dwordx4 v[144:147], v6, s[8:11], s26 offen offset:0 sc1
    v_mfma_f32_32x32x16_bf16 v[112:127], v[44:47], v[232:235], v[112:127]
    v_mfma_f32_32x32x16_bf16 v[128:143], v[44:47], v[236:239], v[128:143]
    buffer_load_dwordx4 v[232:235], v5, s[8:11], s25 offen offset:2048 sc1
    s_waitcnt lgkmcnt(0)
    v_mfma_f32_32x32x16_bf16 v[48:63], v[24:27], v[240:243], v[48:63]
    ds_read_b64_tr_b16 v[36:37], v10 offset:35328
    ds_read_b64_tr_b16 v[38:39], v10 offset:35712
    ds_read_b64_tr_b16 v[40:41], v10 offset:35360
    ds_read_b64_tr_b16 v[42:43], v10 offset:35744
    ds_read_b64_tr_b16 v[44:45], v10 offset:35392
    ds_read_b64_tr_b16 v[46:47], v10 offset:35776
    v_mfma_f32_32x32x16_bf16 v[64:79], v[24:27], v[244:247], v[64:79]
    buffer_load_dwordx4 v[236:239], v5, s[8:11], s25 offen offset:2560 sc1
    s_add_u32 s25, s25, 4096
    v_mfma_f32_32x32x16_bf16 v[80:95], v[28:31], v[240:243], v[80:95]
    s_waitcnt vmcnt(21)
    v_swap_b32 v250, v252
    v_swap_b32 v251, v253
    v_mfma_f32_32x32x16_bf16 v[96:111], v[28:31], v[244:247], v[96:111]
    buffer_load_dwordx4 v[148:151], v6, s[8:11], s26 offen offset:512 sc1
    v_mfma_f32_32x32x16_bf16 v[112:127], v[32:35], v[240:243], v[112:127]
    v_mfma_f32_32x32x16_bf16 v[128:143], v[32:35], v[244:247], v[128:143]
    buffer_load_dwordx4 v[240:243], v5, s[8:11], s25 offen offset:0 sc1
    s_waitcnt lgkmcnt(0)
    v_mfma_f32_32x32x16_bf16 v[48:63], v[36:39], v[248:251], v[48:63]
    ds_read_b64_tr_b16 v[24:25], v10 offset:36864
    ds_read_b64_tr_b16 v[26:27], v10 offset:37248
    ds_read_b64_tr_b16 v[28:29], v10 offset:36896
    ds_read_b64_tr_b16 v[30:31], v10 offset:37280
    ds_read_b64_tr_b16 v[32:33], v10 offset:36928
    ds_read_b64_tr_b16 v[34:35], v10 offset:37312
    v_mfma_f32_32x32x16_bf16 v[64:79], v[36:39], v[252:255], v[64:79]
    buffer_load_dwordx4 v[244:247], v5, s[8:11], s25 offen offset:512 sc1
    v_mfma_f32_32x32x16_bf16 v[80:95], v[40:43], v[248:251], v[80:95]
    s_waitcnt vmcnt(22)
    v_swap_b32 v162, v164
    v_swap_b32 v163, v165
    v_mfma_f32_32x32x16_bf16 v[96:111], v[40:43], v[252:255], v[96:111]
    buffer_load_dwordx4 v[152:155], v6, s[8:11], s26 offen offset:1024 sc1
    v_mfma_f32_32x32x16_bf16 v[112:127], v[44:47], v[248:251], v[112:127]
    v_mfma_f32_32x32x16_bf16 v[128:143], v[44:47], v[252:255], v[128:143]
    buffer_load_dwordx4 v[156:159], v6, s[8:11], s26 offen offset:1536 sc1
    s_waitcnt lgkmcnt(0)
    v_mfma_f32_32x32x16_bf16 v[48:63], v[24:27], v[160:163], v[48:63]
    ds_read_b64_tr_b16 v[36:37], v10 offset:38400
    ds_read_b64_tr_b16 v[38:39], v10 offset:38784
    ds_read_b64_tr_b16 v[40:41], v10 offset:38432
    ds_read_b64_tr_b16 v[42:43], v10 offset:38816
    ds_read_b64_tr_b16 v[44:45], v10 offset:38464
    ds_read_b64_tr_b16 v[46:47], v10 offset:38848
    v_mfma_f32_32x32x16_bf16 v[64:79], v[24:27], v[164:167], v[64:79]
    buffer_load_dwordx4 v[248:251], v5, s[8:11], s25 offen offset:2048 sc1
    v_mfma_f32_32x32x16_bf16 v[80:95], v[28:31], v[160:163], v[80:95]
    s_waitcnt vmcnt(23)
    v_swap_b32 v170, v172
    v_swap_b32 v171, v173
    v_mfma_f32_32x32x16_bf16 v[96:111], v[28:31], v[164:167], v[96:111]
    buffer_load_dwordx4 v[252:255], v5, s[8:11], s25 offen offset:2560 sc1
    s_add_u32 s25, s25, 4096
    v_mfma_f32_32x32x16_bf16 v[112:127], v[32:35], v[160:163], v[112:127]
    v_mfma_f32_32x32x16_bf16 v[128:143], v[32:35], v[164:167], v[128:143]
    buffer_load_dwordx4 v[160:163], v5, s[8:11], s25 offen offset:0 sc1
    s_waitcnt lgkmcnt(0)
    v_mfma_f32_32x32x16_bf16 v[48:63], v[36:39], v[168:171], v[48:63]
    ds_read_b64_tr_b16 v[24:25], v10 offset:39936
    ds_read_b64_tr_b16 v[26:27], v10 offset:40320
    ds_read_b64_tr_b16 v[28:29], v10 offset:39968
    ds_read_b64_tr_b16 v[30:31], v10 offset:40352
    ds_read_b64_tr_b16 v[32:33], v10 offset:40000
    ds_read_b64_tr_b16 v[34:35], v10 offset:40384
    v_mfma_f32_32x32x16_bf16 v[64:79], v[36:39], v[172:175], v[64:79]
    buffer_load_dwordx4 v[164:167], v5, s[8:11], s25 offen offset:512 sc1
    v_mfma_f32_32x32x16_bf16 v[80:95], v[40:43], v[168:171], v[80:95]
    s_waitcnt vmcnt(24)
    v_swap_b32 v178, v180
    v_swap_b32 v179, v181
    v_mfma_f32_32x32x16_bf16 v[96:111], v[40:43], v[172:175], v[96:111]
    v_mfma_f32_32x32x16_bf16 v[112:127], v[44:47], v[168:171], v[112:127]
    v_mfma_f32_32x32x16_bf16 v[128:143], v[44:47], v[172:175], v[128:143]
    buffer_load_dwordx4 v[168:171], v5, s[8:11], s25 offen offset:2048 sc1
    s_waitcnt lgkmcnt(0)
    v_mfma_f32_32x32x16_bf16 v[48:63], v[24:27], v[176:179], v[48:63]
    ds_read_b64_tr_b16 v[36:37], v10 offset:41472
    ds_read_b64_tr_b16 v[38:39], v10 offset:41856
    ds_read_b64_tr_b16 v[40:41], v10 offset:41504
    ds_read_b64_tr_b16 v[42:43], v10 offset:41888
    ds_read_b64_tr_b16 v[44:45], v10 offset:41536
    ds_read_b64_tr_b16 v[46:47], v10 offset:41920
    v_mfma_f32_32x32x16_bf16 v[64:79], v[24:27], v[180:183], v[64:79]
    buffer_load_dwordx4 v[172:175], v5, s[8:11], s25 offen offset:2560 sc1
    s_add_u32 s25, s25, 4096
    v_mfma_f32_32x32x16_bf16 v[80:95], v[28:31], v[176:179], v[80:95]
    s_waitcnt vmcnt(24)
    v_swap_b32 v186, v188
    v_swap_b32 v187, v189
    v_mfma_f32_32x32x16_bf16 v[96:111], v[28:31], v[180:183], v[96:111]
    v_mfma_f32_32x32x16_bf16 v[112:127], v[32:35], v[176:179], v[112:127]
    v_mfma_f32_32x32x16_bf16 v[128:143], v[32:35], v[180:183], v[128:143]
    buffer_load_dwordx4 v[176:179], v5, s[8:11], s25 offen offset:0 sc1
    s_waitcnt lgkmcnt(0)
    v_mfma_f32_32x32x16_bf16 v[48:63], v[36:39], v[184:187], v[48:63]
    v_mfma_f32_32x32x16_bf16 v[64:79], v[36:39], v[188:191], v[64:79]
    buffer_load_dwordx4 v[180:183], v5, s[8:11], s25 offen offset:512 sc1
    v_mfma_f32_32x32x16_bf16 v[80:95], v[40:43], v[184:187], v[80:95]
    s_waitcnt vmcnt(24)
    v_swap_b32 v194, v196
    v_swap_b32 v195, v197
    v_mfma_f32_32x32x16_bf16 v[96:111], v[40:43], v[188:191], v[96:111]
    v_mfma_f32_32x32x16_bf16 v[112:127], v[44:47], v[184:187], v[112:127]
    v_mfma_f32_32x32x16_bf16 v[128:143], v[44:47], v[188:191], v[128:143]
    buffer_load_dwordx4 v[184:187], v5, s[8:11], s25 offen offset:2048 sc1
    ds_read_b64_tr_b16 v[24:25], v10 offset:43008
    ds_read_b64_tr_b16 v[26:27], v10 offset:43392
    ds_read_b64_tr_b16 v[28:29], v10 offset:44544
    ds_read_b64_tr_b16 v[30:31], v10 offset:44928
    ds_read_b64_tr_b16 v[32:33], v10 offset:46080
    ds_read_b64_tr_b16 v[34:35], v10 offset:46464
    s_waitcnt lgkmcnt(4)
    v_mfma_f32_32x32x16_bf16 v[48:63], v[24:27], v[192:195], v[48:63]
    ds_read_b64_tr_b16 v[36:37], v10 offset:47616
    ds_read_b64_tr_b16 v[38:39], v10 offset:48000
    s_waitcnt vmcnt(23)
    v_swap_b32 v202, v204
    v_swap_b32 v203, v205
    v_mfma_f32_32x32x16_bf16 v[64:79], v[24:27], v[196:199], v[64:79]
    buffer_load_dwordx4 v[188:191], v5, s[8:11], s25 offen offset:2560 sc1
    s_add_u32 s25, s25, 4096
    s_waitcnt vmcnt(10)
    v_max_u32 v18, v145, v147
    v_max3_u32 v18, v18, v149, v151
    s_waitcnt lgkmcnt(4)
    v_mfma_f32_32x32x16_bf16 v[48:63], v[28:31], v[200:203], v[48:63]
    ds_read_b64_tr_b16 v[24:25], v10 offset:49152
    ds_read_b64_tr_b16 v[26:27], v10 offset:49536
    v_swap_b32 v210, v212
    v_swap_b32 v211, v213
    v_mfma_f32_32x32x16_bf16 v[64:79], v[28:31], v[204:207], v[64:79]
    s_or_b32 s23, s21, s3
    s_cmp_lt_u32 s23, s101
    s_cbranch_scc1 L_wb_1049
    buffer_load_dword a255, v11, s[8:11], s36 offen
L_wbd_1050:
    v_max3_u32 v18, v18, v153, v155
    v_max3_u32 v18, v18, v157, v159
    v_cmp_eq_u32 vcc, -1, v18
    s_cbranch_vccnz L_stspin_1047
L_stback_1048:
    s_waitcnt lgkmcnt(4)
    v_mfma_f32_32x32x16_bf16 v[48:63], v[32:35], v[208:211], v[48:63]
    ds_read_b64_tr_b16 v[28:29], v10 offset:50688
    ds_read_b64_tr_b16 v[30:31], v10 offset:51072
    v_swap_b32 v218, v220
    v_swap_b32 v219, v221
    v_mfma_f32_32x32x16_bf16 v[64:79], v[32:35], v[212:215], v[64:79]
    v_add_f32 v144, v144, v148
    v_add_f32 v152, v152, v156
    v_add_f32 v145, v145, v149
    v_add_f32 v153, v153, v157
    v_add_f32 v146, v146, v150
    s_waitcnt lgkmcnt(4)
    v_mfma_f32_32x32x16_bf16 v[48:63], v[36:39], v[216:219], v[48:63]
    ds_read_b64_tr_b16 v[32:33], v10 offset:52224
    ds_read_b64_tr_b16 v[34:35], v10 offset:52608
    v_swap_b32 v226, v228
    v_swap_b32 v227, v229
    v_mfma_f32_32x32x16_bf16 v[64:79], v[36:39], v[220:223], v[64:79]
    v_add_f32 v154, v154, v158
    v_add_f32 v147, v147, v151
    v_add_f32 v155, v155, v159
    v_add_f32 v144, v144, v152
    v_add_f32 v145, v145, v153
    s_waitcnt lgkmcnt(4)
    v_mfma_f32_32x32x16_bf16 v[48:63], v[24:27], v[224:227], v[48:63]
    ds_read_b64_tr_b16 v[36:37], v10 offset:53760
    ds_read_b64_tr_b16 v[38:39], v10 offset:54144
    v_swap_b32 v234, v236
    v_swap_b32 v235, v237
    v_mfma_f32_32x32x16_bf16 v[64:79], v[24:27], v[228:231], v[64:79]
    v_add_f32 v146, v146, v154
    v_add_f32 v147, v147, v155
    v_mov_b32 v148, v144
    v_mov_b32 v149, v145
    v_mov_b32 v150, v146
    s_waitcnt lgkmcnt(4)
    v_mfma_f32_32x32x16_bf16 v[48:63], v[28:31], v[232:235], v[48:63]
    ds_read_b64_tr_b16 v[24:25], v10 offset:55296
    ds_read_b64_tr_b16 v[26:27], v10 offset:55680
    v_swap_b32 v242, v244
    v_swap_b32 v243, v245
    v_mfma_f32_32x32x16_bf16 v[64:79], v[28:31], v[236:239], v[64:79]
    v_mov_b32 v151, v147
    v_permlane32_swap_b32 v144, v148
    v_permlane32_swap_b32 v145, v149
    s_waitcnt lgkmcnt(4)
    v_mfma_f32_32x32x16_bf16 v[48:63], v[32:35], v[240:243], v[48:63]
    ds_read_b64_tr_b16 v[28:29], v10 offset:56832
    ds_read_b64_tr_b16 v[30:31], v10 offset:57216
    s_waitcnt vmcnt(9)
    v_swap_b32 v250, v252
    v_swap_b32 v251, v253
    v_mfma_f32_32x32x16_bf16 v[64:79], v[32:35], v[244:247], v[64:79]
    v_permlane32_swap_b32 v146, v150
    v_permlane32_swap_b32 v147, v151
    v_add_f32 v144, v144, v148
    s_waitcnt lgkmcnt(4)
    v_mfma_f32_32x32x16_bf16 v[48:63], v[36:39], v[248:251], v[48:63]
    ds_read_b64_tr_b16 v[32:33], v10 offset:58368
    ds_read_b64_tr_b16 v[34:35], v10 offset:58752
    s_waitcnt vmcnt(7)
    v_swap_b32 v162, v164
    v_swap_b32 v163, v165
    v_mfma_f32_32x32x16_bf16 v[64:79], v[36:39], v[252:255], v[64:79]
    v_add_f32 v145, v145, v149
    v_add_f32 v146, v146, v150
    v_add_f32 v147, v147, v151
    v_mul_f32 v148, 0x3acccccd, v144
    v_mul_f32 v150, 0x3acccccd, v146
    s_waitcnt lgkmcnt(4)
    v_mfma_f32_32x32x16_bf16 v[48:63], v[24:27], v[160:163], v[48:63]
    ds_read_b64_tr_b16 v[36:37], v10 offset:59904
    ds_read_b64_tr_b16 v[38:39], v10 offset:60288
    s_waitcnt vmcnt(5)
    v_swap_b32 v170, v172
    v_swap_b32 v171, v173
    v_mfma_f32_32x32x16_bf16 v[64:79], v[24:27], v[164:167], v[64:79]
    v_mul_f32 v149, 0x3acccccd, v145
    v_mul_f32 v151, 0x3acccccd, v147
    v_fma_f32 v149, -v148, v148, v149
    v_fma_f32 v151, -v150, v150, v151
    v_max_f32 v149, 0, v149
    s_waitcnt lgkmcnt(4)
    v_mfma_f32_32x32x16_bf16 v[48:63], v[28:31], v[168:171], v[48:63]
    s_waitcnt vmcnt(3)
    v_swap_b32 v178, v180
    v_swap_b32 v179, v181
    v_mfma_f32_32x32x16_bf16 v[64:79], v[28:31], v[172:175], v[64:79]
    v_max_f32 v151, 0, v151
    v_cvt_pk_bf16_f32 v40, -v148, -v148
    v_cvt_pk_bf16_f32 v44, -v150, -v150
    v_cvt_pk_bf16_f32 v149, v149, v149
    v_cvt_pk_bf16_f32 v151, v151, v151
    s_waitcnt lgkmcnt(2)
    v_mfma_f32_32x32x16_bf16 v[48:63], v[32:35], v[176:179], v[48:63]
    ds_read_b64_tr_b16 v[28:29], v10 offset:43040
    ds_read_b64_tr_b16 v[30:31], v10 offset:43424
    s_waitcnt vmcnt(1)
    v_swap_b32 v186, v188
    v_swap_b32 v187, v189
    v_mfma_f32_32x32x16_bf16 v[64:79], v[32:35], v[180:183], v[64:79]
    v_lshlrev_b32 v149, 16, v149
    v_lshlrev_b32 v151, 16, v151
    v_and_b32 v41, 0xffff, v40
    v_and_b32 v45, 0xffff, v44
    v_add_f32 v149, 0x3727c5ac, v149
    s_waitcnt lgkmcnt(2)
    v_mfma_f32_32x32x16_bf16 v[48:63], v[36:39], v[184:187], v[48:63]
    ds_read_b64_tr_b16 v[32:33], v10 offset:44576
    ds_read_b64_tr_b16 v[34:35], v10 offset:44960
    v_add_f32 v151, 0x3727c5ac, v151
    v_cvt_pk_bf16_f32 v149, v149, v149
    v_cvt_pk_bf16_f32 v151, v151, v151
    v_lshlrev_b32 v149, 16, v149
    v_lshlrev_b32 v151, 16, v151
    v_mfma_f32_32x32x16_bf16 v[64:79], v[36:39], v[188:191], v[64:79]
    v_sqrt_f32 v149, v149
    v_sqrt_f32 v151, v151
    v_mov_b32 v42, v40
    v_mov_b32 v46, v44
    v_cvt_pk_bf16_f32 v149, v149, v149
    v_cvt_pk_bf16_f32 v151, v151, v151
    v_lshlrev_b32 v149, 16, v149
    v_lshlrev_b32 v151, 16, v151
    v_mul_f32 v16, v149, v149
    v_mul_f32 v17, v151, v151
    v_rcp_f32 v149, v149
    v_rcp_f32 v151, v151
    v_mov_b32 v43, v41
    v_mov_b32 v47, v45
    v_mul_f32 v12, 0xc0135761, v149
    v_mul_f32 v13, 0xc0135761, v151
    v_mul_f32 v14, v149, v149
    v_mul_f32 v15, v151, v151
    v_mul_f32 v149, 0xbdd2d3e8, v149
    v_mul_f32 v151, 0xbdd2d3e8, v151
    v_mul_f32 v14, v14, v149
    v_mul_f32 v15, v15, v151
    s_lshl_b32 s29, s24, 2
    s_lshr_b32 s34, s21, 3
    s_add_u32 s29, s29, s34
    s_lshl_b32 s29, s29, 7
    s_add_u32 s29, s29, 16646144
    s_lshl_b32 s34, s45, 2
    v_mov_b32 v8, s34
    v_mov_b32 v9, s96
    s_lshl_b32 s36, s44, 2
    s_add_u32 s36, s36, s3
    s_lshl_b32 s36, s36, 7
    s_add_u32 s36, s36, 16646144
    v_mfma_f32_32x32x16_bf16 v[48:63], a[240:243], v[40:43], v[48:63]
    ds_read_b64_tr_b16 v[36:37], v10 offset:46112
    ds_read_b64_tr_b16 v[38:39], v10 offset:46496
    v_mfma_f32_32x32x16_bf16 v[64:79], a[240:243], v[44:47], v[64:79]
    s_waitcnt lgkmcnt(4)
    v_mfma_f32_32x32x16_bf16 v[80:95], v[28:31], v[192:195], v[80:95]
    ds_read_b64_tr_b16 v[24:25], v10 offset:47648
    ds_read_b64_tr_b16 v[26:27], v10 offset:48032
    s_nop 3
    s_nop 0
    v_mul_f32 v144, v48, v48
    v_mul_f32 v145, v49, v49
    v_mul_f32 v146, v50, v50
    v_mul_f32 v147, v51, v51
    v_mfma_f32_32x32x16_bf16 v[96:111], v[28:31], v[196:199], v[96:111]
    v_mul_f32 v148, v52, v52
    v_mul_f32 v149, v53, v53
    v_mul_f32 v150, v54, v54
    v_mul_f32 v151, v55, v55
    v_fma_f32 v144, v144, v14, v12
    s_waitcnt lgkmcnt(4)
    v_mfma_f32_32x32x16_bf16 v[80:95], v[32:35], v[200:203], v[80:95]
    ds_read_b64_tr_b16 v[28:29], v10 offset:49184
    ds_read_b64_tr_b16 v[30:31], v10 offset:49568
    v_fma_f32 v145, v145, v14, v12
    v_fma_f32 v146, v146, v14, v12
    v_fma_f32 v147, v147, v14, v12
    v_fma_f32 v148, v148, v14, v12
    v_fma_f32 v149, v149, v14, v12
    v_mfma_f32_32x32x16_bf16 v[96:111], v[32:35], v[204:207], v[96:111]
    v_fma_f32 v150, v150, v14, v12
    v_fma_f32 v151, v151, v14, v12
    v_mul_f32 v144, v144, v48
    v_mul_f32 v145, v145, v49
    v_mul_f32 v146, v146, v50
    s_waitcnt lgkmcnt(4)
    v_mfma_f32_32x32x16_bf16 v[80:95], v[36:39], v[208:211], v[80:95]
    ds_read_b64_tr_b16 v[32:33], v10 offset:50720
    ds_read_b64_tr_b16 v[34:35], v10 offset:51104
    v_mul_f32 v147, v147, v51
    v_mul_f32 v148, v148, v52
    v_mul_f32 v149, v149, v53
    v_mul_f32 v150, v150, v54
    v_mul_f32 v151, v151, v55
    v_mfma_f32_32x32x16_bf16 v[96:111], v[36:39], v[212:215], v[96:111]
    v_exp_f32 v144, v144
    v_mul_f32 v48, v48, v56
    v_exp_f32 v145, v145
    s_waitcnt lgkmcnt(4)
    v_mfma_f32_32x32x16_bf16 v[80:95], v[24:27], v[216:219], v[80:95]
    ds_read_b64_tr_b16 v[36:37], v10 offset:52256
    ds_read_b64_tr_b16 v[38:39], v10 offset:52640
    v_mul_f32 v49, v49, v57
    v_exp_f32 v146, v146
    v_mul_f32 v50, v50, v58
    v_mfma_f32_32x32x16_bf16 v[96:111], v[24:27], v[220:223], v[96:111]
    v_exp_f32 v147, v147
    v_mul_f32 v51, v51, v59
    v_exp_f32 v148, v148
    s_waitcnt lgkmcnt(4)
    v_mfma_f32_32x32x16_bf16 v[80:95], v[28:31], v[224:227], v[80:95]
    ds_read_b64_tr_b16 v[24:25], v10 offset:53792
    ds_read_b64_tr_b16 v[26:27], v10 offset:54176
    v_mul_f32 v52, v52, v60
    v_exp_f32 v149, v149
    v_mul_f32 v53, v53, v61
    v_mfma_f32_32x32x16_bf16 v[96:111], v[28:31], v[228:231], v[96:111]
    v_exp_f32 v150, v150
    v_mul_f32 v54, v54, v62
    v_exp_f32 v151, v151
    s_waitcnt lgkmcnt(4)
    v_mfma_f32_32x32x16_bf16 v[80:95], v[32:35], v[232:235], v[80:95]
    ds_read_b64_tr_b16 v[28:29], v10 offset:55328
    ds_read_b64_tr_b16 v[30:31], v10 offset:55712
    v_mul_f32 v55, v55, v63
    v_fma_f32 v144, v144, v16, v16
    v_fma_f32 v145, v145, v16, v16
    v_fma_f32 v146, v146, v16, v16
    v_fma_f32 v147, v147, v16, v16
    v_mfma_f32_32x32x16_bf16 v[96:111], v[32:35], v[236:239], v[96:111]
    v_fma_f32 v148, v148, v16, v16
    v_fma_f32 v149, v149, v16, v16
    v_fma_f32 v150, v150, v16, v16
    v_fma_f32 v151, v151, v16, v16
    s_waitcnt lgkmcnt(4)
    v_mfma_f32_32x32x16_bf16 v[80:95], v[36:39], v[240:243], v[80:95]
    ds_read_b64_tr_b16 v[32:33], v10 offset:56864
    ds_read_b64_tr_b16 v[34:35], v10 offset:57248
    v_rcp_f32 v144, v144
    v_rcp_f32 v145, v145
    v_mfma_f32_32x32x16_bf16 v[96:111], v[36:39], v[244:247], v[96:111]
    v_rcp_f32 v146, v146
    v_rcp_f32 v147, v147
    s_waitcnt lgkmcnt(4)
    v_mfma_f32_32x32x16_bf16 v[80:95], v[24:27], v[248:251], v[80:95]
    ds_read_b64_tr_b16 v[36:37], v10 offset:58400
    ds_read_b64_tr_b16 v[38:39], v10 offset:58784
    v_rcp_f32 v148, v148
    v_rcp_f32 v149, v149
    v_mfma_f32_32x32x16_bf16 v[96:111], v[24:27], v[252:255], v[96:111]
    v_rcp_f32 v150, v150
    v_rcp_f32 v151, v151
    v_mul_f32 v48, v48, v144
    s_waitcnt lgkmcnt(4)
    v_mfma_f32_32x32x16_bf16 v[80:95], v[28:31], v[160:163], v[80:95]
    ds_read_b64_tr_b16 v[24:25], v10 offset:59936
    ds_read_b64_tr_b16 v[26:27], v10 offset:60320
    v_mul_f32 v49, v49, v145
    v_mul_f32 v50, v50, v146
    v_mul_f32 v51, v51, v147
    v_mul_f32 v52, v52, v148
    v_mul_f32 v53, v53, v149
    v_mfma_f32_32x32x16_bf16 v[96:111], v[28:31], v[164:167], v[96:111]
    v_mul_f32 v54, v54, v150
    v_mul_f32 v55, v55, v151
    v_cvt_pk_bf16_f32 v56, v48, v49
    v_cvt_pk_bf16_f32 v57, v50, v51
    v_cvt_pk_bf16_f32 v58, v52, v53
    s_waitcnt lgkmcnt(4)
    v_mfma_f32_32x32x16_bf16 v[80:95], v[32:35], v[168:171], v[80:95]
    v_cvt_pk_bf16_f32 v59, v54, v55
    s_cmp_eq_u32 s37, 0
    s_cbranch_scc1 L_wt_1051
    buffer_store_dwordx4 v[56:59], v2, s[8:11], s27 offen offset:0
L_wb_1052:
    v_mul_f32 v152, v64, v64
    v_mul_f32 v153, v65, v65
    v_mul_f32 v154, v66, v66
    v_mfma_f32_32x32x16_bf16 v[96:111], v[32:35], v[172:175], v[96:111]
    v_mul_f32 v155, v67, v67
    v_mul_f32 v156, v68, v68
    v_mul_f32 v157, v69, v69
    v_mul_f32 v158, v70, v70
    v_mul_f32 v159, v71, v71
    s_waitcnt lgkmcnt(2)
    v_mfma_f32_32x32x16_bf16 v[80:95], v[36:39], v[176:179], v[80:95]
    ds_read_b64_tr_b16 v[32:33], v10 offset:43072
    ds_read_b64_tr_b16 v[34:35], v10 offset:43456
    v_fma_f32 v152, v152, v15, v13
    v_fma_f32 v153, v153, v15, v13
    v_fma_f32 v154, v154, v15, v13
    v_fma_f32 v155, v155, v15, v13
    v_fma_f32 v156, v156, v15, v13
    v_mfma_f32_32x32x16_bf16 v[96:111], v[36:39], v[180:183], v[96:111]
    v_fma_f32 v157, v157, v15, v13
    v_fma_f32 v158, v158, v15, v13
    v_fma_f32 v159, v159, v15, v13
    v_mul_f32 v152, v152, v64
    v_mul_f32 v153, v153, v65
    s_waitcnt lgkmcnt(2)
    v_mfma_f32_32x32x16_bf16 v[80:95], v[24:27], v[184:187], v[80:95]
    ds_read_b64_tr_b16 v[36:37], v10 offset:44608
    ds_read_b64_tr_b16 v[38:39], v10 offset:44992
    v_mul_f32 v154, v154, v66
    v_mul_f32 v155, v155, v67
    v_mul_f32 v156, v156, v68
    v_mul_f32 v157, v157, v69
    v_mul_f32 v158, v158, v70
    v_mfma_f32_32x32x16_bf16 v[96:111], v[24:27], v[188:191], v[96:111]
    v_mul_f32 v159, v159, v71
    v_exp_f32 v152, v152
    v_mul_f32 v64, v64, v72
    v_mfma_f32_32x32x16_bf16 v[80:95], a[244:247], v[40:43], v[80:95]
    ds_read_b64_tr_b16 v[24:25], v10 offset:46144
    ds_read_b64_tr_b16 v[26:27], v10 offset:46528
    v_exp_f32 v153, v153
    v_mul_f32 v65, v65, v73
    v_exp_f32 v154, v154
    v_mfma_f32_32x32x16_bf16 v[96:111], a[244:247], v[44:47], v[96:111]
    v_mul_f32 v66, v66, v74
    v_exp_f32 v155, v155
    v_mul_f32 v67, v67, v75
    v_exp_f32 v156, v156
    v_mul_f32 v68, v68, v76
    v_exp_f32 v157, v157
    v_mul_f32 v69, v69, v77
    v_exp_f32 v158, v158
    v_mul_f32 v70, v70, v78
    v_exp_f32 v159, v159
    v_mul_f32 v71, v71, v79
    v_fma_f32 v152, v152, v17, v17
    v_fma_f32 v153, v153, v17, v17
    v_fma_f32 v154, v154, v17, v17
    v_fma_f32 v155, v155, v17, v17
    v_fma_f32 v156, v156, v17, v17
    v_fma_f32 v157, v157, v17, v17
    v_fma_f32 v158, v158, v17, v17
    v_fma_f32 v159, v159, v17, v17
    v_rcp_f32 v152, v152
    v_rcp_f32 v153, v153
    v_rcp_f32 v154, v154
    v_rcp_f32 v155, v155
    v_rcp_f32 v156, v156
    v_rcp_f32 v157, v157
    v_rcp_f32 v158, v158
    v_rcp_f32 v159, v159
    v_mul_f32 v64, v64, v152
    v_mul_f32 v65, v65, v153
    v_mul_f32 v66, v66, v154
    v_mul_f32 v67, v67, v155
    v_mul_f32 v68, v68, v156
    v_mul_f32 v69, v69, v157
    v_mul_f32 v70, v70, v158
    v_mul_f32 v71, v71, v159
    v_cvt_pk_bf16_f32 v72, v64, v65
    v_cvt_pk_bf16_f32 v73, v66, v67
    v_cvt_pk_bf16_f32 v74, v68, v69
    v_cvt_pk_bf16_f32 v75, v70, v71
    s_cmp_eq_u32 s37, 0
    s_cbranch_scc1 L_wt_1053
    buffer_store_dwordx4 v[72:75], v2, s[8:11], s28 offen offset:0
L_wb_1054:
    s_waitcnt lgkmcnt(4)
    v_mfma_f32_32x32x16_bf16 v[112:127], v[32:35], v[192:195], v[112:127]
    ds_read_b64_tr_b16 v[28:29], v10 offset:47680
    ds_read_b64_tr_b16 v[30:31], v10 offset:48064
    s_nop 3
    v_mul_f32 v144, v80, v80
    v_mul_f32 v145, v81, v81
    v_mul_f32 v146, v82, v82
    v_mul_f32 v147, v83, v83
    v_mfma_f32_32x32x16_bf16 v[128:143], v[32:35], v[196:199], v[128:143]
    v_mul_f32 v148, v84, v84
    v_mul_f32 v149, v85, v85
    v_mul_f32 v150, v86, v86
    v_mul_f32 v151, v87, v87
    v_fma_f32 v144, v144, v14, v12
    s_waitcnt lgkmcnt(4)
    v_mfma_f32_32x32x16_bf16 v[112:127], v[36:39], v[200:203], v[112:127]
    ds_read_b64_tr_b16 v[32:33], v10 offset:49216
    ds_read_b64_tr_b16 v[34:35], v10 offset:49600
    v_fma_f32 v145, v145, v14, v12
    v_fma_f32 v146, v146, v14, v12
    v_fma_f32 v147, v147, v14, v12
    v_fma_f32 v148, v148, v14, v12
    v_fma_f32 v149, v149, v14, v12
    v_mfma_f32_32x32x16_bf16 v[128:143], v[36:39], v[204:207], v[128:143]
    v_fma_f32 v150, v150, v14, v12
    v_fma_f32 v151, v151, v14, v12
    v_mul_f32 v144, v144, v80
    v_mul_f32 v145, v145, v81
    v_mul_f32 v146, v146, v82
    s_waitcnt lgkmcnt(4)
    v_mfma_f32_32x32x16_bf16 v[112:127], v[24:27], v[208:211], v[112:127]
    ds_read_b64_tr_b16 v[36:37], v10 offset:50752
    ds_read_b64_tr_b16 v[38:39], v10 offset:51136
    v_mul_f32 v147, v147, v83
    v_mul_f32 v148, v148, v84
    v_mul_f32 v149, v149, v85
    v_mul_f32 v150, v150, v86
    v_mul_f32 v151, v151, v87
    v_mfma_f32_32x32x16_bf16 v[128:143], v[24:27], v[212:215], v[128:143]
    v_exp_f32 v144, v144
    v_mul_f32 v80, v80, v88
    v_exp_f32 v145, v145
    s_waitcnt lgkmcnt(4)
    v_mfma_f32_32x32x16_bf16 v[112:127], v[28:31], v[216:219], v[112:127]
    ds_read_b64_tr_b16 v[24:25], v10 offset:52288
    ds_read_b64_tr_b16 v[26:27], v10 offset:52672
    v_mul_f32 v81, v81, v89
    v_exp_f32 v146, v146
    v_mul_f32 v82, v82, v90
    v_mfma_f32_32x32x16_bf16 v[128:143], v[28:31], v[220:223], v[128:143]
    v_exp_f32 v147, v147
    v_mul_f32 v83, v83, v91
    v_exp_f32 v148, v148
    s_waitcnt lgkmcnt(4)
    v_mfma_f32_32x32x16_bf16 v[112:127], v[32:35], v[224:227], v[112:127]
    ds_read_b64_tr_b16 v[28:29], v10 offset:53824
    ds_read_b64_tr_b16 v[30:31], v10 offset:54208
    s_waitcnt vmcnt(0)
    s_mov_b64 exec, 1
    s_cmp_eq_u32 s38, 0
    s_cbranch_scc1 L_wt_1055
    buffer_store_dword v9, v8, s[8:11], s29 offen offset:0
L_wb_1056:
    s_mov_b64 exec, -1
    v_mul_f32 v84, v84, v92
    v_exp_f32 v149, v149
    v_mul_f32 v85, v85, v93
    v_mfma_f32_32x32x16_bf16 v[128:143], v[32:35], v[228:231], v[128:143]
    v_exp_f32 v150, v150
    v_mul_f32 v86, v86, v94
    v_exp_f32 v151, v151
    s_waitcnt lgkmcnt(4)
    v_mfma_f32_32x32x16_bf16 v[112:127], v[36:39], v[232:235], v[112:127]
    ds_read_b64_tr_b16 v[32:33], v10 offset:55360
    ds_read_b64_tr_b16 v[34:35], v10 offset:55744
    v_mul_f32 v87, v87, v95
    v_fma_f32 v144, v144, v16, v16
    v_fma_f32 v145, v145, v16, v16
    v_fma_f32 v146, v146, v16, v16
    v_fma_f32 v147, v147, v16, v16
    v_mfma_f32_32x32x16_bf16 v[128:143], v[36:39], v[236:239], v[128:143]
    v_fma_f32 v148, v148, v16, v16
    v_fma_f32 v149, v149, v16, v16
    v_fma_f32 v150, v150, v16, v16
    v_fma_f32 v151, v151, v16, v16
    s_waitcnt lgkmcnt(4)
    v_mfma_f32_32x32x16_bf16 v[112:127], v[24:27], v[240:243], v[112:127]
    ds_read_b64_tr_b16 v[36:37], v10 offset:56896
    ds_read_b64_tr_b16 v[38:39], v10 offset:57280
    v_rcp_f32 v144, v144
    v_rcp_f32 v145, v145
    v_mfma_f32_32x32x16_bf16 v[128:143], v[24:27], v[244:247], v[128:143]
    v_rcp_f32 v146, v146
    v_rcp_f32 v147, v147
    s_waitcnt lgkmcnt(4)
    v_mfma_f32_32x32x16_bf16 v[112:127], v[28:31], v[248:251], v[112:127]
    ds_read_b64_tr_b16 v[24:25], v10 offset:58432
    ds_read_b64_tr_b16 v[26:27], v10 offset:58816
    v_rcp_f32 v148, v148
    v_rcp_f32 v149, v149
    v_mfma_f32_32x32x16_bf16 v[128:143], v[28:31], v[252:255], v[128:143]
    v_rcp_f32 v150, v150
    v_rcp_f32 v151, v151
    v_mul_f32 v80, v80, v144
    s_waitcnt lgkmcnt(4)
    v_mfma_f32_32x32x16_bf16 v[112:127], v[32:35], v[160:163], v[112:127]
    ds_read_b64_tr_b16 v[28:29], v10 offset:59968
    ds_read_b64_tr_b16 v[30:31], v10 offset:60352
    v_mul_f32 v81, v81, v145
    v_mul_f32 v82, v82, v146
    v_mul_f32 v83, v83, v147
    v_mul_f32 v84, v84, v148
    v_mul_f32 v85, v85, v149
    v_mfma_f32_32x32x16_bf16 v[128:143], v[32:35], v[164:167], v[128:143]
    v_mul_f32 v86, v86, v150
    v_mul_f32 v87, v87, v151
    v_cvt_pk_bf16_f32 v88, v80, v81
    v_cvt_pk_bf16_f32 v89, v82, v83
    v_cvt_pk_bf16_f32 v90, v84, v85
    s_waitcnt lgkmcnt(4)
    v_mfma_f32_32x32x16_bf16 v[112:127], v[36:39], v[168:171], v[112:127]
    v_cvt_pk_bf16_f32 v91, v86, v87
    s_cmp_eq_u32 s37, 0
    s_cbranch_scc1 L_wt_1057
    buffer_store_dwordx4 v[88:91], v2, s[8:11], s27 offen offset:1024
L_wb_1058:
    v_mul_f32 v152, v96, v96
    v_mul_f32 v153, v97, v97
    v_mul_f32 v154, v98, v98
    v_mfma_f32_32x32x16_bf16 v[128:143], v[36:39], v[172:175], v[128:143]
    v_mul_f32 v155, v99, v99
    v_mul_f32 v156, v100, v100
    v_mul_f32 v157, v101, v101
    v_mul_f32 v158, v102, v102
    v_mul_f32 v159, v103, v103
    s_waitcnt lgkmcnt(2)
    v_mfma_f32_32x32x16_bf16 v[112:127], v[24:27], v[176:179], v[112:127]
    v_fma_f32 v152, v152, v15, v13
    v_fma_f32 v153, v153, v15, v13
    v_fma_f32 v154, v154, v15, v13
    v_fma_f32 v155, v155, v15, v13
    v_fma_f32 v156, v156, v15, v13
    v_mfma_f32_32x32x16_bf16 v[128:143], v[24:27], v[180:183], v[128:143]
    v_fma_f32 v157, v157, v15, v13
    v_fma_f32 v158, v158, v15, v13
    v_fma_f32 v159, v159, v15, v13
    v_mul_f32 v152, v152, v96
    v_mul_f32 v153, v153, v97
    s_waitcnt lgkmcnt(0)
    v_mfma_f32_32x32x16_bf16 v[112:127], v[28:31], v[184:187], v[112:127]
    v_mul_f32 v154, v154, v98
    v_mul_f32 v155, v155, v99
    v_mul_f32 v156, v156, v100
    v_mul_f32 v157, v157, v101
    v_mul_f32 v158, v158, v102
    v_mfma_f32_32x32x16_bf16 v[128:143], v[28:31], v[188:191], v[128:143]
    v_mul_f32 v159, v159, v103
    v_exp_f32 v152, v152
    v_mul_f32 v96, v96, v104
    v_mfma_f32_32x32x16_bf16 v[112:127], a[246:249], v[40:43], v[112:127]
    v_exp_f32 v153, v153
    v_mul_f32 v97, v97, v105
    v_exp_f32 v154, v154
    v_mfma_f32_32x32x16_bf16 v[128:143], a[246:249], v[44:47], v[128:143]
    v_mul_f32 v98, v98, v106
    v_exp_f32 v155, v155
    v_mul_f32 v99, v99, v107
    v_exp_f32 v156, v156
    v_mul_f32 v100, v100, v108
    v_exp_f32 v157, v157
    v_mul_f32 v101, v101, v109
    v_exp_f32 v158, v158
    v_mul_f32 v102, v102, v110
    v_exp_f32 v159, v159
    v_mul_f32 v103, v103, v111
    v_fma_f32 v152, v152, v17, v17
    v_fma_f32 v153, v153, v17, v17
    v_fma_f32 v154, v154, v17, v17
    v_fma_f32 v155, v155, v17, v17
    v_fma_f32 v156, v156, v17, v17
    buffer_load_dword v18, v11, s[8:11], s36 offen sc1
    v_fma_f32 v157, v157, v17, v17
    v_fma_f32 v158, v158, v17, v17
    v_fma_f32 v159, v159, v17, v17
    v_rcp_f32 v152, v152
    v_rcp_f32 v153, v153
    v_rcp_f32 v154, v154
    v_rcp_f32 v155, v155
    v_rcp_f32 v156, v156
    v_rcp_f32 v157, v157
    v_rcp_f32 v158, v158
    v_rcp_f32 v159, v159
    v_mul_f32 v96, v96, v152
    v_mul_f32 v97, v97, v153
    v_mul_f32 v98, v98, v154
    v_mul_f32 v99, v99, v155
    v_mul_f32 v100, v100, v156
    v_mul_f32 v101, v101, v157
    v_mul_f32 v102, v102, v158
    v_mul_f32 v103, v103, v159
    v_cvt_pk_bf16_f32 v104, v96, v97
    v_cvt_pk_bf16_f32 v105, v98, v99
    v_cvt_pk_bf16_f32 v106, v100, v101
    v_cvt_pk_bf16_f32 v107, v102, v103
    s_cmp_eq_u32 s37, 0
    s_cbranch_scc1 L_wt_1059
    buffer_store_dwordx4 v[104:107], v2, s[8:11], s28 offen offset:1024
L_wb_1060:
    s_branch L_g2
L_final:
L_mega_end:
    s_endpgm
L_cf_1002:
    s_mov_b32 s36, 262144
L_cf_1002_l:
    buffer_load_dword v16, v15, s[8:11], s23 offen sc1
    s_waitcnt vmcnt(0)
    v_cmp_ne_u32 vcc, s96, v16
    s_nop 0
    s_mov_b64 s[34:35], vcc
    s_cmp_eq_u64 s[34:35], 0
    s_cbranch_scc1 L_cb_1003
    s_sub_u32 s36, s36, 1
    s_cbranch_scc0 L_cf_1002_l
    s_branch L_cb_1003
L_cf_1004:
    s_mov_b32 s36, 262144
L_cf_1004_l:
    buffer_load_dword v224, v2, s[8:11], s23 offen offset:0 sc1
    buffer_load_dword v225, v2, s[8:11], s23 offen offset:1024 sc1
    buffer_load_dword v226, v2, s[8:11], s23 offen offset:2048 sc1
    buffer_load_dword v227, v2, s[8:11], s23 offen offset:3072 sc1
    s_waitcnt vmcnt(0)
    v_cmp_ne_u32 vcc, s96, v224
    s_nop 0
    s_mov_b64 s[34:35], vcc
    v_cmp_ne_u32 vcc, s96, v225
    s_nop 0
    s_or_b64 s[34:35], s[34:35], vcc
    v_cmp_ne_u32 vcc, s96, v226
    s_nop 0
    s_or_b64 s[34:35], s[34:35], vcc
    v_cmp_ne_u32 vcc, s96, v227
    s_nop 0
    s_or_b64 s[34:35], s[34:35], vcc
    s_cmp_eq_u64 s[34:35], 0
    s_cbranch_scc1 L_cb_1005
    s_sub_u32 s36, s36, 1
    s_cbranch_scc0 L_cf_1004_l
    s_branch L_cb_1005
L_cf_1006:
    s_mov_b32 s36, 262144
L_cf_1006_l:
    buffer_load_dword v224, v2, s[8:11], s23 offen offset:0 sc1
    buffer_load_dword v225, v2, s[8:11], s23 offen offset:1024 sc1
    buffer_load_dword v226, v2, s[8:11], s23 offen offset:2048 sc1
    buffer_load_dword v227, v2, s[8:11], s23 offen offset:3072 sc1
    s_waitcnt vmcnt(0)
    v_cmp_ne_u32 vcc, s96, v224
    s_nop 0
    s_mov_b64 s[34:35], vcc
    v_cmp_ne_u32 vcc, s96, v225
    s_nop 0
    s_or_b64 s[34:35], s[34:35], vcc
    v_cmp_ne_u32 vcc, s96, v226
    s_nop 0
    s_or_b64 s[34:35], s[34:35], vcc
    v_cmp_ne_u32 vcc, s96, v227
    s_nop 0
    s_or_b64 s[34:35], s[34:35], vcc
    s_cmp_eq_u64 s[34:35], 0
    s_cbranch_scc1 L_cb_1007
    s_sub_u32 s36, s36, 1
    s_cbranch_scc0 L_cf_1006_l
    s_branch L_cb_1007
L_wt_1010:
    buffer_store_dwordx2 v[154:155], v7, s[8:11], s22 offen sc1
    s_nop 1
    s_branch L_wb_1011
L_cf_1012:
    s_mov_b32 s36, 262144
L_cf_1012_l:
    buffer_load_dword v16, v2, s[8:11], s31 offen offset:0 sc1
    buffer_load_dword v17, v2, s[8:11], s31 offen offset:1024 sc1
    s_waitcnt vmcnt(0)
    v_cmp_ne_u32 vcc, s96, v16
    s_nop 0
    s_mov_b64 s[34:35], vcc
    v_cmp_ne_u32 vcc, s96, v17
    s_nop 0
    s_or_b32 s34, s34, vcc_lo
    s_cmp_eq_u64 s[34:35], 0
    s_cbranch_scc1 L_cb_1013
    s_sub_u32 s36, s36, 1
    s_cbranch_scc0 L_cf_1012_l
    s_branch L_cb_1013
L_stspin_1014:
    s_mov_b32 s35, 262144
L_stspin_1014_l:
    buffer_load_dwordx4 v[144:147], v6, s[8:11], s26 offen offset:0 sc1
    buffer_load_dwordx4 v[148:151], v6, s[8:11], s26 offen offset:512 sc1
    buffer_load_dwordx4 v[152:155], v6, s[8:11], s26 offen offset:1024 sc1
    buffer_load_dwordx4 v[156:159], v6, s[8:11], s26 offen offset:1536 sc1
    s_waitcnt vmcnt(0)
    v_max_u32 v18, v145, v147
    v_max3_u32 v18, v18, v149, v151
    v_max3_u32 v18, v18, v153, v155
    v_max3_u32 v18, v18, v157, v159
    v_cmp_eq_u32 vcc, -1, v18
    s_cbranch_vccz L_stback_1015
    s_sub_u32 s35, s35, 1
    s_cbranch_scc0 L_stspin_1014_l
    s_branch L_stback_1015
L_wt_1016:
    buffer_store_dword v9, v8, s[8:11], s29 offen offset:0 sc1
    s_nop 1
    s_branch L_wb_1017
L_spin_1018:
    s_mov_b32 s35, 262144
L_spin_1018_l:
    buffer_load_dword v18, v11, s[8:11], s36 offen sc1
    s_waitcnt vmcnt(0)
    v_cmp_eq_u32 vcc, s96, v18
    s_nop 1
    s_and_b32 s34, vcc_lo, 0xff
    s_cmp_eq_u32 s34, 0xff
    s_cbranch_scc1 L_back_1019
    s_sub_u32 s35, s35, 1
    s_cbranch_scc0 L_spin_1018_l
    s_branch L_back_1019
L_wt_1020:
    buffer_store_dwordx4 v[120:123], v2, s[8:11], s27 offen offset:2048 sc1
    s_nop 1
    s_branch L_wb_1021
L_wt_1022:
    buffer_store_dword v9, v8, s[8:11], s29 offen offset:32 sc1
    s_nop 1
    s_branch L_wb_1023
L_wt_1024:
    buffer_store_dwordx4 v[136:139], v2, s[8:11], s28 offen offset:2048 sc1
    s_nop 1
    s_branch L_wb_1025
L_spin_1026:
    s_mov_b32 s35, 262144
L_spin_1026_l:
    buffer_load_dword v18, v11, s[8:11], s36 offen sc1
    s_waitcnt vmcnt(0)
    v_cmp_eq_u32 vcc, s96, v18
    s_nop 1
    s_and_b32 s34, vcc_lo, 0xff00
    s_cmp_eq_u32 s34, 0xff00
    s_cbranch_scc1 L_back_1027
    s_sub_u32 s35, s35, 1
    s_cbranch_scc0 L_spin_1026_l
    s_branch L_back_1027
L_wt_1028:
    buffer_store_dword v9, v8, s[8:11], s29 offen offset:64 sc1
    s_nop 1
    s_branch L_wb_1029
L_spin_1030:
    s_mov_b32 s35, 262144
L_spin_1030_l:
    buffer_load_dword v18, v11, s[8:11], s36 offen sc1
    s_waitcnt vmcnt(0)
    v_cmp_eq_u32 vcc, s96, v18
    s_nop 1
    s_and_b32 s34, vcc_lo, 0xff0000
    s_cmp_eq_u32 s34, 0xff0000
    s_cbranch_scc1 L_back_1031
    s_sub_u32 s35, s35, 1
    s_cbranch_scc0 L_spin_1030_l
    s_branch L_back_1031
L_wb_1033:
    buffer_wbl2 sc1
    s_branch L_wbd_1034
L_wt_1035:
    buffer_store_dwordx2 v[12:13], v2, s[8:11], s27 offen sc1
    s_nop 1
    s_branch L_wb_1036
L_wt_1039:
    buffer_store_dwordx2 v[44:45], v21, s[8:11], s23 offen offset:0 sc1
    buffer_store_dwordx2 v[46:47], v21, s[8:11], s23 offen offset:2048 sc1
    buffer_store_dwordx2 v[48:49], v21, s[8:11], s25 offen offset:0 sc1
    buffer_store_dwordx2 v[50:51], v21, s[8:11], s25 offen offset:2048 sc1
    buffer_store_dwordx2 v[52:53], v21, s[8:11], s28 offen offset:0 sc1
    s_nop 1
    s_branch L_wb_1040
L_wt_1041:
    buffer_store_dword v9, v8, s[8:11], s29 offen offset:0 sc1
    s_nop 1
    s_branch L_wb_1042
L_wt_1043:
    buffer_store_dwordx2 v[12:13], v2, s[8:11], s22 offen sc1
    s_nop 1
    s_branch L_wb_1044
L_spin_1045:
    s_mov_b32 s35, 262144
L_spin_1045_l:
    buffer_load_dword v18, v11, s[8:11], s36 offen sc1
    s_waitcnt vmcnt(0)
    v_cmp_eq_u32 vcc, s96, v18
    s_nop 1
    s_and_b32 s34, vcc_lo, 0xffffffff
    s_cmp_eq_u32 s34, 0xffffffff
    s_cbranch_scc1 L_back_1046
    s_sub_u32 s35, s35, 1
    s_cbranch_scc0 L_spin_1045_l
    s_branch L_back_1046
L_stspin_1047:
    s_mov_b32 s35, 262144
L_stspin_1047_l:
    buffer_load_dwordx4 v[144:147], v6, s[8:11], s26 offen offset:0 sc1
    buffer_load_dwordx4 v[148:151], v6, s[8:11], s26 offen offset:512 sc1
    buffer_load_dwordx4 v[152:155], v6, s[8:11], s26 offen offset:1024 sc1
    buffer_load_dwordx4 v[156:159], v6, s[8:11], s26 offen offset:1536 sc1
    s_waitcnt vmcnt(0)
    v_max_u32 v18, v145, v147
    v_max3_u32 v18, v18, v149, v151
    v_max3_u32 v18, v18, v153, v155
    v_max3_u32 v18, v18, v157, v159
    v_cmp_eq_u32 vcc, -1, v18
    s_cbranch_vccz L_stback_1048
    s_sub_u32 s35, s35, 1
    s_cbranch_scc0 L_stspin_1047_l
    s_branch L_stback_1048
L_wb_1049:
    buffer_wbl2 sc1
    s_branch L_wbd_1050
L_wt_1051:
    buffer_store_dwordx4 v[56:59], v2, s[8:11], s27 offen offset:0 sc1
    s_nop 1
    s_branch L_wb_1052
L_wt_1053:
    buffer_store_dwordx4 v[72:75], v2, s[8:11], s28 offen offset:0 sc1
    s_nop 1
    s_branch L_wb_1054
L_wt_1055:
    buffer_store_dword v9, v8, s[8:11], s29 offen offset:0 sc1
    s_nop 1
    s_branch L_wb_1056
L_wt_1057:
    buffer_store_dwordx4 v[88:91], v2, s[8:11], s27 offen offset:1024 sc1
    s_nop 1
    s_branch L_wb_1058
L_wt_1059:
    buffer_store_dwordx4 v[104:107], v2, s[8:11], s28 offen offset:1024 sc1
    s_nop 1
    s_branch L_wb_1060
L_mega_last:
    s_endpgm
.section .rodata,"a"
.p2align 6
.amdhsa_kernel interleave_layers__ssm_conv_h3__glu_gated_geglu__prompt_kernel
  .amdhsa_next_free_vgpr 512
  .amdhsa_next_free_sgpr 102
  .amdhsa_accum_offset 256
  .amdhsa_group_segment_fixed_size 0
  .amdhsa_kernarg_size 104
  .amdhsa_user_sgpr_count 2
  .amdhsa_user_sgpr_kernarg_segment_ptr 1
  .amdhsa_system_sgpr_workgroup_id_x 1
  .amdhsa_float_denorm_mode_32 3
.end_amdhsa_kernel
```
